```python
import torch

def _softmax(x, axis=-1):
    return torch.softmax(x, dim=axis)
def _gelu(x):
    return torch.nn.functional.gelu(x, approximate="tanh")
def _silu(x):
    return torch.nn.functional.silu(x)
def _sigmoid(x):
    return torch.sigmoid(x)
def _layernorm(x, axis=-1, eps=1e-5):
    m = x.mean(dim=axis, keepdim=True)
    v = x.var(dim=axis, keepdim=True, unbiased=False)
    return (x - m) / torch.sqrt(v + eps)
def _scatter_add(tgt, idx, src, axis=0):
    return tgt.clone().index_add_(axis, idx, src)
def _segment_sum(src, seg, n):
    out = torch.zeros((n,) + src.shape[1:], dtype=src.dtype)
    return out.index_add_(0, seg, src)
def _pad(x, pw):
    flat = tuple(v for pair in reversed(pw) for v in pair)
    return torch.nn.functional.pad(x, flat)

kernel_name = 'standalone__mha_softmax__near_ridge'

def setup_inputs():

    _w = (lambda a: (lambda t: t.to(torch.bfloat16) if t.is_floating_point() else t)(torch.as_tensor(a)))
    B, H, Sq, Sk, D = 32, 16, 384, 384, 256
    return {
        "q": _w((lambda *s: torch.randn(*s, dtype=torch.bfloat16) * 0.8)(B, H, Sq, D)),
        "k": _w((lambda *s: torch.randn(*s, dtype=torch.bfloat16) * 0.8)(B, H, Sk, D)),
        "v": _w((lambda *s: torch.randn(*s, dtype=torch.bfloat16) * 0.05)(B, H, Sk, D)),
    }

def reference(q, k, v):
    scale = q.shape[-1] ** -0.5
    scores = torch.einsum("bhqd,bhkd->bhqk", q, k) * scale
    p = _softmax(scores, axis=-1)
    return torch.einsum("bhqk,bhkd->bhqd", p, v)
```

```asm
; @launch grid=(256,1,1) block=(256,1,1) lds=163840
.amdgcn_target "amdgcn-amd-amdhsa--gfx950"
.text
.globl standalone__mha_softmax__near_ridge_kernel
.p2align 8
.type standalone__mha_softmax__near_ridge_kernel,@function
standalone__mha_softmax__near_ridge_kernel:
    s_cmp_ge_u32 s2, 256
    s_cbranch_scc1 L_end
    s_load_dwordx4 s[4:7], s[0:1], 0
    s_load_dwordx4 s[40:43], s[0:1], 16
    s_getpc_b64 s[44:45]
L_pc:
    v_lshlrev_b32 v28, 4, v0
    v_mov_b32 v29, s45
    v_add_co_u32 v28, vcc, s44, v28
    v_addc_co_u32 v29, vcc, 0, v29, vcc
    v_and_b32 v28, -16, v28
    global_load_dwordx4 v[32:35], v[28:29], off
    s_lshr_b32 s33, s2, 3
    s_and_b32 s33, s33, 7
    s_lshl_b32 s33, s33, 13
    v_lshlrev_b32 v28, 4, v0
    v_add_u32 v28, s33, v28
    v_add_u32 v30, 0x1000, v28
    v_min_u32 v28, L_end-L_pc-16, v28
    v_min_u32 v30, L_end-L_pc-16, v30
    v_mov_b32 v29, s45
    v_mov_b32 v31, s45
    v_add_co_u32 v28, vcc, s44, v28
    v_addc_co_u32 v29, vcc, 0, v29, vcc
    v_add_co_u32 v30, vcc, s44, v30
    v_addc_co_u32 v31, vcc, 0, v31, vcc
    v_and_b32 v28, -16, v28
    v_and_b32 v30, -16, v30
    s_mul_i32 s24, s2, 393216
    s_add_u32 s25, s24, 196608
    s_mov_b32 s32, 0
    s_mov_b32 s31, 0
    s_mov_b32 s28, 0x3db8aa3b
    v_lshrrev_b32 v16, 6, v0
    v_bfe_u32 v17, v0, 5, 1
    v_readfirstlane_b32 s26, v16
    v_bfe_u32 v18, v0, 2, 3
    v_lshl_add_u32 v19, v16, 3, v18
    v_lshlrev_b32 v19, 9, v19
    v_lshl_add_u32 v19, v17, 6, v19
    v_and_b32 v20, 3, v0
    v_lshl_add_u32 v5, v20, 4, v19
    v_bfe_u32 v21, v0, 4, 1
    v_xor_b32 v26, v20, v21
    v_bfe_u32 v27, v0, 6, 1
    v_lshl_add_u32 v21, v27, 1, v21
    v_xor_b32 v20, v20, v21
    v_lshl_add_u32 v4, v20, 4, v19
    v_mul_u32_u24 v19, 96, v16
    v_add_u32 v19, v19, v18
    v_lshlrev_b32 v19, 9, v19
    v_lshl_add_u32 v19, v17, 6, v19
    v_lshl_add_u32 v6, v26, 4, v19
    v_bfe_u32 v18, v0, 3, 2
    v_and_b32 v19, 7, v0
    v_lshlrev_b32 v19, 6, v19
    v_bfe_u32 v20, v0, 2, 2
    v_xor_b32 v20, v20, v17
    v_lshl_add_u32 v19, v20, 4, v19
    v_lshl_add_u32 v1, v18, 10, v19
    v_xor_b32 v2, 32, v1
    v_lshl_add_u32 v19, v18, 12, v19
    v_lshl_add_u32 v19, v16, 10, v19
    v_add_u32 v7, 98304, v19
    v_xor_b32 v8, 32, v7
    v_bfe_u32 v18, v0, 2, 2
    v_lshl_add_u32 v18, v17, 2, v18
    v_lshlrev_b32 v18, 6, v18
    v_bfe_u32 v19, v0, 4, 1
    v_lshl_add_u32 v18, v19, 5, v18
    v_and_b32 v19, 1, v0
    v_lshl_add_u32 v18, v19, 4, v18
    v_bfe_u32 v19, v0, 1, 1
    v_lshl_add_u32 v3, v19, 3, v18
    v_xor_b32 v3, 0xc000, v3
    v_and_b32 v18, 31, v0
    v_lshlrev_b32 v18, 7, v18
    v_and_b32 v19, 7, v0
    v_xor_b32 v19, v19, v17
    v_lshl_add_u32 v18, v19, 4, v18
    v_lshl_add_u32 v18, v16, 12, v18
    v_add_u32 v9, 147456, v18
    v_bfe_u32 v18, v0, 3, 3
    v_and_b32 v19, 7, v0
    v_xor_b32 v20, v19, v18
    v_lshlrev_b32 v20, 4, v20
    v_lshl_add_u32 v20, v18, 7, v20
    v_lshl_add_u32 v20, v16, 12, v20
    v_add_u32 v10, 147456, v20
    v_mul_u32_u24 v20, 96, v16
    v_add_u32 v20, v20, v18
    v_lshlrev_b32 v20, 9, v20
    v_lshl_add_u32 v11, v19, 4, v20
    v_mov_b32 v12, 1.0
    v_mov_b32 v13, 1.0
    v_mov_b32 v14, 1.0
    s_lshl_b32 s27, s26, 10
    s_waitcnt lgkmcnt(0)
    s_mov_b32 s33, 0
    s_mov_b32 s8, s4
    s_and_b32 s9, s5, 0xffff
    s_mov_b32 s10, 100663296
    s_mov_b32 s11, 0x00020000
    s_mov_b32 s12, s6
    s_and_b32 s13, s7, 0xffff
    s_mov_b32 s14, 100663296
    s_mov_b32 s15, 0x00020000
    s_mov_b32 s16, s40
    s_and_b32 s17, s41, 0xffff
    s_mov_b32 s18, 100663296
    s_mov_b32 s19, 0x00020000
    s_mov_b32 s20, s42
    s_and_b32 s21, s43, 0xffff
    s_mov_b32 s22, 0
    s_mov_b32 s23, 0x00020000
    s_add_u32 m0, s27, 0
    s_add_u32 s29, s24, 0
    buffer_load_dwordx4 v4, s[12:15], s29 offen offset:0 nt lds
    s_add_u32 m0, s27, 3968
    s_add_u32 s29, s24, 0
    buffer_load_dwordx4 v4, s[12:15], s29 offen offset:128 nt lds
    s_add_u32 m0, s27, 7936
    s_add_u32 s29, s24, 0
    buffer_load_dwordx4 v4, s[12:15], s29 offen offset:256 nt lds
    s_add_u32 m0, s27, 11904
    s_add_u32 s29, s24, 0
    buffer_load_dwordx4 v4, s[12:15], s29 offen offset:384 nt lds
    s_add_u32 m0, s27, 147456
    s_add_u32 s29, s24, 32768
    buffer_load_dwordx4 v6, s[8:11], s29 offen nt lds
    v_xor_b32 v6, 32, v6
    s_add_u32 m0, s27, 151552
    s_add_u32 s29, s24, 36864
    buffer_load_dwordx4 v6, s[8:11], s29 offen nt lds
    v_xor_b32 v6, 32, v6
    s_add_u32 m0, s27, 155648
    s_add_u32 s29, s24, 40960
    buffer_load_dwordx4 v6, s[8:11], s29 offen nt lds
    v_xor_b32 v6, 32, v6
    s_add_u32 m0, s27, 159744
    s_add_u32 s29, s24, 45056
    buffer_load_dwordx4 v6, s[8:11], s29 offen nt lds
    v_xor_b32 v6, 32, v6
    s_add_u32 m0, s27, 98304
    s_add_u32 s29, s24, 32896
    buffer_load_dwordx4 v6, s[8:11], s29 offen nt lds
    v_xor_b32 v6, 32, v6
    s_add_u32 m0, s27, 102400
    s_add_u32 s29, s24, 36992
    buffer_load_dwordx4 v6, s[8:11], s29 offen nt lds
    v_xor_b32 v6, 32, v6
    s_add_u32 m0, s27, 106496
    s_add_u32 s29, s24, 41088
    buffer_load_dwordx4 v6, s[8:11], s29 offen nt lds
    v_xor_b32 v6, 32, v6
    s_add_u32 m0, s27, 110592
    s_add_u32 s29, s24, 45184
    buffer_load_dwordx4 v6, s[8:11], s29 offen nt lds
    v_xor_b32 v6, 32, v6
    s_add_u32 m0, s27, 114688
    s_add_u32 s29, s24, 33024
    buffer_load_dwordx4 v6, s[8:11], s29 offen nt lds
    v_xor_b32 v6, 32, v6
    s_add_u32 m0, s27, 118784
    s_add_u32 s29, s24, 37120
    buffer_load_dwordx4 v6, s[8:11], s29 offen nt lds
    v_xor_b32 v6, 32, v6
    s_add_u32 m0, s27, 122880
    s_add_u32 s29, s24, 41216
    buffer_load_dwordx4 v6, s[8:11], s29 offen nt lds
    v_xor_b32 v6, 32, v6
    s_add_u32 m0, s27, 126976
    s_add_u32 s29, s24, 45312
    buffer_load_dwordx4 v6, s[8:11], s29 offen nt lds
    v_xor_b32 v6, 32, v6
    s_add_u32 m0, s27, 131072
    s_add_u32 s29, s24, 33152
    buffer_load_dwordx4 v6, s[8:11], s29 offen nt lds
    v_xor_b32 v6, 32, v6
    s_add_u32 m0, s27, 135168
    s_add_u32 s29, s24, 37248
    buffer_load_dwordx4 v6, s[8:11], s29 offen nt lds
    v_xor_b32 v6, 32, v6
    s_add_u32 m0, s27, 139264
    s_add_u32 s29, s24, 41344
    buffer_load_dwordx4 v6, s[8:11], s29 offen nt lds
    v_xor_b32 v6, 32, v6
    s_add_u32 m0, s27, 143360
    s_add_u32 s29, s24, 45440
    buffer_load_dwordx4 v6, s[8:11], s29 offen nt lds
    v_xor_b32 v6, 32, v6
    s_add_u32 m0, s27, 81920
    s_add_u32 s29, s24, 0
    buffer_load_dwordx4 v6, s[8:11], s29 offen nt lds
    v_xor_b32 v6, 32, v6
    s_add_u32 m0, s27, 86016
    s_add_u32 s29, s24, 4096
    buffer_load_dwordx4 v6, s[8:11], s29 offen nt lds
    v_xor_b32 v6, 32, v6
    s_add_u32 m0, s27, 90112
    s_add_u32 s29, s24, 8192
    buffer_load_dwordx4 v6, s[8:11], s29 offen nt lds
    v_xor_b32 v6, 32, v6
    s_add_u32 m0, s27, 94208
    s_add_u32 s29, s24, 12288
    buffer_load_dwordx4 v6, s[8:11], s29 offen nt lds
    v_xor_b32 v6, 32, v6
    s_add_u32 m0, s27, 49152
    s_add_u32 s29, s24, 128
    buffer_load_dwordx4 v6, s[8:11], s29 offen nt lds
    v_xor_b32 v6, 32, v6
    s_add_u32 m0, s27, 53248
    s_add_u32 s29, s24, 4224
    buffer_load_dwordx4 v6, s[8:11], s29 offen nt lds
    v_xor_b32 v6, 32, v6
    s_add_u32 m0, s27, 57344
    s_add_u32 s29, s24, 8320
    buffer_load_dwordx4 v6, s[8:11], s29 offen nt lds
    v_xor_b32 v6, 32, v6
    s_add_u32 m0, s27, 61440
    s_add_u32 s29, s24, 12416
    buffer_load_dwordx4 v6, s[8:11], s29 offen nt lds
    v_xor_b32 v6, 32, v6
    s_waitcnt vmcnt(20)
    ds_read_b128 a[64:67], v7 offset:49152
    ds_read_b128 a[68:71], v8 offset:49152
    ds_read_b128 a[72:75], v7 offset:49664
    ds_read_b128 a[76:79], v8 offset:49664
    s_waitcnt lgkmcnt(0)
    s_add_u32 m0, s27, 65536
    s_add_u32 s29, s24, 256
    buffer_load_dwordx4 v6, s[8:11], s29 offen nt lds
    v_xor_b32 v6, 32, v6
    s_add_u32 m0, s27, 69632
    s_add_u32 s29, s24, 4352
    buffer_load_dwordx4 v6, s[8:11], s29 offen nt lds
    v_xor_b32 v6, 32, v6
    s_add_u32 m0, s27, 73728
    s_add_u32 s29, s24, 8448
    buffer_load_dwordx4 v6, s[8:11], s29 offen nt lds
    v_xor_b32 v6, 32, v6
    s_add_u32 m0, s27, 77824
    s_add_u32 s29, s24, 12544
    buffer_load_dwordx4 v6, s[8:11], s29 offen nt lds
    v_xor_b32 v6, 32, v6
    s_add_u32 m0, s27, 16384
    s_add_u32 s29, s24, 384
    buffer_load_dwordx4 v6, s[8:11], s29 offen nt lds
    v_xor_b32 v6, 32, v6
    s_add_u32 m0, s27, 20480
    s_add_u32 s29, s24, 4480
    buffer_load_dwordx4 v6, s[8:11], s29 offen nt lds
    v_xor_b32 v6, 32, v6
    s_add_u32 m0, s27, 24576
    s_add_u32 s29, s24, 8576
    buffer_load_dwordx4 v6, s[8:11], s29 offen nt lds
    v_xor_b32 v6, 32, v6
    s_add_u32 m0, s27, 28672
    s_add_u32 s29, s24, 12672
    buffer_load_dwordx4 v6, s[8:11], s29 offen nt lds
    v_xor_b32 v6, 32, v6
    s_waitcnt vmcnt(12)
    v_subrev_u32 v15, 49152, v7
    ds_read_b128 a[0:3], v15 offset:32768
    ds_read_b128 a[8:11], v15 offset:33280
    v_xor_b32 v15, 32, v15
    ds_read_b128 a[4:7], v15 offset:32768
    ds_read_b128 a[12:15], v15 offset:33280
    s_waitcnt lgkmcnt(0)
    s_add_u32 m0, s27, 32768
    s_add_u32 s29, s24, 16384
    buffer_load_dwordx4 v6, s[8:11], s29 offen nt lds
    v_xor_b32 v6, 32, v6
    s_add_u32 m0, s27, 36864
    s_add_u32 s29, s24, 20480
    buffer_load_dwordx4 v6, s[8:11], s29 offen nt lds
    v_xor_b32 v6, 32, v6
    s_add_u32 m0, s27, 40960
    s_add_u32 s29, s24, 24576
    buffer_load_dwordx4 v6, s[8:11], s29 offen nt lds
    v_xor_b32 v6, 32, v6
    s_add_u32 m0, s27, 45056
    s_add_u32 s29, s24, 28672
    buffer_load_dwordx4 v6, s[8:11], s29 offen nt lds
    v_xor_b32 v6, 32, v6
    s_add_u32 m0, s27, 147456
    s_add_u32 s29, s24, 16512
    buffer_load_dwordx4 v6, s[8:11], s29 offen nt lds
    v_xor_b32 v6, 32, v6
    s_add_u32 m0, s27, 151552
    s_add_u32 s29, s24, 20608
    buffer_load_dwordx4 v6, s[8:11], s29 offen nt lds
    v_xor_b32 v6, 32, v6
    s_add_u32 m0, s27, 155648
    s_add_u32 s29, s24, 24704
    buffer_load_dwordx4 v6, s[8:11], s29 offen nt lds
    v_xor_b32 v6, 32, v6
    s_add_u32 m0, s27, 159744
    s_add_u32 s29, s24, 28800
    buffer_load_dwordx4 v6, s[8:11], s29 offen nt lds
    v_xor_b32 v6, 32, v6
    global_load_dwordx4 v[32:35], v[28:29], off
    global_load_dwordx4 v[36:39], v[30:31], off
    s_waitcnt vmcnt(18)
    v_subrev_u32 v15, 49152, v7
    ds_read_b128 a[16:19], v15 offset:0
    ds_read_b128 a[24:27], v15 offset:512
    v_xor_b32 v15, 32, v15
    ds_read_b128 a[20:23], v15 offset:0
    ds_read_b128 a[28:31], v15 offset:512
    s_waitcnt lgkmcnt(0)
    s_add_u32 m0, s27, 49152
    s_add_u32 s29, s24, 16640
    buffer_load_dwordx4 v6, s[8:11], s29 offen nt lds
    v_xor_b32 v6, 32, v6
    s_add_u32 m0, s27, 53248
    s_add_u32 s29, s24, 20736
    buffer_load_dwordx4 v6, s[8:11], s29 offen nt lds
    v_xor_b32 v6, 32, v6
    s_add_u32 m0, s27, 57344
    s_add_u32 s29, s24, 24832
    buffer_load_dwordx4 v6, s[8:11], s29 offen nt lds
    v_xor_b32 v6, 32, v6
    s_add_u32 m0, s27, 61440
    s_add_u32 s29, s24, 28928
    buffer_load_dwordx4 v6, s[8:11], s29 offen nt lds
    v_xor_b32 v6, 32, v6
    s_waitcnt vmcnt(18)
    v_subrev_u32 v15, 49152, v7
    ds_read_b128 v[80:83], v15 offset:16384
    ds_read_b128 v[88:91], v15 offset:16896
    v_xor_b32 v15, 32, v15
    ds_read_b128 v[84:87], v15 offset:16384
    ds_read_b128 v[92:95], v15 offset:16896
    s_waitcnt lgkmcnt(0)
    s_add_u32 m0, s27, 65536
    s_add_u32 s29, s24, 16768
    buffer_load_dwordx4 v6, s[8:11], s29 offen nt lds
    v_xor_b32 v6, 32, v6
    s_add_u32 m0, s27, 69632
    s_add_u32 s29, s24, 20864
    buffer_load_dwordx4 v6, s[8:11], s29 offen nt lds
    v_xor_b32 v6, 32, v6
    s_add_u32 m0, s27, 73728
    s_add_u32 s29, s24, 24960
    buffer_load_dwordx4 v6, s[8:11], s29 offen nt lds
    v_xor_b32 v6, 32, v6
    s_add_u32 m0, s27, 77824
    s_add_u32 s29, s24, 29056
    buffer_load_dwordx4 v6, s[8:11], s29 offen nt lds
    v_xor_b32 v6, 32, v6
    s_waitcnt vmcnt(18)
    v_subrev_u32 v15, 98304, v7
    ds_read_b128 v[96:99], v15 offset:16384
    ds_read_b128 v[104:107], v15 offset:16896
    v_xor_b32 v15, 32, v15
    ds_read_b128 v[100:103], v15 offset:16384
    ds_read_b128 v[108:111], v15 offset:16896
    s_waitcnt lgkmcnt(0)
    s_waitcnt vmcnt(14)
    v_subrev_u32 v15, 98304, v7
    ds_read_b128 a[32:35], v15 offset:32768
    ds_read_b128 a[40:43], v15 offset:33280
    v_xor_b32 v15, 32, v15
    ds_read_b128 a[36:39], v15 offset:32768
    ds_read_b128 a[44:47], v15 offset:33280
    s_waitcnt lgkmcnt(0)
    s_waitcnt vmcnt(10)
    ds_read_b128 a[48:51], v7 offset:49152
    ds_read_b128 a[52:55], v8 offset:49152
    ds_read_b128 a[56:59], v7 offset:49664
    ds_read_b128 a[60:63], v8 offset:49664
    s_waitcnt lgkmcnt(0)
    s_barrier
    ds_read_b128 v[216:219], v1 offset:0
    ds_read_b128 v[220:223], v2 offset:0
    ds_read_b128 a[240:243], v1 offset:512
    ds_read_b128 a[244:247], v2 offset:512
    ds_read_b128 v[224:227], v1 offset:4096
    ds_read_b128 v[228:231], v2 offset:4096
    ds_read_b128 a[248:251], v1 offset:4608
    ds_read_b128 a[252:255], v2 offset:4608
    ds_read_b128 v[240:243], v1 offset:8192
    ds_read_b128 v[244:247], v2 offset:8192
    ds_read_b128 a[232:235], v1 offset:8704
    ds_read_b128 a[236:239], v2 offset:8704
    ds_read_b128 v[232:235], v1 offset:12288
    ds_read_b128 v[236:239], v2 offset:12288
    ds_read_b128 v[248:251], v1 offset:12800
    ds_read_b128 v[16:19], v7 offset:0
    ds_read_b128 v[252:255], v2 offset:12800
L_head:
    s_barrier
    s_waitcnt lgkmcnt(15)
    v_mfma_f32_32x32x16_bf16 v[48:63], v[216:219], a[64:67], 0
    ds_read_b128 v[20:23], v8 offset:0
    s_add_u32 m0, s27, 16384
    s_add_u32 s29, s24, 16384
    buffer_load_dwordx4 v4, s[12:15], s29 offen offset:0 nt lds
    v_mfma_f32_32x32x16_bf16 v[48:63], v[220:223], a[68:71], v[48:63]
    ds_read_b128 v[24:27], v7 offset:512
    s_add_u32 m0, s27, 20352
    s_add_u32 s29, s24, 16384
    buffer_load_dwordx4 v4, s[12:15], s29 offen offset:128 nt lds
    s_waitcnt lgkmcnt(15)
    v_mfma_f32_32x32x16_bf16 v[48:63], a[240:243], a[72:75], v[48:63]
    ds_read_b128 v[28:31], v8 offset:512
    v_mul_f32 v112, v112, v13
    v_mul_f32 v113, v113, v13
    v_cvt_pk_bf16_f32 v192, v112, v113
    v_mfma_f32_32x32x16_bf16 v[48:63], a[244:247], a[76:79], v[48:63]
    ds_read_b128 a[208:211], v7 offset:16384
    v_mul_f32 v114, v114, v13
    v_mul_f32 v115, v115, v13
    s_waitcnt lgkmcnt(3)
    v_mfma_f32_32x32x16_bf16 v[48:63], v[224:227], v[16:19], v[48:63]
    ds_read_b128 a[212:215], v8 offset:16384
    v_cvt_pk_bf16_f32 v193, v114, v115
    v_mul_f32 v116, v116, v13
    v_mul_f32 v117, v117, v13
    v_mfma_f32_32x32x16_bf16 v[48:63], v[228:231], v[20:23], v[48:63]
    ds_read_b128 v[208:211], v7 offset:16896
    v_cvt_pk_bf16_f32 v194, v116, v117
    v_mul_f32 v118, v118, v13
    s_waitcnt lgkmcnt(3)
    v_mfma_f32_32x32x16_bf16 v[48:63], a[248:251], v[24:27], v[48:63]
    ds_read_b128 v[212:215], v8 offset:16896
    v_mul_f32 v119, v119, v13
    v_cvt_pk_bf16_f32 v195, v118, v119
    v_mul_f32 v120, v120, v13
    v_mfma_f32_32x32x16_bf16 v[48:63], a[252:255], v[28:31], v[48:63]
    ds_read_b128 a[216:219], v7 offset:32768
    v_mul_f32 v121, v121, v13
    v_cvt_pk_bf16_f32 v196, v120, v121
    s_waitcnt lgkmcnt(3)
    v_mfma_f32_32x32x16_bf16 v[48:63], v[240:243], a[208:211], v[48:63]
    ds_read_b128 a[220:223], v8 offset:32768
    v_mul_f32 v122, v122, v13
    v_mul_f32 v123, v123, v13
    v_cvt_pk_bf16_f32 v197, v122, v123
    v_mfma_f32_32x32x16_bf16 v[48:63], v[244:247], a[212:215], v[48:63]
    ds_read_b128 v[16:19], v7 offset:33280
    v_mul_f32 v124, v124, v13
    v_mul_f32 v125, v125, v13
    v_cvt_pk_bf16_f32 v198, v124, v125
    s_waitcnt lgkmcnt(3)
    v_mfma_f32_32x32x16_bf16 v[48:63], a[232:235], v[208:211], v[48:63]
    ds_read_b128 v[20:23], v8 offset:33280
    v_mul_f32 v126, v126, v13
    v_mul_f32 v127, v127, v13
    v_cvt_pk_bf16_f32 v199, v126, v127
    v_mul_f32 v128, v128, v13
    v_mfma_f32_32x32x16_bf16 v[48:63], a[236:239], v[212:215], v[48:63]
    v_mul_f32 v129, v129, v13
    v_cvt_pk_bf16_f32 v200, v128, v129
    v_mul_f32 v130, v130, v13
    v_mul_f32 v131, v131, v13
    s_waitcnt lgkmcnt(2)
    v_mfma_f32_32x32x16_bf16 v[48:63], v[232:235], a[216:219], v[48:63]
    v_cvt_pk_bf16_f32 v201, v130, v131
    v_mul_f32 v132, v132, v13
    v_mul_f32 v133, v133, v13
    v_cvt_pk_bf16_f32 v202, v132, v133
    v_mul_f32 v134, v134, v13
    v_mfma_f32_32x32x16_bf16 v[48:63], v[236:239], a[220:223], v[48:63]
    v_mul_f32 v135, v135, v13
    v_cvt_pk_bf16_f32 v203, v134, v135
    v_mul_f32 v136, v136, v13
    v_mul_f32 v137, v137, v13
    s_waitcnt lgkmcnt(0)
    v_mfma_f32_32x32x16_bf16 v[48:63], v[248:251], v[16:19], v[48:63]
    v_cvt_pk_bf16_f32 v204, v136, v137
    v_mul_f32 v138, v138, v13
    v_mul_f32 v139, v139, v13
    v_cvt_pk_bf16_f32 v205, v138, v139
    v_mul_f32 v140, v140, v13
    v_mfma_f32_32x32x16_bf16 v[48:63], v[252:255], v[20:23], v[48:63]
    v_mul_f32 v141, v141, v13
    v_cvt_pk_bf16_f32 v206, v140, v141
    v_mul_f32 v142, v142, v13
    v_mul_f32 v143, v143, v13
    v_cvt_pk_bf16_f32 v207, v142, v143
    v_mfma_f32_32x32x16_bf16 v[64:79], v[216:219], a[0:3], 0
    s_add_u32 m0, s27, 24320
    s_add_u32 s29, s24, 16384
    buffer_load_dwordx4 v4, s[12:15], s29 offen offset:256 nt lds
    v_mfma_f32_32x32x16_bf16 v[64:79], v[220:223], a[4:7], v[64:79]
    s_add_u32 m0, s27, 28288
    s_add_u32 s29, s24, 16384
    buffer_load_dwordx4 v4, s[12:15], s29 offen offset:384 nt lds
    v_mfma_f32_32x32x16_bf16 v[64:79], a[240:243], a[8:11], v[64:79]
    v_max3_f32 v0, v48, v49, v50
    v_max3_f32 v0, v0, v51, v52
    v_max3_f32 v0, v0, v53, v54
    v_max3_f32 v0, v0, v55, v56
    v_max3_f32 v0, v0, v57, v58
    v_max3_f32 v0, v0, v59, v60
    v_max3_f32 v0, v0, v61, v62
    v_max_f32 v0, v0, v63
    v_mfma_f32_32x32x16_bf16 v[64:79], a[244:247], a[12:15], v[64:79]
    v_mov_b32 v14, v0
    s_nop 1
    v_permlane32_swap_b32 v0, v14
    v_max_f32 v0, v0, v14
    v_mul_f32 v0, s28, v0
    v_add_f32 v14, 0x40e00000, v0
    s_waitcnt vmcnt(8)
    v_subrev_u32 v15, 49152, v7
    v_mfma_f32_32x32x16_bf16 v[64:79], v[224:227], a[16:19], v[64:79]
    v_fma_f32 v48, v48, s28, -v14
    v_fma_f32 v49, v49, s28, -v14
    v_exp_f32 v44, v48
    v_fma_f32 v50, v50, s28, -v14
    v_exp_f32 v45, v49
    ds_read_b128 v[112:115], v15 offset:0
    ds_read_b128 v[120:123], v15 offset:512
    v_mfma_f32_32x32x16_bf16 v[64:79], v[228:231], a[20:23], v[64:79]
    v_fma_f32 v51, v51, s28, -v14
    v_add_f32 v42, v44, v45
    v_cvt_pk_bf16_f32 v32, v44, v45
    v_accvgpr_write_b32 a80, v32
    v_exp_f32 v46, v50
    v_xor_b32 v15, 32, v15
    ds_read_b128 v[116:119], v15 offset:0
    ds_read_b128 v[124:127], v15 offset:512
    v_mfma_f32_32x32x16_bf16 v[64:79], a[248:251], a[24:27], v[64:79]
    s_add_u32 m0, s27, 32768
    s_add_u32 s29, s24, 32768
    buffer_load_dwordx4 v4, s[12:15], s29 offen offset:0 nt lds
    v_fma_f32 v52, v52, s28, -v14
    v_add_f32 v42, v42, v46
    v_exp_f32 v47, v51
    v_mfma_f32_32x32x16_bf16 v[64:79], a[252:255], a[28:31], v[64:79]
    v_fma_f32 v53, v53, s28, -v14
    v_add_f32 v42, v42, v47
    v_cvt_pk_bf16_f32 v33, v46, v47
    v_accvgpr_write_b32 a81, v33
    v_exp_f32 v44, v52
    v_mfma_f32_32x32x16_bf16 v[64:79], v[240:243], v[80:83], v[64:79]
    v_fma_f32 v54, v54, s28, -v14
    v_add_f32 v42, v42, v44
    v_exp_f32 v45, v53
    v_mfma_f32_32x32x16_bf16 v[64:79], v[244:247], v[84:87], v[64:79]
    v_fma_f32 v55, v55, s28, -v14
    v_add_f32 v42, v42, v45
    v_cvt_pk_bf16_f32 v32, v44, v45
    v_accvgpr_write_b32 a82, v32
    s_waitcnt lgkmcnt(0)
    v_exp_f32 v46, v54
    s_waitcnt vmcnt(5)
    v_subrev_u32 v15, 49152, v7
    ds_read_b128 v[128:131], v15 offset:16384
    v_mfma_f32_32x32x16_bf16 v[64:79], a[232:235], v[88:91], v[64:79]
    v_fma_f32 v56, v56, s28, -v14
    v_add_f32 v42, v42, v46
    v_exp_f32 v47, v55
    v_fma_f32 v57, v57, s28, -v14
    v_add_f32 v42, v42, v47
    v_cvt_pk_bf16_f32 v33, v46, v47
    v_accvgpr_write_b32 a83, v33
    v_exp_f32 v44, v56
    ds_read_b128 v[136:139], v15 offset:16896
    v_mfma_f32_32x32x16_bf16 v[64:79], a[236:239], v[92:95], v[64:79]
    s_add_u32 m0, s27, 36736
    s_add_u32 s29, s24, 32768
    buffer_load_dwordx4 v4, s[12:15], s29 offen offset:128 nt lds
    v_fma_f32 v58, v58, s28, -v14
    v_add_f32 v42, v42, v44
    v_exp_f32 v45, v57
    v_mfma_f32_32x32x16_bf16 v[64:79], v[232:235], v[96:99], v[64:79]
    v_fma_f32 v59, v59, s28, -v14
    v_add_f32 v42, v42, v45
    v_cvt_pk_bf16_f32 v32, v44, v45
    v_accvgpr_write_b32 a84, v32
    v_exp_f32 v46, v58
    v_xor_b32 v15, 32, v15
    ds_read_b128 v[132:135], v15 offset:16384
    ds_read_b128 v[140:143], v15 offset:16896
    v_mfma_f32_32x32x16_bf16 v[64:79], v[236:239], v[100:103], v[64:79]
    v_fma_f32 v60, v60, s28, -v14
    v_add_f32 v42, v42, v46
    v_exp_f32 v47, v59
    v_fma_f32 v61, v61, s28, -v14
    v_add_f32 v42, v42, v47
    v_cvt_pk_bf16_f32 v33, v46, v47
    v_accvgpr_write_b32 a85, v33
    v_exp_f32 v44, v60
    v_mfma_f32_32x32x16_bf16 v[64:79], v[248:251], v[104:107], v[64:79]
    v_fma_f32 v62, v62, s28, -v14
    v_add_f32 v42, v42, v44
    v_exp_f32 v45, v61
    v_fma_f32 v63, v63, s28, -v14
    v_add_f32 v42, v42, v45
    v_cvt_pk_bf16_f32 v32, v44, v45
    v_accvgpr_write_b32 a86, v32
    v_exp_f32 v46, v62
    v_mfma_f32_32x32x16_bf16 v[64:79], v[252:255], v[108:111], v[64:79]
    v_add_f32 v42, v42, v46
    v_exp_f32 v47, v63
    s_nop 0
    v_add_f32 v42, v42, v47
    v_cvt_pk_bf16_f32 v33, v46, v47
    v_accvgpr_write_b32 a87, v33
    s_waitcnt lgkmcnt(0)
    v_mfma_f32_32x32x16_bf16 v[48:63], v[216:219], a[32:35], 0
    s_add_u32 m0, s27, 40704
    s_add_u32 s29, s24, 32768
    buffer_load_dwordx4 v4, s[12:15], s29 offen offset:256 nt lds
    v_mfma_f32_32x32x16_bf16 v[48:63], v[220:223], a[36:39], v[48:63]
    s_add_u32 m0, s27, 44672
    s_add_u32 s29, s24, 32768
    buffer_load_dwordx4 v4, s[12:15], s29 offen offset:384 nt lds
    v_mfma_f32_32x32x16_bf16 v[48:63], a[240:243], a[40:43], v[48:63]
    v_max3_f32 v0, v64, v65, v66
    v_max3_f32 v0, v0, v67, v68
    v_max3_f32 v0, v0, v69, v70
    v_max3_f32 v0, v0, v71, v72
    v_max3_f32 v0, v0, v73, v74
    v_max3_f32 v0, v0, v75, v76
    v_max3_f32 v0, v0, v77, v78
    v_max_f32 v0, v0, v79
    v_mfma_f32_32x32x16_bf16 v[48:63], a[244:247], a[44:47], v[48:63]
    v_mov_b32 v12, v0
    s_nop 1
    v_permlane32_swap_b32 v0, v12
    v_max_f32 v0, v0, v12
    v_mul_f32 v0, s28, v0
    v_add_f32 v12, 0x40e00000, v0
    v_mfma_f32_32x32x16_bf16 v[48:63], v[224:227], a[48:51], v[48:63]
    v_fma_f32 v64, v64, s28, -v12
    v_fma_f32 v65, v65, s28, -v12
    v_exp_f32 v44, v64
    v_fma_f32 v66, v66, s28, -v12
    v_exp_f32 v45, v65
    v_mfma_f32_32x32x16_bf16 v[48:63], v[228:231], a[52:55], v[48:63]
    v_fma_f32 v67, v67, s28, -v12
    v_add_f32 v40, v44, v45
    v_cvt_pk_bf16_f32 v144, v44, v45
    v_exp_f32 v46, v66
    s_waitcnt vmcnt(4)
    s_barrier
    v_mfma_f32_32x32x16_bf16 v[48:63], a[248:251], a[56:59], v[48:63]
    ds_read_b128 v[216:219], v1 offset:16384
    v_fma_f32 v68, v68, s28, -v12
    v_add_f32 v40, v40, v46
    v_exp_f32 v47, v67
    v_mfma_f32_32x32x16_bf16 v[48:63], a[252:255], a[60:63], v[48:63]
    ds_read_b128 v[220:223], v2 offset:16384
    v_fma_f32 v69, v69, s28, -v12
    v_add_f32 v40, v40, v47
    v_cvt_pk_bf16_f32 v145, v46, v47
    v_exp_f32 v44, v68
    v_mfma_f32_32x32x16_bf16 v[48:63], v[240:243], v[112:115], v[48:63]
    ds_read_b128 a[240:243], v1 offset:16896
    v_fma_f32 v70, v70, s28, -v12
    v_add_f32 v40, v40, v44
    v_exp_f32 v45, v69
    v_mfma_f32_32x32x16_bf16 v[48:63], v[244:247], v[116:119], v[48:63]
    ds_read_b128 a[244:247], v2 offset:16896
    v_fma_f32 v71, v71, s28, -v12
    v_add_f32 v40, v40, v45
    v_cvt_pk_bf16_f32 v146, v44, v45
    v_exp_f32 v46, v70
    v_mfma_f32_32x32x16_bf16 v[48:63], a[232:235], v[120:123], v[48:63]
    ds_read_b128 v[224:227], v1 offset:20480
    v_fma_f32 v72, v72, s28, -v12
    v_add_f32 v40, v40, v46
    v_exp_f32 v47, v71
    v_mfma_f32_32x32x16_bf16 v[48:63], a[236:239], v[124:127], v[48:63]
    ds_read_b128 v[228:231], v2 offset:20480
    v_fma_f32 v73, v73, s28, -v12
    v_add_f32 v40, v40, v47
    v_cvt_pk_bf16_f32 v147, v46, v47
    v_exp_f32 v44, v72
    v_fma_f32 v74, v74, s28, -v12
    v_add_f32 v40, v40, v44
    v_exp_f32 v45, v73
    v_mfma_f32_32x32x16_bf16 v[48:63], v[232:235], v[128:131], v[48:63]
    ds_read_b128 a[248:251], v1 offset:20992
    v_fma_f32 v75, v75, s28, -v12
    v_add_f32 v40, v40, v45
    v_cvt_pk_bf16_f32 v148, v44, v45
    v_exp_f32 v46, v74
    v_fma_f32 v76, v76, s28, -v12
    v_add_f32 v40, v40, v46
    v_exp_f32 v47, v75
    v_mfma_f32_32x32x16_bf16 v[48:63], v[236:239], v[132:135], v[48:63]
    ds_read_b128 a[252:255], v2 offset:20992
    v_fma_f32 v77, v77, s28, -v12
    v_add_f32 v40, v40, v47
    v_cvt_pk_bf16_f32 v149, v46, v47
    v_exp_f32 v44, v76
    v_fma_f32 v78, v78, s28, -v12
    v_add_f32 v40, v40, v44
    v_exp_f32 v45, v77
    v_mfma_f32_32x32x16_bf16 v[48:63], v[248:251], v[136:139], v[48:63]
    ds_read_b128 v[240:243], v1 offset:24576
    v_fma_f32 v79, v79, s28, -v12
    v_add_f32 v40, v40, v45
    v_cvt_pk_bf16_f32 v150, v44, v45
    v_exp_f32 v46, v78
    s_nop 0
    v_add_f32 v40, v40, v46
    v_exp_f32 v47, v79
    v_mfma_f32_32x32x16_bf16 v[48:63], v[252:255], v[140:143], v[48:63]
    ds_read_b128 v[24:27], v7 offset:0
    ds_read_b128 v[244:247], v2 offset:24576
    v_add_f32 v40, v40, v47
    v_cvt_pk_bf16_f32 v151, v46, v47
    s_waitcnt vmcnt(0)
    s_barrier
    s_waitcnt lgkmcnt(9)
    v_mfma_f32_32x32x16_bf16 v[64:79], v[216:219], a[64:67], 0
    ds_read_b128 v[28:31], v8 offset:0
    ds_read_b128 a[232:235], v1 offset:25088
    s_add_u32 m0, s27, 49152
    s_add_u32 s29, s24, 49152
    buffer_load_dwordx4 v4, s[12:15], s29 offen offset:0 nt lds
    v_mfma_f32_32x32x16_bf16 v[64:79], v[220:223], a[68:71], v[64:79]
    ds_read_b128 a[208:211], v7 offset:512
    ds_read_b128 a[236:239], v2 offset:25088
    s_add_u32 m0, s27, 53120
    s_add_u32 s29, s24, 49152
    buffer_load_dwordx4 v4, s[12:15], s29 offen offset:128 nt lds
    s_waitcnt lgkmcnt(11)
    v_mfma_f32_32x32x16_bf16 v[64:79], a[240:243], a[72:75], v[64:79]
    ds_read_b128 a[212:215], v8 offset:512
    ds_read_b128 v[232:235], v1 offset:28672
    v_max3_f32 v0, v48, v49, v50
    v_max3_f32 v0, v0, v51, v52
    v_max3_f32 v0, v0, v53, v54
    v_max3_f32 v0, v0, v55, v56
    v_mfma_f32_32x32x16_bf16 v[64:79], a[244:247], a[76:79], v[64:79]
    ds_read_b128 v[208:211], v7 offset:16384
    ds_read_b128 v[236:239], v2 offset:28672
    v_max3_f32 v0, v0, v57, v58
    v_max3_f32 v0, v0, v59, v60
    v_max3_f32 v0, v0, v61, v62
    v_max_f32 v0, v0, v63
    s_waitcnt lgkmcnt(7)
    v_mfma_f32_32x32x16_bf16 v[64:79], v[224:227], v[24:27], v[64:79]
    ds_read_b128 v[212:215], v8 offset:16384
    ds_read_b128 v[248:251], v1 offset:29184
    v_mov_b32 v13, v0
    s_nop 1
    v_permlane32_swap_b32 v0, v13
    v_max_f32 v0, v0, v13
    v_mul_f32 v0, s28, v0
    v_add_f32 v13, 0x40e00000, v0
    v_mfma_f32_32x32x16_bf16 v[64:79], v[228:231], v[28:31], v[64:79]
    ds_read_b128 a[216:219], v7 offset:16896
    ds_read_b128 v[252:255], v2 offset:29184
    v_fma_f32 v48, v48, s28, -v13
    v_fma_f32 v49, v49, s28, -v13
    s_waitcnt lgkmcnt(7)
    v_exp_f32 v44, v48
    v_mfma_f32_32x32x16_bf16 v[64:79], a[248:251], a[208:211], v[64:79]
    ds_read_b128 a[220:223], v8 offset:16896
    v_fma_f32 v50, v50, s28, -v13
    v_exp_f32 v45, v49
    v_fma_f32 v51, v51, s28, -v13
    v_add_f32 v41, v44, v45
    v_cvt_pk_bf16_f32 v32, v44, v45
    v_accvgpr_write_b32 a88, v32
    v_exp_f32 v46, v50
    v_mfma_f32_32x32x16_bf16 v[64:79], a[252:255], a[212:215], v[64:79]
    ds_read_b128 v[16:19], v7 offset:32768
    v_fma_f32 v52, v52, s28, -v13
    v_add_f32 v41, v41, v46
    s_waitcnt lgkmcnt(5)
    v_exp_f32 v47, v51
    v_mfma_f32_32x32x16_bf16 v[64:79], v[240:243], v[208:211], v[64:79]
    ds_read_b128 v[20:23], v8 offset:32768
    v_fma_f32 v53, v53, s28, -v13
    v_add_f32 v41, v41, v47
    v_cvt_pk_bf16_f32 v33, v46, v47
    v_accvgpr_write_b32 a89, v33
    v_exp_f32 v44, v52
    v_mfma_f32_32x32x16_bf16 v[64:79], v[244:247], v[212:215], v[64:79]
    ds_read_b128 v[24:27], v7 offset:33280
    v_fma_f32 v54, v54, s28, -v13
    v_add_f32 v41, v41, v44
    s_waitcnt lgkmcnt(3)
    v_exp_f32 v45, v53
    v_mfma_f32_32x32x16_bf16 v[64:79], a[232:235], a[216:219], v[64:79]
    ds_read_b128 v[28:31], v8 offset:33280
    v_fma_f32 v55, v55, s28, -v13
    v_add_f32 v41, v41, v45
    v_cvt_pk_bf16_f32 v32, v44, v45
    v_accvgpr_write_b32 a90, v32
    v_exp_f32 v46, v54
    v_mfma_f32_32x32x16_bf16 v[64:79], a[236:239], a[220:223], v[64:79]
    v_fma_f32 v56, v56, s28, -v13
    v_add_f32 v41, v41, v46
    v_exp_f32 v47, v55
    v_fma_f32 v57, v57, s28, -v13
    v_add_f32 v41, v41, v47
    v_cvt_pk_bf16_f32 v33, v46, v47
    v_accvgpr_write_b32 a91, v33
    s_waitcnt lgkmcnt(2)
    v_exp_f32 v44, v56
    v_mfma_f32_32x32x16_bf16 v[64:79], v[232:235], v[16:19], v[64:79]
    v_fma_f32 v58, v58, s28, -v13
    v_add_f32 v41, v41, v44
    v_exp_f32 v45, v57
    v_fma_f32 v59, v59, s28, -v13
    v_add_f32 v41, v41, v45
    v_cvt_pk_bf16_f32 v32, v44, v45
    v_accvgpr_write_b32 a92, v32
    v_exp_f32 v46, v58
    v_mfma_f32_32x32x16_bf16 v[64:79], v[236:239], v[20:23], v[64:79]
    v_fma_f32 v60, v60, s28, -v13
    v_add_f32 v41, v41, v46
    v_exp_f32 v47, v59
    v_fma_f32 v61, v61, s28, -v13
    v_add_f32 v41, v41, v47
    v_cvt_pk_bf16_f32 v33, v46, v47
    v_accvgpr_write_b32 a93, v33
    s_waitcnt lgkmcnt(0)
    v_exp_f32 v44, v60
    v_mfma_f32_32x32x16_bf16 v[64:79], v[248:251], v[24:27], v[64:79]
    v_fma_f32 v62, v62, s28, -v13
    v_add_f32 v41, v41, v44
    v_exp_f32 v45, v61
    v_fma_f32 v63, v63, s28, -v13
    v_add_f32 v41, v41, v45
    v_cvt_pk_bf16_f32 v32, v44, v45
    v_accvgpr_write_b32 a94, v32
    v_exp_f32 v46, v62
    v_mfma_f32_32x32x16_bf16 v[64:79], v[252:255], v[28:31], v[64:79]
    v_add_f32 v41, v41, v46
    v_exp_f32 v47, v63
    s_nop 0
    v_add_f32 v41, v41, v47
    v_cvt_pk_bf16_f32 v33, v46, v47
    v_accvgpr_write_b32 a95, v33
    v_mfma_f32_32x32x16_bf16 v[48:63], v[216:219], a[0:3], 0
    s_add_u32 m0, s27, 57088
    s_add_u32 s29, s24, 49152
    buffer_load_dwordx4 v4, s[12:15], s29 offen offset:256 nt lds
    v_mfma_f32_32x32x16_bf16 v[48:63], v[220:223], a[4:7], v[48:63]
    s_add_u32 m0, s27, 61056
    s_add_u32 s29, s24, 49152
    buffer_load_dwordx4 v4, s[12:15], s29 offen offset:384 nt lds
    v_mfma_f32_32x32x16_bf16 v[48:63], a[240:243], a[8:11], v[48:63]
    v_fma_f32 v64, v64, s28, -v14
    v_fma_f32 v65, v65, s28, -v14
    v_exp_f32 v44, v64
    v_fma_f32 v66, v66, s28, -v14
    v_exp_f32 v45, v65
    v_mfma_f32_32x32x16_bf16 v[48:63], a[244:247], a[12:15], v[48:63]
    v_fma_f32 v67, v67, s28, -v14
    v_add_f32 v43, v44, v45
    v_cvt_pk_bf16_f32 v32, v44, v45
    v_accvgpr_write_b32 a96, v32
    v_exp_f32 v46, v66
    v_mfma_f32_32x32x16_bf16 v[48:63], v[224:227], a[16:19], v[48:63]
    v_fma_f32 v68, v68, s28, -v14
    v_add_f32 v43, v43, v46
    v_exp_f32 v47, v67
    ds_write_b128 v9, a[112:115]
    v_mfma_f32_32x32x16_bf16 v[48:63], v[228:231], a[20:23], v[48:63]
    v_fma_f32 v69, v69, s28, -v14
    v_add_f32 v43, v43, v47
    v_cvt_pk_bf16_f32 v33, v46, v47
    v_accvgpr_write_b32 a97, v33
    v_exp_f32 v44, v68
    v_xor_b32 v0, 32, v9
    ds_write_b128 v0, a[116:119]
    v_mfma_f32_32x32x16_bf16 v[48:63], a[248:251], a[24:27], v[48:63]
    s_add_u32 m0, s27, 65536
    s_add_u32 s29, s24, 65536
    buffer_load_dwordx4 v4, s[12:15], s29 offen offset:0 nt lds
    v_fma_f32 v70, v70, s28, -v14
    v_add_f32 v43, v43, v44
    v_exp_f32 v45, v69
    v_mfma_f32_32x32x16_bf16 v[48:63], a[252:255], a[28:31], v[48:63]
    v_fma_f32 v71, v71, s28, -v14
    v_add_f32 v43, v43, v45
    v_cvt_pk_bf16_f32 v32, v44, v45
    v_accvgpr_write_b32 a98, v32
    v_exp_f32 v46, v70
    v_xor_b32 v0, 64, v9
    ds_write_b128 v0, a[128:131]
    v_mfma_f32_32x32x16_bf16 v[48:63], v[240:243], v[80:83], v[48:63]
    v_fma_f32 v72, v72, s28, -v14
    v_add_f32 v43, v43, v46
    v_exp_f32 v47, v71
    v_xor_b32 v0, 96, v9
    ds_write_b128 v0, a[132:135]
    v_mfma_f32_32x32x16_bf16 v[48:63], v[244:247], v[84:87], v[48:63]
    v_fma_f32 v73, v73, s28, -v14
    v_add_f32 v43, v43, v47
    v_cvt_pk_bf16_f32 v33, v46, v47
    v_accvgpr_write_b32 a99, v33
    v_exp_f32 v44, v72
    ds_read_b128 a[112:115], v10 offset:0
    v_mfma_f32_32x32x16_bf16 v[48:63], a[232:235], v[88:91], v[48:63]
    v_fma_f32 v74, v74, s28, -v14
    v_add_f32 v43, v43, v44
    v_exp_f32 v45, v73
    v_fma_f32 v75, v75, s28, -v14
    v_add_f32 v43, v43, v45
    v_cvt_pk_bf16_f32 v32, v44, v45
    v_accvgpr_write_b32 a100, v32
    v_exp_f32 v46, v74
    v_mfma_f32_32x32x16_bf16 v[48:63], a[236:239], v[92:95], v[48:63]
    s_add_u32 m0, s27, 69504
    s_add_u32 s29, s24, 65536
    buffer_load_dwordx4 v4, s[12:15], s29 offen offset:128 nt lds
    v_fma_f32 v76, v76, s28, -v14
    v_add_f32 v43, v43, v46
    v_exp_f32 v47, v75
    v_mfma_f32_32x32x16_bf16 v[48:63], v[232:235], v[96:99], v[48:63]
    v_fma_f32 v77, v77, s28, -v14
    v_add_f32 v43, v43, v47
    v_cvt_pk_bf16_f32 v33, v46, v47
    v_accvgpr_write_b32 a101, v33
    v_exp_f32 v44, v76
    ds_read_b128 a[116:119], v10 offset:1024
    v_mfma_f32_32x32x16_bf16 v[48:63], v[236:239], v[100:103], v[48:63]
    v_fma_f32 v78, v78, s28, -v14
    v_add_f32 v43, v43, v44
    v_exp_f32 v45, v77
    v_fma_f32 v79, v79, s28, -v14
    v_add_f32 v43, v43, v45
    v_cvt_pk_bf16_f32 v32, v44, v45
    v_accvgpr_write_b32 a102, v32
    v_exp_f32 v46, v78
    v_mfma_f32_32x32x16_bf16 v[48:63], v[248:251], v[104:107], v[48:63]
    v_add_f32 v43, v43, v46
    v_exp_f32 v47, v79
    s_nop 0
    v_add_f32 v43, v43, v47
    v_cvt_pk_bf16_f32 v33, v46, v47
    v_accvgpr_write_b32 a103, v33
    v_mfma_f32_32x32x16_bf16 v[48:63], v[252:255], v[108:111], v[48:63]
    v_cmp_ngt_f32 vcc, 2.0, v43
    s_cbranch_vccnz L_rare3
L_back3:
    v_add_f32 v42, v42, v43
    ds_read_b128 a[128:131], v10 offset:2048
    v_mfma_f32_32x32x16_bf16 v[64:79], v[216:219], a[32:35], 0
    ds_read_b128 v[216:219], v1 offset:32768
    s_add_u32 m0, s27, 73472
    s_add_u32 s29, s24, 65536
    buffer_load_dwordx4 v4, s[12:15], s29 offen offset:256 nt lds
    v_mfma_f32_32x32x16_bf16 v[64:79], v[220:223], a[36:39], v[64:79]
    ds_read_b128 v[220:223], v2 offset:32768
    s_add_u32 m0, s27, 77440
    s_add_u32 s29, s24, 65536
    buffer_load_dwordx4 v4, s[12:15], s29 offen offset:384 nt lds
    v_mfma_f32_32x32x16_bf16 v[64:79], a[240:243], a[40:43], v[64:79]
    ds_read_b128 a[240:243], v1 offset:33280
    v_fma_f32 v48, v48, s28, -v12
    v_fma_f32 v49, v49, s28, -v12
    v_exp_f32 v44, v48
    v_fma_f32 v50, v50, s28, -v12
    v_exp_f32 v45, v49
    v_mfma_f32_32x32x16_bf16 v[64:79], a[244:247], a[44:47], v[64:79]
    ds_read_b128 a[244:247], v2 offset:33280
    v_fma_f32 v51, v51, s28, -v12
    v_add_f32 v43, v44, v45
    v_cvt_pk_bf16_f32 v152, v44, v45
    v_exp_f32 v46, v50
    ds_read_b128 a[132:135], v10 offset:3072
    v_mfma_f32_32x32x16_bf16 v[64:79], v[224:227], a[48:51], v[64:79]
    ds_read_b128 v[224:227], v1 offset:36864
    v_fma_f32 v52, v52, s28, -v12
    v_add_f32 v43, v43, v46
    v_exp_f32 v47, v51
    v_mfma_f32_32x32x16_bf16 v[64:79], v[228:231], a[52:55], v[64:79]
    ds_read_b128 v[228:231], v2 offset:36864
    v_fma_f32 v53, v53, s28, -v12
    v_add_f32 v43, v43, v47
    v_cvt_pk_bf16_f32 v153, v46, v47
    v_exp_f32 v44, v52
    v_mfma_f32_32x32x16_bf16 v[64:79], a[248:251], a[56:59], v[64:79]
    ds_read_b128 a[248:251], v1 offset:37376
    v_fma_f32 v54, v54, s28, -v12
    v_add_f32 v43, v43, v44
    v_exp_f32 v45, v53
    s_waitcnt lgkmcnt(10)
    s_add_u32 s30, s32, 16640
    buffer_store_dwordx4 a[112:115], v11, s[20:23], s30 offen sc1
    v_mfma_f32_32x32x16_bf16 v[64:79], a[252:255], a[60:63], v[64:79]
    ds_read_b128 a[252:255], v2 offset:37376
    v_fma_f32 v55, v55, s28, -v12
    v_add_f32 v43, v43, v45
    v_cvt_pk_bf16_f32 v154, v44, v45
    v_exp_f32 v46, v54
    v_mfma_f32_32x32x16_bf16 v[64:79], v[240:243], v[112:115], v[64:79]
    ds_read_b128 v[240:243], v1 offset:40960
    v_fma_f32 v56, v56, s28, -v12
    v_add_f32 v43, v43, v46
    v_exp_f32 v47, v55
    s_waitcnt lgkmcnt(11)
    s_add_u32 s30, s32, 20736
    buffer_store_dwordx4 a[116:119], v11, s[20:23], s30 offen sc1
    v_mfma_f32_32x32x16_bf16 v[64:79], v[244:247], v[116:119], v[64:79]
    ds_read_b128 v[244:247], v2 offset:40960
    v_fma_f32 v57, v57, s28, -v12
    v_add_f32 v43, v43, v47
    v_cvt_pk_bf16_f32 v155, v46, v47
    v_exp_f32 v44, v56
    v_mfma_f32_32x32x16_bf16 v[64:79], a[232:235], v[120:123], v[64:79]
    ds_read_b128 a[232:235], v1 offset:41472
    v_fma_f32 v58, v58, s28, -v12
    v_add_f32 v43, v43, v44
    v_exp_f32 v45, v57
    s_waitcnt lgkmcnt(12)
    s_add_u32 s30, s32, 24832
    buffer_store_dwordx4 a[128:131], v11, s[20:23], s30 offen sc1
    v_mfma_f32_32x32x16_bf16 v[64:79], a[236:239], v[124:127], v[64:79]
    ds_read_b128 a[236:239], v2 offset:41472
    v_fma_f32 v59, v59, s28, -v12
    v_add_f32 v43, v43, v45
    v_cvt_pk_bf16_f32 v156, v44, v45
    v_exp_f32 v46, v58
    v_mfma_f32_32x32x16_bf16 v[64:79], v[232:235], v[128:131], v[64:79]
    ds_read_b128 v[232:235], v1 offset:45056
    v_fma_f32 v60, v60, s28, -v12
    v_add_f32 v43, v43, v46
    v_exp_f32 v47, v59
    v_fma_f32 v61, v61, s28, -v12
    v_add_f32 v43, v43, v47
    v_cvt_pk_bf16_f32 v157, v46, v47
    v_exp_f32 v44, v60
    v_mfma_f32_32x32x16_bf16 v[64:79], v[236:239], v[132:135], v[64:79]
    ds_read_b128 v[236:239], v2 offset:45056
    v_fma_f32 v62, v62, s28, -v12
    v_add_f32 v43, v43, v44
    v_exp_f32 v45, v61
    v_fma_f32 v63, v63, s28, -v12
    v_add_f32 v43, v43, v45
    v_cvt_pk_bf16_f32 v158, v44, v45
    v_exp_f32 v46, v62
    v_mfma_f32_32x32x16_bf16 v[64:79], v[248:251], v[136:139], v[64:79]
    ds_read_b128 v[248:251], v1 offset:45568
    v_add_f32 v43, v43, v46
    v_exp_f32 v47, v63
    s_nop 0
    v_add_f32 v43, v43, v47
    v_cvt_pk_bf16_f32 v159, v46, v47
    v_mfma_f32_32x32x16_bf16 v[64:79], v[252:255], v[140:143], v[64:79]
    ds_read_b128 a[208:211], v7 offset:0
    ds_read_b128 v[252:255], v2 offset:45568
    v_cmp_ngt_f32 vcc, 2.0, v43
    s_cbranch_vccnz L_rare4
L_back4:
    v_add_f32 v40, v40, v43
    s_waitcnt vmcnt(7)
    s_barrier
    s_waitcnt lgkmcnt(15)
    v_mfma_f32_32x32x16_bf16 v[48:63], v[216:219], a[64:67], 0
    ds_read_b128 a[212:215], v8 offset:0
    s_add_u32 m0, s27, 81920
    s_add_u32 s29, s24, 81920
    buffer_load_dwordx4 v4, s[12:15], s29 offen offset:0 nt lds
    v_mfma_f32_32x32x16_bf16 v[48:63], v[220:223], a[68:71], v[48:63]
    ds_read_b128 v[208:211], v7 offset:512
    s_add_u32 m0, s27, 85888
    s_add_u32 s29, s24, 81920
    buffer_load_dwordx4 v4, s[12:15], s29 offen offset:128 nt lds
    s_waitcnt lgkmcnt(15)
    v_mfma_f32_32x32x16_bf16 v[48:63], a[240:243], a[72:75], v[48:63]
    ds_read_b128 v[212:215], v8 offset:512
    v_fma_f32 v64, v64, s28, -v13
    v_fma_f32 v65, v65, s28, -v13
    v_exp_f32 v44, v64
    v_fma_f32 v66, v66, s28, -v13
    v_exp_f32 v45, v65
    v_mfma_f32_32x32x16_bf16 v[48:63], a[244:247], a[76:79], v[48:63]
    ds_read_b128 a[216:219], v7 offset:16384
    v_fma_f32 v67, v67, s28, -v13
    v_add_f32 v43, v44, v45
    v_cvt_pk_bf16_f32 v32, v44, v45
    v_accvgpr_write_b32 a104, v32
    s_waitcnt lgkmcnt(3)
    v_exp_f32 v46, v66
    v_mfma_f32_32x32x16_bf16 v[48:63], v[224:227], a[208:211], v[48:63]
    ds_read_b128 a[220:223], v8 offset:16384
    v_fma_f32 v68, v68, s28, -v13
    v_add_f32 v43, v43, v46
    v_exp_f32 v47, v67
    v_fma_f32 v69, v69, s28, -v13
    v_add_f32 v43, v43, v47
    v_cvt_pk_bf16_f32 v33, v46, v47
    v_accvgpr_write_b32 a105, v33
    v_exp_f32 v44, v68
    v_mfma_f32_32x32x16_bf16 v[48:63], v[228:231], a[212:215], v[48:63]
    ds_read_b128 v[16:19], v7 offset:16896
    v_fma_f32 v70, v70, s28, -v13
    v_add_f32 v43, v43, v44
    s_waitcnt lgkmcnt(3)
    v_exp_f32 v45, v69
    v_mfma_f32_32x32x16_bf16 v[48:63], a[248:251], v[208:211], v[48:63]
    ds_read_b128 v[20:23], v8 offset:16896
    v_fma_f32 v71, v71, s28, -v13
    v_add_f32 v43, v43, v45
    v_cvt_pk_bf16_f32 v32, v44, v45
    v_accvgpr_write_b32 a106, v32
    v_exp_f32 v46, v70
    v_mfma_f32_32x32x16_bf16 v[48:63], a[252:255], v[212:215], v[48:63]
    ds_read_b128 v[24:27], v7 offset:32768
    v_fma_f32 v72, v72, s28, -v13
    v_add_f32 v43, v43, v46
    s_waitcnt lgkmcnt(3)
    v_exp_f32 v47, v71
    v_mfma_f32_32x32x16_bf16 v[48:63], v[240:243], a[216:219], v[48:63]
    ds_read_b128 v[28:31], v8 offset:32768
    v_fma_f32 v73, v73, s28, -v13
    v_add_f32 v43, v43, v47
    v_cvt_pk_bf16_f32 v33, v46, v47
    v_accvgpr_write_b32 a107, v33
    v_exp_f32 v44, v72
    v_mfma_f32_32x32x16_bf16 v[48:63], v[244:247], a[220:223], v[48:63]
    ds_read_b128 a[208:211], v7 offset:33280
    v_fma_f32 v74, v74, s28, -v13
    v_add_f32 v43, v43, v44
    s_waitcnt lgkmcnt(3)
    v_exp_f32 v45, v73
    v_mfma_f32_32x32x16_bf16 v[48:63], a[232:235], v[16:19], v[48:63]
    ds_read_b128 a[212:215], v8 offset:33280
    v_fma_f32 v75, v75, s28, -v13
    v_add_f32 v43, v43, v45
    v_cvt_pk_bf16_f32 v32, v44, v45
    v_accvgpr_write_b32 a108, v32
    v_exp_f32 v46, v74
    v_mfma_f32_32x32x16_bf16 v[48:63], a[236:239], v[20:23], v[48:63]
    v_fma_f32 v76, v76, s28, -v13
    v_add_f32 v43, v43, v46
    v_exp_f32 v47, v75
    s_add_u32 s30, s32, 28928
    buffer_store_dwordx4 a[132:135], v11, s[20:23], s30 offen sc1
    s_waitcnt lgkmcnt(2)
    v_mfma_f32_32x32x16_bf16 v[48:63], v[232:235], v[24:27], v[48:63]
    v_fma_f32 v77, v77, s28, -v13
    v_add_f32 v43, v43, v47
    v_cvt_pk_bf16_f32 v33, v46, v47
    v_accvgpr_write_b32 a109, v33
    v_exp_f32 v44, v76
    v_fma_f32 v78, v78, s28, -v13
    v_add_f32 v43, v43, v44
    v_exp_f32 v45, v77
    v_mfma_f32_32x32x16_bf16 v[48:63], v[236:239], v[28:31], v[48:63]
    v_fma_f32 v79, v79, s28, -v13
    v_add_f32 v43, v43, v45
    v_cvt_pk_bf16_f32 v32, v44, v45
    v_accvgpr_write_b32 a110, v32
    s_waitcnt lgkmcnt(0)
    v_exp_f32 v46, v78
    v_mfma_f32_32x32x16_bf16 v[48:63], v[248:251], a[208:211], v[48:63]
    v_add_f32 v43, v43, v46
    v_exp_f32 v47, v79
    s_nop 0
    v_add_f32 v43, v43, v47
    v_cvt_pk_bf16_f32 v33, v46, v47
    v_accvgpr_write_b32 a111, v33
    v_mfma_f32_32x32x16_bf16 v[48:63], v[252:255], a[212:215], v[48:63]
    v_cmp_ngt_f32 vcc, 2.0, v43
    s_cbranch_vccnz L_rare5
L_back5:
    v_add_f32 v41, v41, v43
    v_mfma_f32_32x32x16_bf16 v[64:79], v[216:219], a[0:3], 0
    s_add_u32 m0, s27, 89856
    s_add_u32 s29, s24, 81920
    buffer_load_dwordx4 v4, s[12:15], s29 offen offset:256 nt lds
    v_mfma_f32_32x32x16_bf16 v[64:79], v[220:223], a[4:7], v[64:79]
    s_add_u32 m0, s27, 93824
    s_add_u32 s29, s24, 81920
    buffer_load_dwordx4 v4, s[12:15], s29 offen offset:384 nt lds
    v_mfma_f32_32x32x16_bf16 v[64:79], a[240:243], a[8:11], v[64:79]
    v_fma_f32 v48, v48, s28, -v14
    v_fma_f32 v49, v49, s28, -v14
    v_exp_f32 v44, v48
    v_fma_f32 v50, v50, s28, -v14
    v_exp_f32 v45, v49
    v_mfma_f32_32x32x16_bf16 v[64:79], a[244:247], a[12:15], v[64:79]
    v_fma_f32 v51, v51, s28, -v14
    v_add_f32 v43, v44, v45
    v_cvt_pk_bf16_f32 v32, v44, v45
    v_accvgpr_write_b32 a112, v32
    v_exp_f32 v46, v50
    v_mfma_f32_32x32x16_bf16 v[64:79], v[224:227], a[16:19], v[64:79]
    v_fma_f32 v52, v52, s28, -v14
    v_add_f32 v43, v43, v46
    v_exp_f32 v47, v51
    v_mfma_f32_32x32x16_bf16 v[64:79], v[228:231], a[20:23], v[64:79]
    v_fma_f32 v53, v53, s28, -v14
    v_add_f32 v43, v43, v47
    v_cvt_pk_bf16_f32 v33, v46, v47
    v_accvgpr_write_b32 a113, v33
    v_exp_f32 v44, v52
    v_mfma_f32_32x32x16_bf16 v[64:79], a[248:251], a[24:27], v[64:79]
    s_add_u32 m0, s27, 0
    s_add_u32 s29, s24, 98304
    buffer_load_dwordx4 v4, s[12:15], s29 offen offset:0 nt lds
    v_fma_f32 v54, v54, s28, -v14
    v_add_f32 v43, v43, v44
    v_exp_f32 v45, v53
    v_mfma_f32_32x32x16_bf16 v[64:79], a[252:255], a[28:31], v[64:79]
    v_fma_f32 v55, v55, s28, -v14
    v_add_f32 v43, v43, v45
    v_cvt_pk_bf16_f32 v32, v44, v45
    v_accvgpr_write_b32 a114, v32
    v_exp_f32 v46, v54
    v_mfma_f32_32x32x16_bf16 v[64:79], v[240:243], v[80:83], v[64:79]
    v_fma_f32 v56, v56, s28, -v14
    v_add_f32 v43, v43, v46
    v_exp_f32 v47, v55
    v_mfma_f32_32x32x16_bf16 v[64:79], v[244:247], v[84:87], v[64:79]
    v_fma_f32 v57, v57, s28, -v14
    v_add_f32 v43, v43, v47
    v_cvt_pk_bf16_f32 v33, v46, v47
    v_accvgpr_write_b32 a115, v33
    v_exp_f32 v44, v56
    v_mfma_f32_32x32x16_bf16 v[64:79], a[232:235], v[88:91], v[64:79]
    v_fma_f32 v58, v58, s28, -v14
    v_add_f32 v43, v43, v44
    v_exp_f32 v45, v57
    v_fma_f32 v59, v59, s28, -v14
    v_add_f32 v43, v43, v45
    v_cvt_pk_bf16_f32 v32, v44, v45
    v_accvgpr_write_b32 a116, v32
    v_exp_f32 v46, v58
    v_mfma_f32_32x32x16_bf16 v[64:79], a[236:239], v[92:95], v[64:79]
    s_add_u32 m0, s27, 3968
    s_add_u32 s29, s24, 98304
    buffer_load_dwordx4 v4, s[12:15], s29 offen offset:128 nt lds
    v_fma_f32 v60, v60, s28, -v14
    v_add_f32 v43, v43, v46
    v_exp_f32 v47, v59
    v_mfma_f32_32x32x16_bf16 v[64:79], v[232:235], v[96:99], v[64:79]
    v_fma_f32 v61, v61, s28, -v14
    v_add_f32 v43, v43, v47
    v_cvt_pk_bf16_f32 v33, v46, v47
    v_accvgpr_write_b32 a117, v33
    v_exp_f32 v44, v60
    v_mfma_f32_32x32x16_bf16 v[64:79], v[236:239], v[100:103], v[64:79]
    v_fma_f32 v62, v62, s28, -v14
    v_add_f32 v43, v43, v44
    v_exp_f32 v45, v61
    v_fma_f32 v63, v63, s28, -v14
    v_add_f32 v43, v43, v45
    v_cvt_pk_bf16_f32 v32, v44, v45
    v_accvgpr_write_b32 a118, v32
    v_exp_f32 v46, v62
    v_mfma_f32_32x32x16_bf16 v[64:79], v[248:251], v[104:107], v[64:79]
    v_add_f32 v43, v43, v46
    v_exp_f32 v47, v63
    s_nop 0
    v_add_f32 v43, v43, v47
    v_cvt_pk_bf16_f32 v33, v46, v47
    v_accvgpr_write_b32 a119, v33
    v_mfma_f32_32x32x16_bf16 v[64:79], v[252:255], v[108:111], v[64:79]
    v_cmp_ngt_f32 vcc, 2.0, v43
    s_cbranch_vccnz L_rare6
L_back6:
    v_add_f32 v42, v42, v43
    v_mfma_f32_32x32x16_bf16 v[48:63], v[216:219], a[32:35], 0
    v_xor_b32 v1, 0xc000, v1
    v_xor_b32 v2, 0xc000, v2
    ds_read_b128 v[216:219], v1 offset:0
    s_add_u32 m0, s27, 7936
    s_add_u32 s29, s24, 98304
    buffer_load_dwordx4 v4, s[12:15], s29 offen offset:256 nt lds
    v_mfma_f32_32x32x16_bf16 v[48:63], v[220:223], a[36:39], v[48:63]
    ds_read_b128 v[220:223], v2 offset:0
    s_add_u32 m0, s27, 11904
    s_add_u32 s29, s24, 98304
    buffer_load_dwordx4 v4, s[12:15], s29 offen offset:384 nt lds
    v_mfma_f32_32x32x16_bf16 v[48:63], a[240:243], a[40:43], v[48:63]
    ds_read_b128 a[240:243], v1 offset:512
    v_fma_f32 v64, v64, s28, -v12
    v_fma_f32 v65, v65, s28, -v12
    v_exp_f32 v44, v64
    v_fma_f32 v66, v66, s28, -v12
    v_exp_f32 v45, v65
    v_mfma_f32_32x32x16_bf16 v[48:63], a[244:247], a[44:47], v[48:63]
    ds_read_b128 a[244:247], v2 offset:512
    v_fma_f32 v67, v67, s28, -v12
    v_add_f32 v43, v44, v45
    v_cvt_pk_bf16_f32 v160, v44, v45
    v_exp_f32 v46, v66
    v_mfma_f32_32x32x16_bf16 v[48:63], v[224:227], a[48:51], v[48:63]
    ds_read_b128 v[224:227], v1 offset:4096
    v_fma_f32 v68, v68, s28, -v12
    v_add_f32 v43, v43, v46
    v_exp_f32 v47, v67
    ds_write_b128 v9, a[144:147]
    v_mfma_f32_32x32x16_bf16 v[48:63], v[228:231], a[52:55], v[48:63]
    ds_read_b128 v[228:231], v2 offset:4096
    v_fma_f32 v69, v69, s28, -v12
    v_add_f32 v43, v43, v47
    v_cvt_pk_bf16_f32 v161, v46, v47
    v_exp_f32 v44, v68
    v_mfma_f32_32x32x16_bf16 v[48:63], a[248:251], a[56:59], v[48:63]
    ds_read_b128 a[248:251], v1 offset:4608
    v_fma_f32 v70, v70, s28, -v12
    v_add_f32 v43, v43, v44
    v_exp_f32 v45, v69
    v_xor_b32 v0, 32, v9
    ds_write_b128 v0, a[148:151]
    v_mfma_f32_32x32x16_bf16 v[48:63], a[252:255], a[60:63], v[48:63]
    ds_read_b128 a[252:255], v2 offset:4608
    v_fma_f32 v71, v71, s28, -v12
    v_add_f32 v43, v43, v45
    v_cvt_pk_bf16_f32 v162, v44, v45
    v_exp_f32 v46, v70
    v_mfma_f32_32x32x16_bf16 v[48:63], v[240:243], v[112:115], v[48:63]
    ds_read_b128 v[240:243], v1 offset:8192
    v_fma_f32 v72, v72, s28, -v12
    v_add_f32 v43, v43, v46
    v_exp_f32 v47, v71
    v_xor_b32 v0, 64, v9
    ds_write_b128 v0, a[160:163]
    v_mfma_f32_32x32x16_bf16 v[48:63], v[244:247], v[116:119], v[48:63]
    ds_read_b128 v[244:247], v2 offset:8192
    v_fma_f32 v73, v73, s28, -v12
    v_add_f32 v43, v43, v47
    v_cvt_pk_bf16_f32 v163, v46, v47
    v_exp_f32 v44, v72
    v_mfma_f32_32x32x16_bf16 v[48:63], a[232:235], v[120:123], v[48:63]
    ds_read_b128 a[232:235], v1 offset:8704
    v_fma_f32 v74, v74, s28, -v12
    v_add_f32 v43, v43, v44
    v_exp_f32 v45, v73
    v_xor_b32 v0, 96, v9
    ds_write_b128 v0, a[164:167]
    v_mfma_f32_32x32x16_bf16 v[48:63], a[236:239], v[124:127], v[48:63]
    ds_read_b128 a[236:239], v2 offset:8704
    v_fma_f32 v75, v75, s28, -v12
    v_add_f32 v43, v43, v45
    v_cvt_pk_bf16_f32 v164, v44, v45
    v_exp_f32 v46, v74
    ds_read_b128 a[144:147], v10 offset:0
    v_mfma_f32_32x32x16_bf16 v[48:63], v[232:235], v[128:131], v[48:63]
    ds_read_b128 v[232:235], v1 offset:12288
    v_fma_f32 v76, v76, s28, -v12
    v_add_f32 v43, v43, v46
    v_exp_f32 v47, v75
    v_fma_f32 v77, v77, s28, -v12
    v_add_f32 v43, v43, v47
    v_cvt_pk_bf16_f32 v165, v46, v47
    v_exp_f32 v44, v76
    v_mfma_f32_32x32x16_bf16 v[48:63], v[236:239], v[132:135], v[48:63]
    ds_read_b128 v[236:239], v2 offset:12288
    v_fma_f32 v78, v78, s28, -v12
    v_add_f32 v43, v43, v44
    v_exp_f32 v45, v77
    v_fma_f32 v79, v79, s28, -v12
    v_add_f32 v43, v43, v45
    v_cvt_pk_bf16_f32 v166, v44, v45
    v_exp_f32 v46, v78
    v_mfma_f32_32x32x16_bf16 v[48:63], v[248:251], v[136:139], v[48:63]
    ds_read_b128 v[248:251], v1 offset:12800
    v_add_f32 v43, v43, v46
    v_exp_f32 v47, v79
    s_nop 0
    v_add_f32 v43, v43, v47
    v_cvt_pk_bf16_f32 v167, v46, v47
    v_mfma_f32_32x32x16_bf16 v[48:63], v[252:255], v[140:143], v[48:63]
    ds_read_b128 v[208:211], v7 offset:0
    ds_read_b128 v[252:255], v2 offset:12800
    v_cmp_ngt_f32 vcc, 2.0, v43
    s_cbranch_vccnz L_rare7
L_back7:
    v_add_f32 v40, v40, v43
    s_waitcnt vmcnt(12)
    s_barrier
    s_waitcnt lgkmcnt(15)
    v_mfma_f32_32x32x16_bf16 v[64:79], v[216:219], a[64:67], 0
    ds_read_b128 v[212:215], v8 offset:0
    s_add_u32 m0, s27, 16384
    s_add_u32 s29, s24, 114688
    buffer_load_dwordx4 v4, s[12:15], s29 offen offset:0 nt lds
    v_mfma_f32_32x32x16_bf16 v[64:79], v[220:223], a[68:71], v[64:79]
    ds_read_b128 a[216:219], v7 offset:512
    s_add_u32 m0, s27, 20352
    s_add_u32 s29, s24, 114688
    buffer_load_dwordx4 v4, s[12:15], s29 offen offset:128 nt lds
    v_mfma_f32_32x32x16_bf16 v[64:79], a[240:243], a[72:75], v[64:79]
    ds_read_b128 a[220:223], v8 offset:512
    v_fma_f32 v48, v48, s28, -v13
    v_fma_f32 v49, v49, s28, -v13
    v_exp_f32 v44, v48
    v_fma_f32 v50, v50, s28, -v13
    v_exp_f32 v45, v49
    v_mfma_f32_32x32x16_bf16 v[64:79], a[244:247], a[76:79], v[64:79]
    ds_read_b128 v[16:19], v7 offset:16384
    v_fma_f32 v51, v51, s28, -v13
    v_add_f32 v43, v44, v45
    v_cvt_pk_bf16_f32 v32, v44, v45
    v_accvgpr_write_b32 a120, v32
    s_waitcnt lgkmcnt(3)
    v_exp_f32 v46, v50
    v_mfma_f32_32x32x16_bf16 v[64:79], v[224:227], v[208:211], v[64:79]
    ds_read_b128 v[20:23], v8 offset:16384
    v_fma_f32 v52, v52, s28, -v13
    v_add_f32 v43, v43, v46
    v_exp_f32 v47, v51
    v_fma_f32 v53, v53, s28, -v13
    v_add_f32 v43, v43, v47
    v_cvt_pk_bf16_f32 v33, v46, v47
    v_accvgpr_write_b32 a121, v33
    v_exp_f32 v44, v52
    v_mfma_f32_32x32x16_bf16 v[64:79], v[228:231], v[212:215], v[64:79]
    ds_read_b128 v[24:27], v7 offset:16896
    v_fma_f32 v54, v54, s28, -v13
    v_add_f32 v43, v43, v44
    v_exp_f32 v45, v53
    ds_read_b128 a[148:151], v10 offset:1024
    s_waitcnt lgkmcnt(4)
    v_mfma_f32_32x32x16_bf16 v[64:79], a[248:251], a[216:219], v[64:79]
    ds_read_b128 v[28:31], v8 offset:16896
    v_fma_f32 v55, v55, s28, -v13
    v_add_f32 v43, v43, v45
    v_cvt_pk_bf16_f32 v32, v44, v45
    v_accvgpr_write_b32 a122, v32
    v_exp_f32 v46, v54
    v_mfma_f32_32x32x16_bf16 v[64:79], a[252:255], a[220:223], v[64:79]
    ds_read_b128 a[208:211], v7 offset:32768
    v_fma_f32 v56, v56, s28, -v13
    v_add_f32 v43, v43, v46
    v_exp_f32 v47, v55
    ds_read_b128 a[160:163], v10 offset:2048
    s_waitcnt lgkmcnt(5)
    v_mfma_f32_32x32x16_bf16 v[64:79], v[240:243], v[16:19], v[64:79]
    ds_read_b128 a[212:215], v8 offset:32768
    v_fma_f32 v57, v57, s28, -v13
    v_add_f32 v43, v43, v47
    v_cvt_pk_bf16_f32 v33, v46, v47
    v_accvgpr_write_b32 a123, v33
    v_exp_f32 v44, v56
    v_mfma_f32_32x32x16_bf16 v[64:79], v[244:247], v[20:23], v[64:79]
    ds_read_b128 v[208:211], v7 offset:33280
    v_fma_f32 v58, v58, s28, -v13
    v_add_f32 v43, v43, v44
    v_exp_f32 v45, v57
    ds_read_b128 a[164:167], v10 offset:3072
    s_waitcnt lgkmcnt(5)
    v_mfma_f32_32x32x16_bf16 v[64:79], a[232:235], v[24:27], v[64:79]
    ds_read_b128 v[212:215], v8 offset:33280
    v_fma_f32 v59, v59, s28, -v13
    v_add_f32 v43, v43, v45
    v_cvt_pk_bf16_f32 v32, v44, v45
    v_accvgpr_write_b32 a124, v32
    v_exp_f32 v46, v58
    v_mfma_f32_32x32x16_bf16 v[64:79], a[236:239], v[28:31], v[64:79]
    v_fma_f32 v60, v60, s28, -v13
    v_add_f32 v43, v43, v46
    v_exp_f32 v47, v59
    s_waitcnt lgkmcnt(3)
    v_mfma_f32_32x32x16_bf16 v[64:79], v[232:235], a[208:211], v[64:79]
    v_fma_f32 v61, v61, s28, -v13
    v_add_f32 v43, v43, v47
    v_cvt_pk_bf16_f32 v33, v46, v47
    v_accvgpr_write_b32 a125, v33
    v_exp_f32 v44, v60
    v_fma_f32 v62, v62, s28, -v13
    v_add_f32 v43, v43, v44
    v_exp_f32 v45, v61
    v_mfma_f32_32x32x16_bf16 v[64:79], v[236:239], a[212:215], v[64:79]
    v_fma_f32 v63, v63, s28, -v13
    v_add_f32 v43, v43, v45
    v_cvt_pk_bf16_f32 v32, v44, v45
    v_accvgpr_write_b32 a126, v32
    s_waitcnt lgkmcnt(0)
    v_exp_f32 v46, v62
    v_mfma_f32_32x32x16_bf16 v[64:79], v[248:251], v[208:211], v[64:79]
    v_add_f32 v43, v43, v46
    v_exp_f32 v47, v63
    s_nop 0
    v_add_f32 v43, v43, v47
    v_cvt_pk_bf16_f32 v33, v46, v47
    v_accvgpr_write_b32 a127, v33
    v_mfma_f32_32x32x16_bf16 v[64:79], v[252:255], v[212:215], v[64:79]
    v_cmp_ngt_f32 vcc, 2.0, v43
    s_cbranch_vccnz L_rare8
L_back8:
    v_add_f32 v41, v41, v43
    v_mfma_f32_32x32x16_bf16 v[48:63], v[216:219], a[0:3], 0
    s_add_u32 m0, s27, 24320
    s_add_u32 s29, s24, 114688
    buffer_load_dwordx4 v4, s[12:15], s29 offen offset:256 nt lds
    v_mfma_f32_32x32x16_bf16 v[48:63], v[220:223], a[4:7], v[48:63]
    s_add_u32 m0, s27, 28288
    s_add_u32 s29, s24, 114688
    buffer_load_dwordx4 v4, s[12:15], s29 offen offset:384 nt lds
    v_mfma_f32_32x32x16_bf16 v[48:63], a[240:243], a[8:11], v[48:63]
    v_fma_f32 v64, v64, s28, -v14
    v_fma_f32 v65, v65, s28, -v14
    v_exp_f32 v44, v64
    v_fma_f32 v66, v66, s28, -v14
    v_exp_f32 v45, v65
    v_mfma_f32_32x32x16_bf16 v[48:63], a[244:247], a[12:15], v[48:63]
    v_fma_f32 v67, v67, s28, -v14
    v_add_f32 v43, v44, v45
    v_cvt_pk_bf16_f32 v32, v44, v45
    v_accvgpr_write_b32 a128, v32
    v_exp_f32 v46, v66
    v_mfma_f32_32x32x16_bf16 v[48:63], v[224:227], a[16:19], v[48:63]
    v_fma_f32 v68, v68, s28, -v14
    v_add_f32 v43, v43, v46
    v_exp_f32 v47, v67
    s_add_u32 s30, s32, 384
    buffer_store_dwordx4 a[144:147], v11, s[20:23], s30 offen sc1
    v_mfma_f32_32x32x16_bf16 v[48:63], v[228:231], a[20:23], v[48:63]
    v_fma_f32 v69, v69, s28, -v14
    v_add_f32 v43, v43, v47
    v_cvt_pk_bf16_f32 v33, v46, v47
    v_accvgpr_write_b32 a129, v33
    v_exp_f32 v44, v68
    v_mfma_f32_32x32x16_bf16 v[48:63], a[248:251], a[24:27], v[48:63]
    s_add_u32 m0, s27, 32768
    s_add_u32 s29, s24, 131072
    buffer_load_dwordx4 v4, s[12:15], s29 offen offset:0 nt lds
    v_fma_f32 v70, v70, s28, -v14
    v_add_f32 v43, v43, v44
    v_exp_f32 v45, v69
    v_mfma_f32_32x32x16_bf16 v[48:63], a[252:255], a[28:31], v[48:63]
    v_fma_f32 v71, v71, s28, -v14
    v_add_f32 v43, v43, v45
    v_cvt_pk_bf16_f32 v32, v44, v45
    v_accvgpr_write_b32 a130, v32
    v_exp_f32 v46, v70
    v_mfma_f32_32x32x16_bf16 v[48:63], v[240:243], v[80:83], v[48:63]
    v_fma_f32 v72, v72, s28, -v14
    v_add_f32 v43, v43, v46
    v_exp_f32 v47, v71
    s_add_u32 s30, s32, 4480
    buffer_store_dwordx4 a[148:151], v11, s[20:23], s30 offen sc1
    v_mfma_f32_32x32x16_bf16 v[48:63], v[244:247], v[84:87], v[48:63]
    v_fma_f32 v73, v73, s28, -v14
    v_add_f32 v43, v43, v47
    v_cvt_pk_bf16_f32 v33, v46, v47
    v_accvgpr_write_b32 a131, v33
    v_exp_f32 v44, v72
    v_mfma_f32_32x32x16_bf16 v[48:63], a[232:235], v[88:91], v[48:63]
    v_fma_f32 v74, v74, s28, -v14
    v_add_f32 v43, v43, v44
    v_exp_f32 v45, v73
    v_fma_f32 v75, v75, s28, -v14
    v_add_f32 v43, v43, v45
    v_cvt_pk_bf16_f32 v32, v44, v45
    v_accvgpr_write_b32 a132, v32
    v_exp_f32 v46, v74
    v_mfma_f32_32x32x16_bf16 v[48:63], a[236:239], v[92:95], v[48:63]
    s_add_u32 m0, s27, 36736
    s_add_u32 s29, s24, 131072
    buffer_load_dwordx4 v4, s[12:15], s29 offen offset:128 nt lds
    v_fma_f32 v76, v76, s28, -v14
    v_add_f32 v43, v43, v46
    v_exp_f32 v47, v75
    v_mfma_f32_32x32x16_bf16 v[48:63], v[232:235], v[96:99], v[48:63]
    v_fma_f32 v77, v77, s28, -v14
    v_add_f32 v43, v43, v47
    v_cvt_pk_bf16_f32 v33, v46, v47
    v_accvgpr_write_b32 a133, v33
    v_exp_f32 v44, v76
    v_mfma_f32_32x32x16_bf16 v[48:63], v[236:239], v[100:103], v[48:63]
    v_fma_f32 v78, v78, s28, -v14
    v_add_f32 v43, v43, v44
    v_exp_f32 v45, v77
    v_fma_f32 v79, v79, s28, -v14
    v_add_f32 v43, v43, v45
    v_cvt_pk_bf16_f32 v32, v44, v45
    v_accvgpr_write_b32 a134, v32
    v_exp_f32 v46, v78
    v_mfma_f32_32x32x16_bf16 v[48:63], v[248:251], v[104:107], v[48:63]
    v_add_f32 v43, v43, v46
    v_exp_f32 v47, v79
    s_nop 0
    v_add_f32 v43, v43, v47
    v_cvt_pk_bf16_f32 v33, v46, v47
    v_accvgpr_write_b32 a135, v33
    v_mfma_f32_32x32x16_bf16 v[48:63], v[252:255], v[108:111], v[48:63]
    v_cmp_ngt_f32 vcc, 2.0, v43
    s_cbranch_vccnz L_rare9
L_back9:
    v_add_f32 v42, v42, v43
    v_mfma_f32_32x32x16_bf16 v[64:79], v[216:219], a[32:35], 0
    ds_read_b128 v[216:219], v1 offset:16384
    s_add_u32 m0, s27, 40704
    s_add_u32 s29, s24, 131072
    buffer_load_dwordx4 v4, s[12:15], s29 offen offset:256 nt lds
    v_mfma_f32_32x32x16_bf16 v[64:79], v[220:223], a[36:39], v[64:79]
    ds_read_b128 v[220:223], v2 offset:16384
    s_add_u32 m0, s27, 44672
    s_add_u32 s29, s24, 131072
    buffer_load_dwordx4 v4, s[12:15], s29 offen offset:384 nt lds
    v_mfma_f32_32x32x16_bf16 v[64:79], a[240:243], a[40:43], v[64:79]
    ds_read_b128 a[240:243], v1 offset:16896
    v_fma_f32 v48, v48, s28, -v12
    v_fma_f32 v49, v49, s28, -v12
    v_exp_f32 v44, v48
    v_fma_f32 v50, v50, s28, -v12
    v_exp_f32 v45, v49
    v_mfma_f32_32x32x16_bf16 v[64:79], a[244:247], a[44:47], v[64:79]
    ds_read_b128 a[244:247], v2 offset:16896
    v_fma_f32 v51, v51, s28, -v12
    v_add_f32 v43, v44, v45
    v_cvt_pk_bf16_f32 v168, v44, v45
    v_exp_f32 v46, v50
    v_mfma_f32_32x32x16_bf16 v[64:79], v[224:227], a[48:51], v[64:79]
    ds_read_b128 v[224:227], v1 offset:20480
    v_fma_f32 v52, v52, s28, -v12
    v_add_f32 v43, v43, v46
    v_exp_f32 v47, v51
    v_mfma_f32_32x32x16_bf16 v[64:79], v[228:231], a[52:55], v[64:79]
    ds_read_b128 v[228:231], v2 offset:20480
    v_fma_f32 v53, v53, s28, -v12
    v_add_f32 v43, v43, v47
    v_cvt_pk_bf16_f32 v169, v46, v47
    v_exp_f32 v44, v52
    v_mfma_f32_32x32x16_bf16 v[64:79], a[248:251], a[56:59], v[64:79]
    ds_read_b128 a[248:251], v1 offset:20992
    v_fma_f32 v54, v54, s28, -v12
    v_add_f32 v43, v43, v44
    v_exp_f32 v45, v53
    v_mfma_f32_32x32x16_bf16 v[64:79], a[252:255], a[60:63], v[64:79]
    ds_read_b128 a[252:255], v2 offset:20992
    v_fma_f32 v55, v55, s28, -v12
    v_add_f32 v43, v43, v45
    v_cvt_pk_bf16_f32 v170, v44, v45
    v_exp_f32 v46, v54
    v_mfma_f32_32x32x16_bf16 v[64:79], v[240:243], v[112:115], v[64:79]
    ds_read_b128 v[240:243], v1 offset:24576
    v_fma_f32 v56, v56, s28, -v12
    v_add_f32 v43, v43, v46
    v_exp_f32 v47, v55
    s_add_u32 s30, s32, 8576
    buffer_store_dwordx4 a[160:163], v11, s[20:23], s30 offen sc1
    v_mfma_f32_32x32x16_bf16 v[64:79], v[244:247], v[116:119], v[64:79]
    ds_read_b128 v[244:247], v2 offset:24576
    v_fma_f32 v57, v57, s28, -v12
    v_add_f32 v43, v43, v47
    v_cvt_pk_bf16_f32 v171, v46, v47
    v_exp_f32 v44, v56
    v_mfma_f32_32x32x16_bf16 v[64:79], a[232:235], v[120:123], v[64:79]
    ds_read_b128 a[232:235], v1 offset:25088
    v_fma_f32 v58, v58, s28, -v12
    v_add_f32 v43, v43, v44
    v_exp_f32 v45, v57
    s_add_u32 s30, s32, 12672
    buffer_store_dwordx4 a[164:167], v11, s[20:23], s30 offen sc1
    v_mfma_f32_32x32x16_bf16 v[64:79], a[236:239], v[124:127], v[64:79]
    ds_read_b128 a[236:239], v2 offset:25088
    v_fma_f32 v59, v59, s28, -v12
    v_add_f32 v43, v43, v45
    v_cvt_pk_bf16_f32 v172, v44, v45
    v_exp_f32 v46, v58
    v_mfma_f32_32x32x16_bf16 v[64:79], v[232:235], v[128:131], v[64:79]
    ds_read_b128 v[232:235], v1 offset:28672
    v_fma_f32 v60, v60, s28, -v12
    v_add_f32 v43, v43, v46
    v_exp_f32 v47, v59
    v_fma_f32 v61, v61, s28, -v12
    v_add_f32 v43, v43, v47
    v_cvt_pk_bf16_f32 v173, v46, v47
    v_exp_f32 v44, v60
    v_mfma_f32_32x32x16_bf16 v[64:79], v[236:239], v[132:135], v[64:79]
    ds_read_b128 v[236:239], v2 offset:28672
    v_fma_f32 v62, v62, s28, -v12
    v_add_f32 v43, v43, v44
    v_exp_f32 v45, v61
    v_fma_f32 v63, v63, s28, -v12
    v_add_f32 v43, v43, v45
    v_cvt_pk_bf16_f32 v174, v44, v45
    v_exp_f32 v46, v62
    v_mfma_f32_32x32x16_bf16 v[64:79], v[248:251], v[136:139], v[64:79]
    ds_read_b128 v[248:251], v1 offset:29184
    v_add_f32 v43, v43, v46
    v_exp_f32 v47, v63
    s_nop 0
    v_add_f32 v43, v43, v47
    v_cvt_pk_bf16_f32 v175, v46, v47
    v_mfma_f32_32x32x16_bf16 v[64:79], v[252:255], v[140:143], v[64:79]
    ds_read_b128 a[216:219], v7 offset:0
    ds_read_b128 v[252:255], v2 offset:29184
    v_cmp_ngt_f32 vcc, 2.0, v43
    s_cbranch_vccnz L_rare10
L_back10:
    v_add_f32 v40, v40, v43
    s_waitcnt vmcnt(16)
    s_barrier
    s_waitcnt lgkmcnt(15)
    v_mfma_f32_32x32x16_bf16 v[48:63], v[216:219], a[64:67], 0
    ds_read_b128 a[220:223], v8 offset:0
    s_add_u32 m0, s27, 49152
    s_add_u32 s29, s24, 147456
    buffer_load_dwordx4 v4, s[12:15], s29 offen offset:0 nt lds
    v_mfma_f32_32x32x16_bf16 v[48:63], v[220:223], a[68:71], v[48:63]
    ds_read_b128 v[16:19], v7 offset:512
    s_add_u32 m0, s27, 53120
    s_add_u32 s29, s24, 147456
    buffer_load_dwordx4 v4, s[12:15], s29 offen offset:128 nt lds
    s_waitcnt lgkmcnt(15)
    v_mfma_f32_32x32x16_bf16 v[48:63], a[240:243], a[72:75], v[48:63]
    ds_read_b128 v[20:23], v8 offset:512
    v_fma_f32 v64, v64, s28, -v13
    v_fma_f32 v65, v65, s28, -v13
    v_exp_f32 v44, v64
    v_fma_f32 v66, v66, s28, -v13
    v_exp_f32 v45, v65
    v_mfma_f32_32x32x16_bf16 v[48:63], a[244:247], a[76:79], v[48:63]
    ds_read_b128 v[24:27], v7 offset:16384
    v_fma_f32 v67, v67, s28, -v13
    v_add_f32 v43, v44, v45
    v_cvt_pk_bf16_f32 v32, v44, v45
    v_accvgpr_write_b32 a136, v32
    s_waitcnt lgkmcnt(3)
    v_exp_f32 v46, v66
    v_mfma_f32_32x32x16_bf16 v[48:63], v[224:227], a[216:219], v[48:63]
    ds_read_b128 v[28:31], v8 offset:16384
    v_fma_f32 v68, v68, s28, -v13
    v_add_f32 v43, v43, v46
    v_exp_f32 v47, v67
    v_fma_f32 v69, v69, s28, -v13
    v_add_f32 v43, v43, v47
    v_cvt_pk_bf16_f32 v33, v46, v47
    v_accvgpr_write_b32 a137, v33
    v_exp_f32 v44, v68
    v_mfma_f32_32x32x16_bf16 v[48:63], v[228:231], a[220:223], v[48:63]
    ds_read_b128 a[208:211], v7 offset:16896
    v_fma_f32 v70, v70, s28, -v13
    v_add_f32 v43, v43, v44
    s_waitcnt lgkmcnt(3)
    v_exp_f32 v45, v69
    v_mfma_f32_32x32x16_bf16 v[48:63], a[248:251], v[16:19], v[48:63]
    ds_read_b128 a[212:215], v8 offset:16896
    v_fma_f32 v71, v71, s28, -v13
    v_add_f32 v43, v43, v45
    v_cvt_pk_bf16_f32 v32, v44, v45
    v_accvgpr_write_b32 a138, v32
    v_exp_f32 v46, v70
    v_mfma_f32_32x32x16_bf16 v[48:63], a[252:255], v[20:23], v[48:63]
    ds_read_b128 v[208:211], v7 offset:32768
    v_fma_f32 v72, v72, s28, -v13
    v_add_f32 v43, v43, v46
    s_waitcnt lgkmcnt(3)
    v_exp_f32 v47, v71
    v_mfma_f32_32x32x16_bf16 v[48:63], v[240:243], v[24:27], v[48:63]
    ds_read_b128 v[212:215], v8 offset:32768
    v_fma_f32 v73, v73, s28, -v13
    v_add_f32 v43, v43, v47
    v_cvt_pk_bf16_f32 v33, v46, v47
    v_accvgpr_write_b32 a139, v33
    v_exp_f32 v44, v72
    v_mfma_f32_32x32x16_bf16 v[48:63], v[244:247], v[28:31], v[48:63]
    ds_read_b128 a[216:219], v7 offset:33280
    v_fma_f32 v74, v74, s28, -v13
    v_add_f32 v43, v43, v44
    s_waitcnt lgkmcnt(3)
    v_exp_f32 v45, v73
    v_mfma_f32_32x32x16_bf16 v[48:63], a[232:235], a[208:211], v[48:63]
    ds_read_b128 a[220:223], v8 offset:33280
    v_fma_f32 v75, v75, s28, -v13
    v_add_f32 v43, v43, v45
    v_cvt_pk_bf16_f32 v32, v44, v45
    v_accvgpr_write_b32 a140, v32
    v_exp_f32 v46, v74
    v_mfma_f32_32x32x16_bf16 v[48:63], a[236:239], a[212:215], v[48:63]
    v_fma_f32 v76, v76, s28, -v13
    v_add_f32 v43, v43, v46
    v_exp_f32 v47, v75
    ds_write_b128 v9, a[176:179]
    s_waitcnt lgkmcnt(3)
    v_mfma_f32_32x32x16_bf16 v[48:63], v[232:235], v[208:211], v[48:63]
    v_fma_f32 v77, v77, s28, -v13
    v_add_f32 v43, v43, v47
    v_cvt_pk_bf16_f32 v33, v46, v47
    v_accvgpr_write_b32 a141, v33
    v_exp_f32 v44, v76
    v_fma_f32 v78, v78, s28, -v13
    v_add_f32 v43, v43, v44
    v_exp_f32 v45, v77
    v_mfma_f32_32x32x16_bf16 v[48:63], v[236:239], v[212:215], v[48:63]
    v_fma_f32 v79, v79, s28, -v13
    v_add_f32 v43, v43, v45
    v_cvt_pk_bf16_f32 v32, v44, v45
    v_accvgpr_write_b32 a142, v32
    s_waitcnt lgkmcnt(1)
    v_exp_f32 v46, v78
    v_mfma_f32_32x32x16_bf16 v[48:63], v[248:251], a[216:219], v[48:63]
    v_add_f32 v43, v43, v46
    v_exp_f32 v47, v79
    s_nop 0
    v_add_f32 v43, v43, v47
    v_cvt_pk_bf16_f32 v33, v46, v47
    v_accvgpr_write_b32 a143, v33
    v_mfma_f32_32x32x16_bf16 v[48:63], v[252:255], a[220:223], v[48:63]
    v_cmp_ngt_f32 vcc, 2.0, v43
    s_cbranch_vccnz L_rare11
L_back11:
    v_add_f32 v41, v41, v43
    v_mfma_f32_32x32x16_bf16 v[64:79], v[216:219], a[0:3], 0
    s_add_u32 m0, s27, 57088
    s_add_u32 s29, s24, 147456
    buffer_load_dwordx4 v4, s[12:15], s29 offen offset:256 nt lds
    v_mfma_f32_32x32x16_bf16 v[64:79], v[220:223], a[4:7], v[64:79]
    s_add_u32 m0, s27, 61056
    s_add_u32 s29, s24, 147456
    buffer_load_dwordx4 v4, s[12:15], s29 offen offset:384 nt lds
    v_mfma_f32_32x32x16_bf16 v[64:79], a[240:243], a[8:11], v[64:79]
    v_fma_f32 v48, v48, s28, -v14
    v_fma_f32 v49, v49, s28, -v14
    v_exp_f32 v44, v48
    v_fma_f32 v50, v50, s28, -v14
    v_exp_f32 v45, v49
    v_mfma_f32_32x32x16_bf16 v[64:79], a[244:247], a[12:15], v[64:79]
    v_fma_f32 v51, v51, s28, -v14
    v_add_f32 v43, v44, v45
    v_cvt_pk_bf16_f32 v32, v44, v45
    v_accvgpr_write_b32 a144, v32
    v_exp_f32 v46, v50
    v_mfma_f32_32x32x16_bf16 v[64:79], v[224:227], a[16:19], v[64:79]
    v_fma_f32 v52, v52, s28, -v14
    v_add_f32 v43, v43, v46
    v_exp_f32 v47, v51
    v_xor_b32 v0, 32, v9
    ds_write_b128 v0, a[180:183]
    v_mfma_f32_32x32x16_bf16 v[64:79], v[228:231], a[20:23], v[64:79]
    v_fma_f32 v53, v53, s28, -v14
    v_add_f32 v43, v43, v47
    v_cvt_pk_bf16_f32 v33, v46, v47
    v_accvgpr_write_b32 a145, v33
    v_exp_f32 v44, v52
    v_mfma_f32_32x32x16_bf16 v[64:79], a[248:251], a[24:27], v[64:79]
    v_fma_f32 v54, v54, s28, -v14
    v_add_f32 v43, v43, v44
    v_exp_f32 v45, v53
    v_mfma_f32_32x32x16_bf16 v[64:79], a[252:255], a[28:31], v[64:79]
    v_fma_f32 v55, v55, s28, -v14
    v_add_f32 v43, v43, v45
    v_cvt_pk_bf16_f32 v32, v44, v45
    v_accvgpr_write_b32 a146, v32
    v_exp_f32 v46, v54
    v_xor_b32 v0, 64, v9
    ds_write_b128 v0, a[192:195]
    v_mfma_f32_32x32x16_bf16 v[64:79], v[240:243], v[80:83], v[64:79]
    v_fma_f32 v56, v56, s28, -v14
    v_add_f32 v43, v43, v46
    v_exp_f32 v47, v55
    v_xor_b32 v0, 96, v9
    ds_write_b128 v0, a[196:199]
    v_mfma_f32_32x32x16_bf16 v[64:79], v[244:247], v[84:87], v[64:79]
    v_fma_f32 v57, v57, s28, -v14
    v_add_f32 v43, v43, v47
    v_cvt_pk_bf16_f32 v33, v46, v47
    v_accvgpr_write_b32 a147, v33
    v_exp_f32 v44, v56
    ds_read_b128 a[176:179], v10 offset:0
    v_mfma_f32_32x32x16_bf16 v[64:79], a[232:235], v[88:91], v[64:79]
    v_fma_f32 v58, v58, s28, -v14
    v_add_f32 v43, v43, v44
    v_exp_f32 v45, v57
    v_fma_f32 v59, v59, s28, -v14
    v_add_f32 v43, v43, v45
    v_cvt_pk_bf16_f32 v32, v44, v45
    v_accvgpr_write_b32 a148, v32
    v_exp_f32 v46, v58
    v_mfma_f32_32x32x16_bf16 v[64:79], a[236:239], v[92:95], v[64:79]
    v_fma_f32 v60, v60, s28, -v14
    v_add_f32 v43, v43, v46
    v_exp_f32 v47, v59
    v_mfma_f32_32x32x16_bf16 v[64:79], v[232:235], v[96:99], v[64:79]
    v_fma_f32 v61, v61, s28, -v14
    v_add_f32 v43, v43, v47
    v_cvt_pk_bf16_f32 v33, v46, v47
    v_accvgpr_write_b32 a149, v33
    v_exp_f32 v44, v60
    ds_read_b128 a[180:183], v10 offset:1024
    v_mfma_f32_32x32x16_bf16 v[64:79], v[236:239], v[100:103], v[64:79]
    v_fma_f32 v62, v62, s28, -v14
    v_add_f32 v43, v43, v44
    v_exp_f32 v45, v61
    v_fma_f32 v63, v63, s28, -v14
    v_add_f32 v43, v43, v45
    v_cvt_pk_bf16_f32 v32, v44, v45
    v_accvgpr_write_b32 a150, v32
    v_exp_f32 v46, v62
    v_mfma_f32_32x32x16_bf16 v[64:79], v[248:251], v[104:107], v[64:79]
    v_add_f32 v43, v43, v46
    v_exp_f32 v47, v63
    s_nop 0
    v_add_f32 v43, v43, v47
    v_cvt_pk_bf16_f32 v33, v46, v47
    v_accvgpr_write_b32 a151, v33
    v_mfma_f32_32x32x16_bf16 v[64:79], v[252:255], v[108:111], v[64:79]
    v_cmp_ngt_f32 vcc, 2.0, v43
    s_cbranch_vccnz L_rare12
L_back12:
    v_add_f32 v42, v42, v43
    ds_read_b128 a[192:195], v10 offset:2048
    v_mfma_f32_32x32x16_bf16 v[48:63], v[216:219], a[32:35], 0
    ds_read_b128 v[216:219], v1 offset:32768
    v_mfma_f32_32x32x16_bf16 v[48:63], v[220:223], a[36:39], v[48:63]
    ds_read_b128 v[220:223], v2 offset:32768
    v_mfma_f32_32x32x16_bf16 v[48:63], a[240:243], a[40:43], v[48:63]
    ds_read_b128 a[240:243], v1 offset:33280
    s_nop 1
    v_fma_f32 v64, v64, s28, -v12
    v_fma_f32 v65, v65, s28, -v12
    v_exp_f32 v44, v64
    v_fma_f32 v66, v66, s28, -v12
    v_exp_f32 v45, v65
    v_mfma_f32_32x32x16_bf16 v[48:63], a[244:247], a[44:47], v[48:63]
    ds_read_b128 a[244:247], v2 offset:33280
    v_fma_f32 v67, v67, s28, -v12
    v_add_f32 v43, v44, v45
    v_cvt_pk_bf16_f32 v176, v44, v45
    v_exp_f32 v46, v66
    ds_read_b128 a[196:199], v10 offset:3072
    v_mfma_f32_32x32x16_bf16 v[48:63], v[224:227], a[48:51], v[48:63]
    ds_read_b128 v[224:227], v1 offset:36864
    v_fma_f32 v68, v68, s28, -v12
    v_add_f32 v43, v43, v46
    v_exp_f32 v47, v67
    v_mfma_f32_32x32x16_bf16 v[48:63], v[228:231], a[52:55], v[48:63]
    ds_read_b128 v[228:231], v2 offset:36864
    v_fma_f32 v69, v69, s28, -v12
    v_add_f32 v43, v43, v47
    v_cvt_pk_bf16_f32 v177, v46, v47
    v_exp_f32 v44, v68
    v_mfma_f32_32x32x16_bf16 v[48:63], a[248:251], a[56:59], v[48:63]
    ds_read_b128 a[248:251], v1 offset:37376
    v_fma_f32 v70, v70, s28, -v12
    v_add_f32 v43, v43, v44
    v_exp_f32 v45, v69
    s_waitcnt lgkmcnt(10)
    s_add_u32 s30, s32, 33152
    buffer_store_dwordx4 a[176:179], v11, s[20:23], s30 offen sc1
    v_mfma_f32_32x32x16_bf16 v[48:63], a[252:255], a[60:63], v[48:63]
    ds_read_b128 a[252:255], v2 offset:37376
    v_fma_f32 v71, v71, s28, -v12
    v_add_f32 v43, v43, v45
    v_cvt_pk_bf16_f32 v178, v44, v45
    v_exp_f32 v46, v70
    v_mfma_f32_32x32x16_bf16 v[48:63], v[240:243], v[112:115], v[48:63]
    ds_read_b128 v[240:243], v1 offset:40960
    v_fma_f32 v72, v72, s28, -v12
    v_add_f32 v43, v43, v46
    v_exp_f32 v47, v71
    s_waitcnt lgkmcnt(11)
    s_add_u32 s30, s32, 37248
    buffer_store_dwordx4 a[180:183], v11, s[20:23], s30 offen sc1
    v_mfma_f32_32x32x16_bf16 v[48:63], v[244:247], v[116:119], v[48:63]
    ds_read_b128 v[244:247], v2 offset:40960
    v_fma_f32 v73, v73, s28, -v12
    v_add_f32 v43, v43, v47
    v_cvt_pk_bf16_f32 v179, v46, v47
    v_exp_f32 v44, v72
    v_mfma_f32_32x32x16_bf16 v[48:63], a[232:235], v[120:123], v[48:63]
    ds_read_b128 a[232:235], v1 offset:41472
    v_fma_f32 v74, v74, s28, -v12
    v_add_f32 v43, v43, v44
    v_exp_f32 v45, v73
    s_waitcnt lgkmcnt(12)
    s_add_u32 s30, s32, 41344
    buffer_store_dwordx4 a[192:195], v11, s[20:23], s30 offen sc1
    v_mfma_f32_32x32x16_bf16 v[48:63], a[236:239], v[124:127], v[48:63]
    ds_read_b128 a[236:239], v2 offset:41472
    v_fma_f32 v75, v75, s28, -v12
    v_add_f32 v43, v43, v45
    v_cvt_pk_bf16_f32 v180, v44, v45
    v_exp_f32 v46, v74
    v_mfma_f32_32x32x16_bf16 v[48:63], v[232:235], v[128:131], v[48:63]
    ds_read_b128 v[232:235], v1 offset:45056
    v_fma_f32 v76, v76, s28, -v12
    v_add_f32 v43, v43, v46
    v_exp_f32 v47, v75
    v_fma_f32 v77, v77, s28, -v12
    v_add_f32 v43, v43, v47
    v_cvt_pk_bf16_f32 v181, v46, v47
    v_exp_f32 v44, v76
    v_mfma_f32_32x32x16_bf16 v[48:63], v[236:239], v[132:135], v[48:63]
    ds_read_b128 v[236:239], v2 offset:45056
    v_fma_f32 v78, v78, s28, -v12
    v_add_f32 v43, v43, v44
    v_exp_f32 v45, v77
    v_fma_f32 v79, v79, s28, -v12
    v_add_f32 v43, v43, v45
    v_cvt_pk_bf16_f32 v182, v44, v45
    v_exp_f32 v46, v78
    v_mfma_f32_32x32x16_bf16 v[48:63], v[248:251], v[136:139], v[48:63]
    ds_read_b128 v[248:251], v1 offset:45568
    v_add_f32 v43, v43, v46
    v_exp_f32 v47, v79
    s_nop 0
    v_add_f32 v43, v43, v47
    v_cvt_pk_bf16_f32 v183, v46, v47
    v_mfma_f32_32x32x16_bf16 v[48:63], v[252:255], v[140:143], v[48:63]
    ds_read_b128 v[16:19], v7 offset:0
    ds_read_b128 v[252:255], v2 offset:45568
    v_cmp_ngt_f32 vcc, 2.0, v43
    s_cbranch_vccnz L_rare13
L_back13:
    v_add_f32 v40, v40, v43
    s_waitcnt vmcnt(19)
    s_barrier
    s_waitcnt lgkmcnt(15)
    v_mfma_f32_32x32x16_bf16 v[64:79], v[216:219], a[64:67], 0
    ds_read_b128 v[20:23], v8 offset:0
    s_add_u32 m0, s27, 65536
    s_add_u32 s29, s24, 163840
    buffer_load_dwordx4 v4, s[12:15], s29 offen offset:0 nt lds
    v_mfma_f32_32x32x16_bf16 v[64:79], v[220:223], a[68:71], v[64:79]
    ds_read_b128 v[24:27], v7 offset:512
    s_add_u32 m0, s27, 69504
    s_add_u32 s29, s24, 163840
    buffer_load_dwordx4 v4, s[12:15], s29 offen offset:128 nt lds
    s_waitcnt lgkmcnt(15)
    v_mfma_f32_32x32x16_bf16 v[64:79], a[240:243], a[72:75], v[64:79]
    ds_read_b128 v[28:31], v8 offset:512
    v_fma_f32 v48, v48, s28, -v13
    v_fma_f32 v49, v49, s28, -v13
    v_exp_f32 v44, v48
    v_fma_f32 v50, v50, s28, -v13
    v_exp_f32 v45, v49
    v_mfma_f32_32x32x16_bf16 v[64:79], a[244:247], a[76:79], v[64:79]
    ds_read_b128 a[208:211], v7 offset:16384
    v_fma_f32 v51, v51, s28, -v13
    v_add_f32 v43, v44, v45
    v_cvt_pk_bf16_f32 v32, v44, v45
    v_accvgpr_write_b32 a152, v32
    s_waitcnt lgkmcnt(3)
    v_exp_f32 v46, v50
    v_mfma_f32_32x32x16_bf16 v[64:79], v[224:227], v[16:19], v[64:79]
    ds_read_b128 a[212:215], v8 offset:16384
    v_fma_f32 v52, v52, s28, -v13
    v_add_f32 v43, v43, v46
    v_exp_f32 v47, v51
    v_fma_f32 v53, v53, s28, -v13
    v_add_f32 v43, v43, v47
    v_cvt_pk_bf16_f32 v33, v46, v47
    v_accvgpr_write_b32 a153, v33
    v_exp_f32 v44, v52
    v_mfma_f32_32x32x16_bf16 v[64:79], v[228:231], v[20:23], v[64:79]
    ds_read_b128 v[208:211], v7 offset:16896
    v_fma_f32 v54, v54, s28, -v13
    v_add_f32 v43, v43, v44
    s_waitcnt lgkmcnt(3)
    v_exp_f32 v45, v53
    v_mfma_f32_32x32x16_bf16 v[64:79], a[248:251], v[24:27], v[64:79]
    ds_read_b128 v[212:215], v8 offset:16896
    v_fma_f32 v55, v55, s28, -v13
    v_add_f32 v43, v43, v45
    v_cvt_pk_bf16_f32 v32, v44, v45
    v_accvgpr_write_b32 a154, v32
    v_exp_f32 v46, v54
    v_mfma_f32_32x32x16_bf16 v[64:79], a[252:255], v[28:31], v[64:79]
    ds_read_b128 a[216:219], v7 offset:32768
    v_fma_f32 v56, v56, s28, -v13
    v_add_f32 v43, v43, v46
    s_waitcnt lgkmcnt(3)
    v_exp_f32 v47, v55
    v_mfma_f32_32x32x16_bf16 v[64:79], v[240:243], a[208:211], v[64:79]
    ds_read_b128 a[220:223], v8 offset:32768
    v_fma_f32 v57, v57, s28, -v13
    v_add_f32 v43, v43, v47
    v_cvt_pk_bf16_f32 v33, v46, v47
    v_accvgpr_write_b32 a155, v33
    v_exp_f32 v44, v56
    v_mfma_f32_32x32x16_bf16 v[64:79], v[244:247], a[212:215], v[64:79]
    ds_read_b128 v[16:19], v7 offset:33280
    v_fma_f32 v58, v58, s28, -v13
    v_add_f32 v43, v43, v44
    s_waitcnt lgkmcnt(3)
    v_exp_f32 v45, v57
    v_mfma_f32_32x32x16_bf16 v[64:79], a[232:235], v[208:211], v[64:79]
    ds_read_b128 v[20:23], v8 offset:33280
    v_fma_f32 v59, v59, s28, -v13
    v_add_f32 v43, v43, v45
    v_cvt_pk_bf16_f32 v32, v44, v45
    v_accvgpr_write_b32 a156, v32
    v_exp_f32 v46, v58
    v_mfma_f32_32x32x16_bf16 v[64:79], a[236:239], v[212:215], v[64:79]
    v_fma_f32 v60, v60, s28, -v13
    v_add_f32 v43, v43, v46
    v_exp_f32 v47, v59
    s_add_u32 s30, s32, 45440
    buffer_store_dwordx4 a[196:199], v11, s[20:23], s30 offen sc1
    s_waitcnt lgkmcnt(2)
    v_mfma_f32_32x32x16_bf16 v[64:79], v[232:235], a[216:219], v[64:79]
    v_fma_f32 v61, v61, s28, -v13
    v_add_f32 v43, v43, v47
    v_cvt_pk_bf16_f32 v33, v46, v47
    v_accvgpr_write_b32 a157, v33
    v_exp_f32 v44, v60
    v_fma_f32 v62, v62, s28, -v13
    v_add_f32 v43, v43, v44
    v_exp_f32 v45, v61
    v_mfma_f32_32x32x16_bf16 v[64:79], v[236:239], a[220:223], v[64:79]
    v_fma_f32 v63, v63, s28, -v13
    v_add_f32 v43, v43, v45
    v_cvt_pk_bf16_f32 v32, v44, v45
    v_accvgpr_write_b32 a158, v32
    s_waitcnt lgkmcnt(0)
    v_exp_f32 v46, v62
    v_mfma_f32_32x32x16_bf16 v[64:79], v[248:251], v[16:19], v[64:79]
    v_add_f32 v43, v43, v46
    v_exp_f32 v47, v63
    s_nop 0
    v_add_f32 v43, v43, v47
    v_cvt_pk_bf16_f32 v33, v46, v47
    v_accvgpr_write_b32 a159, v33
    v_mfma_f32_32x32x16_bf16 v[64:79], v[252:255], v[20:23], v[64:79]
    v_cmp_ngt_f32 vcc, 2.0, v43
    s_cbranch_vccnz L_rare14
L_back14:
    v_add_f32 v41, v41, v43
    v_mfma_f32_32x32x16_bf16 v[48:63], v[216:219], a[0:3], 0
    s_add_u32 m0, s27, 73472
    s_add_u32 s29, s24, 163840
    buffer_load_dwordx4 v4, s[12:15], s29 offen offset:256 nt lds
    v_mfma_f32_32x32x16_bf16 v[48:63], v[220:223], a[4:7], v[48:63]
    s_add_u32 m0, s27, 77440
    s_add_u32 s29, s24, 163840
    buffer_load_dwordx4 v4, s[12:15], s29 offen offset:384 nt lds
    v_mfma_f32_32x32x16_bf16 v[48:63], a[240:243], a[8:11], v[48:63]
    v_fma_f32 v64, v64, s28, -v14
    v_fma_f32 v65, v65, s28, -v14
    v_exp_f32 v44, v64
    v_fma_f32 v66, v66, s28, -v14
    v_exp_f32 v45, v65
    v_mfma_f32_32x32x16_bf16 v[48:63], a[244:247], a[12:15], v[48:63]
    v_fma_f32 v67, v67, s28, -v14
    v_add_f32 v43, v44, v45
    v_cvt_pk_bf16_f32 v32, v44, v45
    v_accvgpr_write_b32 a160, v32
    v_exp_f32 v46, v66
    v_mfma_f32_32x32x16_bf16 v[48:63], v[224:227], a[16:19], v[48:63]
    v_fma_f32 v68, v68, s28, -v14
    v_add_f32 v43, v43, v46
    v_exp_f32 v47, v67
    ds_write_b128 v9, v[192:195]
    v_mfma_f32_32x32x16_bf16 v[48:63], v[228:231], a[20:23], v[48:63]
    v_fma_f32 v69, v69, s28, -v14
    v_add_f32 v43, v43, v47
    v_cvt_pk_bf16_f32 v33, v46, v47
    v_accvgpr_write_b32 a161, v33
    v_exp_f32 v44, v68
    v_mfma_f32_32x32x16_bf16 v[48:63], a[248:251], a[24:27], v[48:63]
    v_fma_f32 v70, v70, s28, -v14
    v_add_f32 v43, v43, v44
    v_exp_f32 v45, v69
    v_mfma_f32_32x32x16_bf16 v[48:63], a[252:255], a[28:31], v[48:63]
    v_fma_f32 v71, v71, s28, -v14
    v_add_f32 v43, v43, v45
    v_cvt_pk_bf16_f32 v32, v44, v45
    v_accvgpr_write_b32 a162, v32
    v_exp_f32 v46, v70
    v_mfma_f32_32x32x16_bf16 v[48:63], v[240:243], v[80:83], v[48:63]
    v_fma_f32 v72, v72, s28, -v14
    v_add_f32 v43, v43, v46
    v_exp_f32 v47, v71
    v_xor_b32 v0, 32, v9
    ds_write_b128 v0, v[196:199]
    v_mfma_f32_32x32x16_bf16 v[48:63], v[244:247], v[84:87], v[48:63]
    v_fma_f32 v73, v73, s28, -v14
    v_add_f32 v43, v43, v47
    v_cvt_pk_bf16_f32 v33, v46, v47
    v_accvgpr_write_b32 a163, v33
    v_exp_f32 v44, v72
    v_mfma_f32_32x32x16_bf16 v[48:63], a[232:235], v[88:91], v[48:63]
    v_fma_f32 v74, v74, s28, -v14
    v_add_f32 v43, v43, v44
    v_exp_f32 v45, v73
    v_fma_f32 v75, v75, s28, -v14
    v_add_f32 v43, v43, v45
    v_cvt_pk_bf16_f32 v32, v44, v45
    v_accvgpr_write_b32 a164, v32
    v_exp_f32 v46, v74
    v_mfma_f32_32x32x16_bf16 v[48:63], a[236:239], v[92:95], v[48:63]
    v_fma_f32 v76, v76, s28, -v14
    v_add_f32 v43, v43, v46
    v_exp_f32 v47, v75
    v_mfma_f32_32x32x16_bf16 v[48:63], v[232:235], v[96:99], v[48:63]
    v_fma_f32 v77, v77, s28, -v14
    v_add_f32 v43, v43, v47
    v_cvt_pk_bf16_f32 v33, v46, v47
    v_accvgpr_write_b32 a165, v33
    v_exp_f32 v44, v76
    v_mfma_f32_32x32x16_bf16 v[48:63], v[236:239], v[100:103], v[48:63]
    v_fma_f32 v78, v78, s28, -v14
    v_add_f32 v43, v43, v44
    v_exp_f32 v45, v77
    v_fma_f32 v79, v79, s28, -v14
    v_add_f32 v43, v43, v45
    v_cvt_pk_bf16_f32 v32, v44, v45
    v_accvgpr_write_b32 a166, v32
    v_exp_f32 v46, v78
    v_mfma_f32_32x32x16_bf16 v[48:63], v[248:251], v[104:107], v[48:63]
    v_add_f32 v43, v43, v46
    v_exp_f32 v47, v79
    s_nop 0
    v_add_f32 v43, v43, v47
    v_cvt_pk_bf16_f32 v33, v46, v47
    v_accvgpr_write_b32 a167, v33
    v_mfma_f32_32x32x16_bf16 v[48:63], v[252:255], v[108:111], v[48:63]
    v_cmp_ngt_f32 vcc, 2.0, v43
    s_cbranch_vccnz L_rare15
L_back15:
    v_add_f32 v42, v42, v43
    v_mfma_f32_32x32x16_bf16 v[64:79], v[216:219], a[32:35], 0
    v_xor_b32 v1, 0xc000, v1
    v_xor_b32 v2, 0xc000, v2
    ds_read_b128 v[216:219], v1 offset:0
    v_mfma_f32_32x32x16_bf16 v[64:79], v[220:223], a[36:39], v[64:79]
    ds_read_b128 v[220:223], v2 offset:0
    v_mfma_f32_32x32x16_bf16 v[64:79], a[240:243], a[40:43], v[64:79]
    ds_read_b128 a[240:243], v1 offset:512
    s_nop 0
    v_fma_f32 v48, v48, s28, -v12
    v_fma_f32 v49, v49, s28, -v12
    v_exp_f32 v44, v48
    v_fma_f32 v50, v50, s28, -v12
    v_exp_f32 v45, v49
    v_mfma_f32_32x32x16_bf16 v[64:79], a[244:247], a[44:47], v[64:79]
    ds_read_b128 a[244:247], v2 offset:512
    v_fma_f32 v51, v51, s28, -v12
    v_add_f32 v43, v44, v45
    v_cvt_pk_bf16_f32 v184, v44, v45
    v_exp_f32 v46, v50
    v_mfma_f32_32x32x16_bf16 v[64:79], v[224:227], a[48:51], v[64:79]
    ds_read_b128 v[224:227], v1 offset:4096
    v_fma_f32 v52, v52, s28, -v12
    v_add_f32 v43, v43, v46
    v_exp_f32 v47, v51
    v_xor_b32 v0, 64, v9
    ds_write_b128 v0, v[200:203]
    v_mfma_f32_32x32x16_bf16 v[64:79], v[228:231], a[52:55], v[64:79]
    ds_read_b128 v[228:231], v2 offset:4096
    v_fma_f32 v53, v53, s28, -v12
    v_add_f32 v43, v43, v47
    v_cvt_pk_bf16_f32 v185, v46, v47
    v_exp_f32 v44, v52
    v_mfma_f32_32x32x16_bf16 v[64:79], a[248:251], a[56:59], v[64:79]
    ds_read_b128 a[248:251], v1 offset:4608
    v_fma_f32 v54, v54, s28, -v12
    v_add_f32 v43, v43, v44
    v_exp_f32 v45, v53
    v_xor_b32 v0, 96, v9
    ds_write_b128 v0, v[204:207]
    v_mfma_f32_32x32x16_bf16 v[64:79], a[252:255], a[60:63], v[64:79]
    ds_read_b128 a[252:255], v2 offset:4608
    v_fma_f32 v55, v55, s28, -v12
    v_add_f32 v43, v43, v45
    v_cvt_pk_bf16_f32 v186, v44, v45
    v_exp_f32 v46, v54
    ds_read_b128 v[192:195], v10 offset:0
    v_mfma_f32_32x32x16_bf16 v[64:79], v[240:243], v[112:115], v[64:79]
    ds_read_b128 v[240:243], v1 offset:8192
    v_fma_f32 v56, v56, s28, -v12
    v_add_f32 v43, v43, v46
    v_exp_f32 v47, v55
    ds_read_b128 v[196:199], v10 offset:1024
    ds_read_b128 v[200:203], v10 offset:2048
    v_mfma_f32_32x32x16_bf16 v[64:79], v[244:247], v[116:119], v[64:79]
    ds_read_b128 v[244:247], v2 offset:8192
    v_fma_f32 v57, v57, s28, -v12
    v_add_f32 v43, v43, v47
    v_cvt_pk_bf16_f32 v187, v46, v47
    v_exp_f32 v44, v56
    ds_read_b128 v[204:207], v10 offset:3072
    v_mfma_f32_32x32x16_bf16 v[64:79], a[232:235], v[120:123], v[64:79]
    ds_read_b128 a[232:235], v1 offset:8704
    v_fma_f32 v58, v58, s28, -v12
    v_add_f32 v43, v43, v44
    v_exp_f32 v45, v57
    v_mfma_f32_32x32x16_bf16 v[64:79], a[236:239], v[124:127], v[64:79]
    ds_read_b128 a[236:239], v2 offset:8704
    v_fma_f32 v59, v59, s28, -v12
    v_add_f32 v43, v43, v45
    v_cvt_pk_bf16_f32 v188, v44, v45
    v_exp_f32 v46, v58
    v_mfma_f32_32x32x16_bf16 v[64:79], v[232:235], v[128:131], v[64:79]
    ds_read_b128 v[232:235], v1 offset:12288
    v_fma_f32 v60, v60, s28, -v12
    v_add_f32 v43, v43, v46
    v_exp_f32 v47, v59
    v_fma_f32 v61, v61, s28, -v12
    v_add_f32 v43, v43, v47
    v_cvt_pk_bf16_f32 v189, v46, v47
    v_exp_f32 v44, v60
    v_mfma_f32_32x32x16_bf16 v[64:79], v[236:239], v[132:135], v[64:79]
    ds_read_b128 v[236:239], v2 offset:12288
    v_fma_f32 v62, v62, s28, -v12
    v_add_f32 v43, v43, v44
    v_exp_f32 v45, v61
    v_fma_f32 v63, v63, s28, -v12
    v_add_f32 v43, v43, v45
    v_cvt_pk_bf16_f32 v190, v44, v45
    v_exp_f32 v46, v62
    v_mfma_f32_32x32x16_bf16 v[64:79], v[248:251], v[136:139], v[64:79]
    ds_read_b128 v[248:251], v1 offset:12800
    v_add_f32 v43, v43, v46
    v_exp_f32 v47, v63
    s_nop 0
    v_add_f32 v43, v43, v47
    v_cvt_pk_bf16_f32 v191, v46, v47
    v_mfma_f32_32x32x16_bf16 v[64:79], v[252:255], v[140:143], v[64:79]
    ds_read_b128 v[24:27], v7 offset:0
    ds_read_b128 v[252:255], v2 offset:12800
    v_cmp_ngt_f32 vcc, 2.0, v43
    s_cbranch_vccnz L_rare16
L_back16:
    v_add_f32 v40, v40, v43
    s_waitcnt vmcnt(20)
    s_barrier
    s_waitcnt lgkmcnt(15)
    v_mfma_f32_32x32x16_bf16 v[48:63], v[216:219], a[64:67], 0
    ds_read_b128 v[28:31], v8 offset:0
    s_add_u32 m0, s27, 81920
    s_add_u32 s29, s24, 180224
    buffer_load_dwordx4 v4, s[12:15], s29 offen offset:0 nt lds
    v_mfma_f32_32x32x16_bf16 v[48:63], v[220:223], a[68:71], v[48:63]
    ds_read_b128 a[208:211], v7 offset:512
    s_add_u32 m0, s27, 85888
    s_add_u32 s29, s24, 180224
    buffer_load_dwordx4 v4, s[12:15], s29 offen offset:128 nt lds
    v_mfma_f32_32x32x16_bf16 v[48:63], a[240:243], a[72:75], v[48:63]
    ds_read_b128 a[212:215], v8 offset:512
    v_fma_f32 v64, v64, s28, -v13
    v_fma_f32 v65, v65, s28, -v13
    v_exp_f32 v44, v64
    v_fma_f32 v66, v66, s28, -v13
    v_exp_f32 v45, v65
    v_mfma_f32_32x32x16_bf16 v[48:63], a[244:247], a[76:79], v[48:63]
    ds_read_b128 v[208:211], v7 offset:16384
    v_fma_f32 v67, v67, s28, -v13
    v_add_f32 v43, v44, v45
    v_cvt_pk_bf16_f32 v32, v44, v45
    v_accvgpr_write_b32 a168, v32
    s_waitcnt lgkmcnt(3)
    v_exp_f32 v46, v66
    v_mfma_f32_32x32x16_bf16 v[48:63], v[224:227], v[24:27], v[48:63]
    ds_read_b128 v[212:215], v8 offset:16384
    v_fma_f32 v68, v68, s28, -v13
    v_add_f32 v43, v43, v46
    v_exp_f32 v47, v67
    v_fma_f32 v69, v69, s28, -v13
    v_add_f32 v43, v43, v47
    v_cvt_pk_bf16_f32 v33, v46, v47
    v_accvgpr_write_b32 a169, v33
    v_exp_f32 v44, v68
    v_mfma_f32_32x32x16_bf16 v[48:63], v[228:231], v[28:31], v[48:63]
    ds_read_b128 a[216:219], v7 offset:16896
    v_fma_f32 v70, v70, s28, -v13
    v_add_f32 v43, v43, v44
    s_waitcnt lgkmcnt(3)
    v_exp_f32 v45, v69
    v_mfma_f32_32x32x16_bf16 v[48:63], a[248:251], a[208:211], v[48:63]
    ds_read_b128 a[220:223], v8 offset:16896
    v_fma_f32 v71, v71, s28, -v13
    v_add_f32 v43, v43, v45
    v_cvt_pk_bf16_f32 v32, v44, v45
    v_accvgpr_write_b32 a170, v32
    v_exp_f32 v46, v70
    v_mfma_f32_32x32x16_bf16 v[48:63], a[252:255], a[212:215], v[48:63]
    ds_read_b128 v[16:19], v7 offset:32768
    v_fma_f32 v72, v72, s28, -v13
    v_add_f32 v43, v43, v46
    s_waitcnt lgkmcnt(3)
    v_exp_f32 v47, v71
    v_mfma_f32_32x32x16_bf16 v[48:63], v[240:243], v[208:211], v[48:63]
    ds_read_b128 v[20:23], v8 offset:32768
    v_fma_f32 v73, v73, s28, -v13
    v_add_f32 v43, v43, v47
    v_cvt_pk_bf16_f32 v33, v46, v47
    v_accvgpr_write_b32 a171, v33
    v_exp_f32 v44, v72
    v_mfma_f32_32x32x16_bf16 v[48:63], v[244:247], v[212:215], v[48:63]
    ds_read_b128 v[24:27], v7 offset:33280
    v_fma_f32 v74, v74, s28, -v13
    v_add_f32 v43, v43, v44
    s_waitcnt lgkmcnt(3)
    v_exp_f32 v45, v73
    v_mfma_f32_32x32x16_bf16 v[48:63], a[232:235], a[216:219], v[48:63]
    ds_read_b128 v[28:31], v8 offset:33280
    v_fma_f32 v75, v75, s28, -v13
    v_add_f32 v43, v43, v45
    v_cvt_pk_bf16_f32 v32, v44, v45
    v_accvgpr_write_b32 a172, v32
    v_exp_f32 v46, v74
    v_mfma_f32_32x32x16_bf16 v[48:63], a[236:239], a[220:223], v[48:63]
    v_fma_f32 v76, v76, s28, -v13
    v_add_f32 v43, v43, v46
    v_exp_f32 v47, v75
    s_add_u32 s30, s32, 16768
    buffer_store_dwordx4 v[192:195], v11, s[20:23], s30 offen sc1
    s_waitcnt lgkmcnt(2)
    v_mfma_f32_32x32x16_bf16 v[48:63], v[232:235], v[16:19], v[48:63]
    v_fma_f32 v77, v77, s28, -v13
    v_add_f32 v43, v43, v47
    v_cvt_pk_bf16_f32 v33, v46, v47
    v_accvgpr_write_b32 a173, v33
    v_exp_f32 v44, v76
    v_fma_f32 v78, v78, s28, -v13
    v_add_f32 v43, v43, v44
    v_exp_f32 v45, v77
    v_mfma_f32_32x32x16_bf16 v[48:63], v[236:239], v[20:23], v[48:63]
    v_fma_f32 v79, v79, s28, -v13
    v_add_f32 v43, v43, v45
    v_cvt_pk_bf16_f32 v32, v44, v45
    v_accvgpr_write_b32 a174, v32
    s_waitcnt lgkmcnt(0)
    v_exp_f32 v46, v78
    v_mfma_f32_32x32x16_bf16 v[48:63], v[248:251], v[24:27], v[48:63]
    v_add_f32 v43, v43, v46
    v_exp_f32 v47, v79
    s_nop 0
    v_add_f32 v43, v43, v47
    v_cvt_pk_bf16_f32 v33, v46, v47
    v_accvgpr_write_b32 a175, v33
    v_mfma_f32_32x32x16_bf16 v[48:63], v[252:255], v[28:31], v[48:63]
    v_cmp_ngt_f32 vcc, 2.0, v43
    s_cbranch_vccnz L_rare17
L_back17:
    v_add_f32 v41, v41, v43
    v_mfma_f32_32x32x16_bf16 v[64:79], v[216:219], a[0:3], 0
    s_add_u32 m0, s27, 89856
    s_add_u32 s29, s24, 180224
    buffer_load_dwordx4 v4, s[12:15], s29 offen offset:256 nt lds
    v_mfma_f32_32x32x16_bf16 v[64:79], v[220:223], a[4:7], v[64:79]
    s_add_u32 m0, s27, 93824
    s_add_u32 s29, s24, 180224
    buffer_load_dwordx4 v4, s[12:15], s29 offen offset:384 nt lds
    v_mfma_f32_32x32x16_bf16 v[64:79], a[240:243], a[8:11], v[64:79]
    v_fma_f32 v48, v48, s28, -v14
    v_fma_f32 v49, v49, s28, -v14
    v_exp_f32 v44, v48
    v_fma_f32 v50, v50, s28, -v14
    v_exp_f32 v45, v49
    v_mfma_f32_32x32x16_bf16 v[64:79], a[244:247], a[12:15], v[64:79]
    v_fma_f32 v51, v51, s28, -v14
    v_add_f32 v43, v44, v45
    v_cvt_pk_bf16_f32 v32, v44, v45
    v_accvgpr_write_b32 a176, v32
    v_exp_f32 v46, v50
    v_mfma_f32_32x32x16_bf16 v[64:79], v[224:227], a[16:19], v[64:79]
    v_fma_f32 v52, v52, s28, -v14
    v_add_f32 v43, v43, v46
    v_exp_f32 v47, v51
    s_add_u32 s30, s32, 20864
    buffer_store_dwordx4 v[196:199], v11, s[20:23], s30 offen sc1
    v_mfma_f32_32x32x16_bf16 v[64:79], v[228:231], a[20:23], v[64:79]
    v_fma_f32 v53, v53, s28, -v14
    v_add_f32 v43, v43, v47
    v_cvt_pk_bf16_f32 v33, v46, v47
    v_accvgpr_write_b32 a177, v33
    v_exp_f32 v44, v52
    v_mfma_f32_32x32x16_bf16 v[64:79], a[248:251], a[24:27], v[64:79]
    v_fma_f32 v54, v54, s28, -v14
    v_add_f32 v43, v43, v44
    v_exp_f32 v45, v53
    v_mfma_f32_32x32x16_bf16 v[64:79], a[252:255], a[28:31], v[64:79]
    v_fma_f32 v55, v55, s28, -v14
    v_add_f32 v43, v43, v45
    v_cvt_pk_bf16_f32 v32, v44, v45
    v_accvgpr_write_b32 a178, v32
    v_exp_f32 v46, v54
    v_mfma_f32_32x32x16_bf16 v[64:79], v[240:243], v[80:83], v[64:79]
    v_fma_f32 v56, v56, s28, -v14
    v_add_f32 v43, v43, v46
    v_exp_f32 v47, v55
    s_add_u32 s30, s32, 24960
    buffer_store_dwordx4 v[200:203], v11, s[20:23], s30 offen sc1
    v_mfma_f32_32x32x16_bf16 v[64:79], v[244:247], v[84:87], v[64:79]
    v_fma_f32 v57, v57, s28, -v14
    v_add_f32 v43, v43, v47
    v_cvt_pk_bf16_f32 v33, v46, v47
    v_accvgpr_write_b32 a179, v33
    v_exp_f32 v44, v56
    v_mfma_f32_32x32x16_bf16 v[64:79], a[232:235], v[88:91], v[64:79]
    v_fma_f32 v58, v58, s28, -v14
    v_add_f32 v43, v43, v44
    v_exp_f32 v45, v57
    v_fma_f32 v59, v59, s28, -v14
    v_add_f32 v43, v43, v45
    v_cvt_pk_bf16_f32 v32, v44, v45
    v_accvgpr_write_b32 a180, v32
    v_exp_f32 v46, v58
    v_mfma_f32_32x32x16_bf16 v[64:79], a[236:239], v[92:95], v[64:79]
    v_fma_f32 v60, v60, s28, -v14
    v_add_f32 v43, v43, v46
    v_exp_f32 v47, v59
    v_mfma_f32_32x32x16_bf16 v[64:79], v[232:235], v[96:99], v[64:79]
    v_fma_f32 v61, v61, s28, -v14
    v_add_f32 v43, v43, v47
    v_cvt_pk_bf16_f32 v33, v46, v47
    v_accvgpr_write_b32 a181, v33
    v_exp_f32 v44, v60
    v_mfma_f32_32x32x16_bf16 v[64:79], v[236:239], v[100:103], v[64:79]
    v_fma_f32 v62, v62, s28, -v14
    v_add_f32 v43, v43, v44
    v_exp_f32 v45, v61
    v_fma_f32 v63, v63, s28, -v14
    v_add_f32 v43, v43, v45
    v_cvt_pk_bf16_f32 v32, v44, v45
    v_accvgpr_write_b32 a182, v32
    v_exp_f32 v46, v62
    v_mfma_f32_32x32x16_bf16 v[64:79], v[248:251], v[104:107], v[64:79]
    v_add_f32 v43, v43, v46
    v_exp_f32 v47, v63
    s_nop 0
    v_add_f32 v43, v43, v47
    v_cvt_pk_bf16_f32 v33, v46, v47
    v_accvgpr_write_b32 a183, v33
    v_mfma_f32_32x32x16_bf16 v[64:79], v[252:255], v[108:111], v[64:79]
    v_cmp_ngt_f32 vcc, 2.0, v43
    s_cbranch_vccnz L_rare18
L_back18:
    v_add_f32 v42, v42, v43
    s_add_u32 s30, s32, 29056
    buffer_store_dwordx4 v[204:207], v11, s[20:23], s30 offen sc1
    v_mfma_f32_32x32x16_bf16 v[48:63], v[216:219], a[32:35], 0
    ds_read_b128 v[216:219], v1 offset:16384
    v_mfma_f32_32x32x16_bf16 v[48:63], v[220:223], a[36:39], v[48:63]
    ds_read_b128 v[220:223], v2 offset:16384
    v_mfma_f32_32x32x16_bf16 v[48:63], a[240:243], a[40:43], v[48:63]
    ds_read_b128 a[240:243], v1 offset:16896
    s_nop 0
    v_fma_f32 v64, v64, s28, -v12
    v_fma_f32 v65, v65, s28, -v12
    v_exp_f32 v44, v64
    v_fma_f32 v66, v66, s28, -v12
    v_exp_f32 v45, v65
    v_mfma_f32_32x32x16_bf16 v[48:63], a[244:247], a[44:47], v[48:63]
    ds_read_b128 a[244:247], v2 offset:16896
    v_fma_f32 v67, v67, s28, -v12
    v_add_f32 v43, v44, v45
    v_cvt_pk_bf16_f32 v192, v44, v45
    v_exp_f32 v46, v66
    v_mfma_f32_32x32x16_bf16 v[48:63], v[224:227], a[48:51], v[48:63]
    ds_read_b128 v[224:227], v1 offset:20480
    v_fma_f32 v68, v68, s28, -v12
    v_add_f32 v43, v43, v46
    v_exp_f32 v47, v67
    v_mfma_f32_32x32x16_bf16 v[48:63], v[228:231], a[52:55], v[48:63]
    ds_read_b128 v[228:231], v2 offset:20480
    v_fma_f32 v69, v69, s28, -v12
    v_add_f32 v43, v43, v47
    v_cvt_pk_bf16_f32 v193, v46, v47
    v_exp_f32 v44, v68
    v_mfma_f32_32x32x16_bf16 v[48:63], a[248:251], a[56:59], v[48:63]
    ds_read_b128 a[248:251], v1 offset:20992
    v_fma_f32 v70, v70, s28, -v12
    v_add_f32 v43, v43, v44
    v_exp_f32 v45, v69
    v_mfma_f32_32x32x16_bf16 v[48:63], a[252:255], a[60:63], v[48:63]
    ds_read_b128 a[252:255], v2 offset:20992
    v_fma_f32 v71, v71, s28, -v12
    v_add_f32 v43, v43, v45
    v_cvt_pk_bf16_f32 v194, v44, v45
    v_exp_f32 v46, v70
    v_mfma_f32_32x32x16_bf16 v[48:63], v[240:243], v[112:115], v[48:63]
    ds_read_b128 v[240:243], v1 offset:24576
    v_fma_f32 v72, v72, s28, -v12
    v_add_f32 v43, v43, v46
    v_exp_f32 v47, v71
    v_mfma_f32_32x32x16_bf16 v[48:63], v[244:247], v[116:119], v[48:63]
    ds_read_b128 v[244:247], v2 offset:24576
    v_fma_f32 v73, v73, s28, -v12
    v_add_f32 v43, v43, v47
    v_cvt_pk_bf16_f32 v195, v46, v47
    v_exp_f32 v44, v72
    v_mfma_f32_32x32x16_bf16 v[48:63], a[232:235], v[120:123], v[48:63]
    ds_read_b128 a[232:235], v1 offset:25088
    v_fma_f32 v74, v74, s28, -v12
    v_add_f32 v43, v43, v44
    v_exp_f32 v45, v73
    v_mfma_f32_32x32x16_bf16 v[48:63], a[236:239], v[124:127], v[48:63]
    ds_read_b128 a[236:239], v2 offset:25088
    v_fma_f32 v75, v75, s28, -v12
    v_add_f32 v43, v43, v45
    v_cvt_pk_bf16_f32 v196, v44, v45
    v_exp_f32 v46, v74
    v_mfma_f32_32x32x16_bf16 v[48:63], v[232:235], v[128:131], v[48:63]
    ds_read_b128 v[232:235], v1 offset:28672
    v_fma_f32 v76, v76, s28, -v12
    v_add_f32 v43, v43, v46
    v_exp_f32 v47, v75
    v_fma_f32 v77, v77, s28, -v12
    v_add_f32 v43, v43, v47
    v_cvt_pk_bf16_f32 v197, v46, v47
    v_exp_f32 v44, v76
    v_mfma_f32_32x32x16_bf16 v[48:63], v[236:239], v[132:135], v[48:63]
    ds_read_b128 v[236:239], v2 offset:28672
    v_fma_f32 v78, v78, s28, -v12
    v_add_f32 v43, v43, v44
    v_exp_f32 v45, v77
    v_fma_f32 v79, v79, s28, -v12
    v_add_f32 v43, v43, v45
    v_cvt_pk_bf16_f32 v198, v44, v45
    v_exp_f32 v46, v78
    v_mfma_f32_32x32x16_bf16 v[48:63], v[248:251], v[136:139], v[48:63]
    ds_read_b128 v[248:251], v1 offset:29184
    v_add_f32 v43, v43, v46
    v_exp_f32 v47, v79
    s_nop 0
    v_add_f32 v43, v43, v47
    v_cvt_pk_bf16_f32 v199, v46, v47
    v_mfma_f32_32x32x16_bf16 v[48:63], v[252:255], v[140:143], v[48:63]
    ds_read_b128 a[208:211], v7 offset:0
    ds_read_b128 v[252:255], v2 offset:29184
    v_cmp_ngt_f32 vcc, 2.0, v43
    s_cbranch_vccnz L_rare19
L_back19:
    v_add_f32 v40, v40, v43
    s_waitcnt vmcnt(22)
    s_barrier
    s_mov_b32 s22, 100663296
    s_waitcnt lgkmcnt(15)
    v_mfma_f32_32x32x16_bf16 v[64:79], v[216:219], a[64:67], 0
    ds_read_b128 a[212:215], v8 offset:0
    s_add_u32 m0, s27, 0
    s_add_u32 s29, s24, 0
    buffer_load_dwordx4 v5, s[16:19], s29 offen nt lds
    v_mfma_f32_32x32x16_bf16 v[64:79], v[220:223], a[68:71], v[64:79]
    ds_read_b128 v[208:211], v7 offset:512
    s_add_u32 m0, s27, 4096
    s_add_u32 s29, s24, 16384
    buffer_load_dwordx4 v5, s[16:19], s29 offen nt lds
    s_waitcnt lgkmcnt(15)
    v_mfma_f32_32x32x16_bf16 v[64:79], a[240:243], a[72:75], v[64:79]
    ds_read_b128 v[212:215], v8 offset:512
    v_fma_f32 v48, v48, s28, -v13
    v_fma_f32 v49, v49, s28, -v13
    v_exp_f32 v44, v48
    v_fma_f32 v50, v50, s28, -v13
    v_exp_f32 v45, v49
    v_mfma_f32_32x32x16_bf16 v[64:79], a[244:247], a[76:79], v[64:79]
    ds_read_b128 a[216:219], v7 offset:16384
    v_fma_f32 v51, v51, s28, -v13
    v_add_f32 v43, v44, v45
    v_cvt_pk_bf16_f32 v32, v44, v45
    v_accvgpr_write_b32 a184, v32
    s_waitcnt lgkmcnt(3)
    v_exp_f32 v46, v50
    v_mfma_f32_32x32x16_bf16 v[64:79], v[224:227], a[208:211], v[64:79]
    ds_read_b128 a[220:223], v8 offset:16384
    v_fma_f32 v52, v52, s28, -v13
    v_add_f32 v43, v43, v46
    v_exp_f32 v47, v51
    v_fma_f32 v53, v53, s28, -v13
    v_add_f32 v43, v43, v47
    v_cvt_pk_bf16_f32 v33, v46, v47
    v_accvgpr_write_b32 a185, v33
    v_exp_f32 v44, v52
    v_mfma_f32_32x32x16_bf16 v[64:79], v[228:231], a[212:215], v[64:79]
    ds_read_b128 v[16:19], v7 offset:16896
    v_fma_f32 v54, v54, s28, -v13
    v_add_f32 v43, v43, v44
    s_waitcnt lgkmcnt(3)
    v_exp_f32 v45, v53
    v_mfma_f32_32x32x16_bf16 v[64:79], a[248:251], v[208:211], v[64:79]
    ds_read_b128 v[20:23], v8 offset:16896
    v_fma_f32 v55, v55, s28, -v13
    v_add_f32 v43, v43, v45
    v_cvt_pk_bf16_f32 v32, v44, v45
    v_accvgpr_write_b32 a186, v32
    v_exp_f32 v46, v54
    v_mfma_f32_32x32x16_bf16 v[64:79], a[252:255], v[212:215], v[64:79]
    ds_read_b128 v[24:27], v7 offset:32768
    v_fma_f32 v56, v56, s28, -v13
    v_add_f32 v43, v43, v46
    s_waitcnt lgkmcnt(3)
    v_exp_f32 v47, v55
    v_mfma_f32_32x32x16_bf16 v[64:79], v[240:243], a[216:219], v[64:79]
    ds_read_b128 v[28:31], v8 offset:32768
    v_fma_f32 v57, v57, s28, -v13
    v_add_f32 v43, v43, v47
    v_cvt_pk_bf16_f32 v33, v46, v47
    v_accvgpr_write_b32 a187, v33
    v_exp_f32 v44, v56
    v_mfma_f32_32x32x16_bf16 v[64:79], v[244:247], a[220:223], v[64:79]
    ds_read_b128 a[208:211], v7 offset:33280
    v_fma_f32 v58, v58, s28, -v13
    v_add_f32 v43, v43, v44
    s_waitcnt lgkmcnt(3)
    v_exp_f32 v45, v57
    v_mfma_f32_32x32x16_bf16 v[64:79], a[232:235], v[16:19], v[64:79]
    ds_read_b128 a[212:215], v8 offset:33280
    v_fma_f32 v59, v59, s28, -v13
    v_add_f32 v43, v43, v45
    v_cvt_pk_bf16_f32 v32, v44, v45
    v_accvgpr_write_b32 a188, v32
    v_exp_f32 v46, v58
    v_mfma_f32_32x32x16_bf16 v[64:79], a[236:239], v[20:23], v[64:79]
    v_fma_f32 v60, v60, s28, -v13
    v_add_f32 v43, v43, v46
    s_waitcnt lgkmcnt(2)
    v_exp_f32 v47, v59
    v_mfma_f32_32x32x16_bf16 v[64:79], v[232:235], v[24:27], v[64:79]
    v_fma_f32 v61, v61, s28, -v13
    v_add_f32 v43, v43, v47
    v_cvt_pk_bf16_f32 v33, v46, v47
    v_accvgpr_write_b32 a189, v33
    v_exp_f32 v44, v60
    v_fma_f32 v62, v62, s28, -v13
    v_add_f32 v43, v43, v44
    v_exp_f32 v45, v61
    v_mfma_f32_32x32x16_bf16 v[64:79], v[236:239], v[28:31], v[64:79]
    v_fma_f32 v63, v63, s28, -v13
    v_add_f32 v43, v43, v45
    v_cvt_pk_bf16_f32 v32, v44, v45
    v_accvgpr_write_b32 a190, v32
    s_waitcnt lgkmcnt(0)
    v_exp_f32 v46, v62
    v_mfma_f32_32x32x16_bf16 v[64:79], v[248:251], a[208:211], v[64:79]
    v_add_f32 v43, v43, v46
    v_exp_f32 v47, v63
    s_nop 0
    v_add_f32 v43, v43, v47
    v_cvt_pk_bf16_f32 v33, v46, v47
    v_accvgpr_write_b32 a191, v33
    v_mfma_f32_32x32x16_bf16 v[64:79], v[252:255], a[212:215], v[64:79]
    v_cmp_ngt_f32 vcc, 2.0, v43
    s_cbranch_vccnz L_rare20
L_back20:
    v_add_f32 v41, v41, v43
    v_mfma_f32_32x32x16_bf16 v[48:63], v[216:219], a[0:3], 0
    s_add_u32 m0, s27, 8192
    s_add_u32 s29, s24, 32768
    buffer_load_dwordx4 v5, s[16:19], s29 offen nt lds
    v_mfma_f32_32x32x16_bf16 v[48:63], v[220:223], a[4:7], v[48:63]
    s_add_u32 m0, s27, 12288
    s_add_u32 s29, s24, 49152
    buffer_load_dwordx4 v5, s[16:19], s29 offen nt lds
    v_mfma_f32_32x32x16_bf16 v[48:63], a[240:243], a[8:11], v[48:63]
    v_fma_f32 v64, v64, s28, -v14
    v_fma_f32 v65, v65, s28, -v14
    v_exp_f32 v44, v64
    v_fma_f32 v66, v66, s28, -v14
    v_exp_f32 v45, v65
    v_mfma_f32_32x32x16_bf16 v[48:63], a[244:247], a[12:15], v[48:63]
    v_fma_f32 v67, v67, s28, -v14
    v_add_f32 v43, v44, v45
    v_cvt_pk_bf16_f32 v32, v44, v45
    v_accvgpr_write_b32 a192, v32
    v_exp_f32 v46, v66
    v_mfma_f32_32x32x16_bf16 v[48:63], v[224:227], a[16:19], v[48:63]
    v_fma_f32 v68, v68, s28, -v14
    v_add_f32 v43, v43, v46
    v_exp_f32 v47, v67
    v_mfma_f32_32x32x16_bf16 v[48:63], v[228:231], a[20:23], v[48:63]
    v_fma_f32 v69, v69, s28, -v14
    v_add_f32 v43, v43, v47
    v_cvt_pk_bf16_f32 v33, v46, v47
    v_accvgpr_write_b32 a193, v33
    v_exp_f32 v44, v68
    v_mfma_f32_32x32x16_bf16 v[48:63], a[248:251], a[24:27], v[48:63]
    v_fma_f32 v70, v70, s28, -v14
    v_add_f32 v43, v43, v44
    v_exp_f32 v45, v69
    v_mfma_f32_32x32x16_bf16 v[48:63], a[252:255], a[28:31], v[48:63]
    v_fma_f32 v71, v71, s28, -v14
    v_add_f32 v43, v43, v45
    v_cvt_pk_bf16_f32 v32, v44, v45
    v_accvgpr_write_b32 a194, v32
    v_exp_f32 v46, v70
    v_mfma_f32_32x32x16_bf16 v[48:63], v[240:243], v[80:83], v[48:63]
    v_fma_f32 v72, v72, s28, -v14
    v_add_f32 v43, v43, v46
    v_exp_f32 v47, v71
    v_mfma_f32_32x32x16_bf16 v[48:63], v[244:247], v[84:87], v[48:63]
    v_fma_f32 v73, v73, s28, -v14
    v_add_f32 v43, v43, v47
    v_cvt_pk_bf16_f32 v33, v46, v47
    v_accvgpr_write_b32 a195, v33
    v_exp_f32 v44, v72
    v_mfma_f32_32x32x16_bf16 v[48:63], a[232:235], v[88:91], v[48:63]
    v_fma_f32 v74, v74, s28, -v14
    v_add_f32 v43, v43, v44
    v_exp_f32 v45, v73
    v_fma_f32 v75, v75, s28, -v14
    v_add_f32 v43, v43, v45
    v_cvt_pk_bf16_f32 v32, v44, v45
    v_accvgpr_write_b32 a196, v32
    v_exp_f32 v46, v74
    v_mfma_f32_32x32x16_bf16 v[48:63], a[236:239], v[92:95], v[48:63]
    v_fma_f32 v76, v76, s28, -v14
    v_add_f32 v43, v43, v46
    v_exp_f32 v47, v75
    v_mfma_f32_32x32x16_bf16 v[48:63], v[232:235], v[96:99], v[48:63]
    v_fma_f32 v77, v77, s28, -v14
    v_add_f32 v43, v43, v47
    v_cvt_pk_bf16_f32 v33, v46, v47
    v_accvgpr_write_b32 a197, v33
    v_exp_f32 v44, v76
    v_mfma_f32_32x32x16_bf16 v[48:63], v[236:239], v[100:103], v[48:63]
    v_fma_f32 v78, v78, s28, -v14
    v_add_f32 v43, v43, v44
    v_exp_f32 v45, v77
    v_fma_f32 v79, v79, s28, -v14
    v_add_f32 v43, v43, v45
    v_cvt_pk_bf16_f32 v32, v44, v45
    v_accvgpr_write_b32 a198, v32
    v_exp_f32 v46, v78
    v_mfma_f32_32x32x16_bf16 v[48:63], v[248:251], v[104:107], v[48:63]
    v_add_f32 v43, v43, v46
    v_exp_f32 v47, v79
    s_nop 0
    v_add_f32 v43, v43, v47
    v_cvt_pk_bf16_f32 v33, v46, v47
    v_accvgpr_write_b32 a199, v33
    v_mfma_f32_32x32x16_bf16 v[48:63], v[252:255], v[108:111], v[48:63]
    v_cmp_ngt_f32 vcc, 2.0, v43
    s_cbranch_vccnz L_rare21
L_back21:
    v_add_f32 v42, v42, v43
    v_mfma_f32_32x32x16_bf16 v[64:79], v[216:219], a[32:35], 0
    ds_read_b128 v[216:219], v1 offset:32768
    v_mfma_f32_32x32x16_bf16 v[64:79], v[220:223], a[36:39], v[64:79]
    ds_read_b128 v[220:223], v2 offset:32768
    v_mfma_f32_32x32x16_bf16 v[64:79], a[240:243], a[40:43], v[64:79]
    ds_read_b128 a[240:243], v1 offset:33280
    s_nop 2
    v_fma_f32 v48, v48, s28, -v12
    v_fma_f32 v49, v49, s28, -v12
    v_exp_f32 v44, v48
    v_fma_f32 v50, v50, s28, -v12
    v_exp_f32 v45, v49
    v_mfma_f32_32x32x16_bf16 v[64:79], a[244:247], a[44:47], v[64:79]
    ds_read_b128 a[244:247], v2 offset:33280
    v_fma_f32 v51, v51, s28, -v12
    v_add_f32 v43, v44, v45
    v_cvt_pk_bf16_f32 v200, v44, v45
    v_exp_f32 v46, v50
    v_mfma_f32_32x32x16_bf16 v[64:79], v[224:227], a[48:51], v[64:79]
    ds_read_b128 v[224:227], v1 offset:36864
    v_fma_f32 v52, v52, s28, -v12
    v_add_f32 v43, v43, v46
    v_exp_f32 v47, v51
    v_mfma_f32_32x32x16_bf16 v[64:79], v[228:231], a[52:55], v[64:79]
    ds_read_b128 v[228:231], v2 offset:36864
    v_fma_f32 v53, v53, s28, -v12
    v_add_f32 v43, v43, v47
    v_cvt_pk_bf16_f32 v201, v46, v47
    v_exp_f32 v44, v52
    v_mfma_f32_32x32x16_bf16 v[64:79], a[248:251], a[56:59], v[64:79]
    ds_read_b128 a[248:251], v1 offset:37376
    v_fma_f32 v54, v54, s28, -v12
    v_add_f32 v43, v43, v44
    v_exp_f32 v45, v53
    v_mfma_f32_32x32x16_bf16 v[64:79], a[252:255], a[60:63], v[64:79]
    ds_read_b128 a[252:255], v2 offset:37376
    v_fma_f32 v55, v55, s28, -v12
    v_add_f32 v43, v43, v45
    v_cvt_pk_bf16_f32 v202, v44, v45
    v_exp_f32 v46, v54
    v_mfma_f32_32x32x16_bf16 v[64:79], v[240:243], v[112:115], v[64:79]
    ds_read_b128 v[240:243], v1 offset:40960
    v_fma_f32 v56, v56, s28, -v12
    v_add_f32 v43, v43, v46
    v_exp_f32 v47, v55
    v_mfma_f32_32x32x16_bf16 v[64:79], v[244:247], v[116:119], v[64:79]
    ds_read_b128 v[244:247], v2 offset:40960
    v_fma_f32 v57, v57, s28, -v12
    v_add_f32 v43, v43, v47
    v_cvt_pk_bf16_f32 v203, v46, v47
    v_exp_f32 v44, v56
    v_mfma_f32_32x32x16_bf16 v[64:79], a[232:235], v[120:123], v[64:79]
    ds_read_b128 a[232:235], v1 offset:41472
    v_fma_f32 v58, v58, s28, -v12
    v_add_f32 v43, v43, v44
    v_exp_f32 v45, v57
    v_mfma_f32_32x32x16_bf16 v[64:79], a[236:239], v[124:127], v[64:79]
    ds_read_b128 a[236:239], v2 offset:41472
    v_fma_f32 v59, v59, s28, -v12
    v_add_f32 v43, v43, v45
    v_cvt_pk_bf16_f32 v204, v44, v45
    v_exp_f32 v46, v58
    v_mfma_f32_32x32x16_bf16 v[64:79], v[232:235], v[128:131], v[64:79]
    ds_read_b128 v[232:235], v1 offset:45056
    v_fma_f32 v60, v60, s28, -v12
    v_add_f32 v43, v43, v46
    v_exp_f32 v47, v59
    v_fma_f32 v61, v61, s28, -v12
    v_add_f32 v43, v43, v47
    v_cvt_pk_bf16_f32 v205, v46, v47
    v_exp_f32 v44, v60
    v_mfma_f32_32x32x16_bf16 v[64:79], v[236:239], v[132:135], v[64:79]
    ds_read_b128 v[236:239], v2 offset:45056
    v_fma_f32 v62, v62, s28, -v12
    v_add_f32 v43, v43, v44
    v_exp_f32 v45, v61
    v_fma_f32 v63, v63, s28, -v12
    v_add_f32 v43, v43, v45
    v_cvt_pk_bf16_f32 v206, v44, v45
    v_exp_f32 v46, v62
    v_mfma_f32_32x32x16_bf16 v[64:79], v[248:251], v[136:139], v[64:79]
    ds_read_b128 v[248:251], v1 offset:45568
    v_add_f32 v43, v43, v46
    v_exp_f32 v47, v63
    s_nop 0
    v_add_f32 v43, v43, v47
    v_cvt_pk_bf16_f32 v207, v46, v47
    v_mfma_f32_32x32x16_bf16 v[64:79], v[252:255], v[140:143], v[64:79]
    ds_read_b128 v[208:211], v7 offset:0
    ds_read_b128 v[252:255], v2 offset:45568
    v_cmp_ngt_f32 vcc, 2.0, v43
    s_cbranch_vccnz L_rare22
L_back22:
    v_add_f32 v40, v40, v43
    s_waitcnt vmcnt(20)
    s_barrier
    s_waitcnt lgkmcnt(15)
    v_mfma_f32_32x32x16_bf16 v[48:63], v[216:219], a[64:67], 0
    ds_read_b128 v[212:215], v8 offset:0
    s_add_u32 m0, s27, 16384
    s_add_u32 s29, s24, 65536
    buffer_load_dwordx4 v5, s[16:19], s29 offen nt lds
    v_mfma_f32_32x32x16_bf16 v[48:63], v[220:223], a[68:71], v[48:63]
    ds_read_b128 a[216:219], v7 offset:512
    s_add_u32 m0, s27, 20480
    s_add_u32 s29, s24, 81920
    buffer_load_dwordx4 v5, s[16:19], s29 offen nt lds
    s_waitcnt lgkmcnt(15)
    v_mfma_f32_32x32x16_bf16 v[48:63], a[240:243], a[72:75], v[48:63]
    ds_read_b128 a[220:223], v8 offset:512
    v_fma_f32 v64, v64, s28, -v13
    v_fma_f32 v65, v65, s28, -v13
    v_exp_f32 v44, v64
    v_fma_f32 v66, v66, s28, -v13
    v_exp_f32 v45, v65
    v_mfma_f32_32x32x16_bf16 v[48:63], a[244:247], a[76:79], v[48:63]
    ds_read_b128 v[16:19], v7 offset:16384
    v_fma_f32 v67, v67, s28, -v13
    v_add_f32 v43, v44, v45
    v_cvt_pk_bf16_f32 v32, v44, v45
    v_accvgpr_write_b32 a200, v32
    s_waitcnt lgkmcnt(3)
    v_exp_f32 v46, v66
    v_mfma_f32_32x32x16_bf16 v[48:63], v[224:227], v[208:211], v[48:63]
    ds_read_b128 v[20:23], v8 offset:16384
    v_fma_f32 v68, v68, s28, -v13
    v_add_f32 v43, v43, v46
    v_exp_f32 v47, v67
    v_fma_f32 v69, v69, s28, -v13
    v_add_f32 v43, v43, v47
    v_cvt_pk_bf16_f32 v33, v46, v47
    v_accvgpr_write_b32 a201, v33
    v_exp_f32 v44, v68
    v_mfma_f32_32x32x16_bf16 v[48:63], v[228:231], v[212:215], v[48:63]
    ds_read_b128 v[24:27], v7 offset:16896
    v_fma_f32 v70, v70, s28, -v13
    v_add_f32 v43, v43, v44
    s_waitcnt lgkmcnt(3)
    v_exp_f32 v45, v69
    v_mfma_f32_32x32x16_bf16 v[48:63], a[248:251], a[216:219], v[48:63]
    ds_read_b128 v[28:31], v8 offset:16896
    v_fma_f32 v71, v71, s28, -v13
    v_add_f32 v43, v43, v45
    v_cvt_pk_bf16_f32 v32, v44, v45
    v_accvgpr_write_b32 a202, v32
    v_exp_f32 v46, v70
    v_mfma_f32_32x32x16_bf16 v[48:63], a[252:255], a[220:223], v[48:63]
    ds_read_b128 a[208:211], v7 offset:32768
    v_fma_f32 v72, v72, s28, -v13
    v_add_f32 v43, v43, v46
    s_waitcnt lgkmcnt(3)
    v_exp_f32 v47, v71
    v_mfma_f32_32x32x16_bf16 v[48:63], v[240:243], v[16:19], v[48:63]
    ds_read_b128 a[212:215], v8 offset:32768
    v_fma_f32 v73, v73, s28, -v13
    v_add_f32 v43, v43, v47
    v_cvt_pk_bf16_f32 v33, v46, v47
    v_accvgpr_write_b32 a203, v33
    v_exp_f32 v44, v72
    v_mfma_f32_32x32x16_bf16 v[48:63], v[244:247], v[20:23], v[48:63]
    ds_read_b128 v[208:211], v7 offset:33280
    v_fma_f32 v74, v74, s28, -v13
    v_add_f32 v43, v43, v44
    s_waitcnt lgkmcnt(3)
    v_exp_f32 v45, v73
    v_mfma_f32_32x32x16_bf16 v[48:63], a[232:235], v[24:27], v[48:63]
    ds_read_b128 v[212:215], v8 offset:33280
    v_fma_f32 v75, v75, s28, -v13
    v_add_f32 v43, v43, v45
    v_cvt_pk_bf16_f32 v32, v44, v45
    v_accvgpr_write_b32 a204, v32
    v_exp_f32 v46, v74
    v_mfma_f32_32x32x16_bf16 v[48:63], a[236:239], v[28:31], v[48:63]
    v_fma_f32 v76, v76, s28, -v13
    v_add_f32 v43, v43, v46
    s_waitcnt lgkmcnt(2)
    v_exp_f32 v47, v75
    v_mfma_f32_32x32x16_bf16 v[48:63], v[232:235], a[208:211], v[48:63]
    v_fma_f32 v77, v77, s28, -v13
    v_add_f32 v43, v43, v47
    v_cvt_pk_bf16_f32 v33, v46, v47
    v_accvgpr_write_b32 a205, v33
    v_exp_f32 v44, v76
    v_fma_f32 v78, v78, s28, -v13
    v_add_f32 v43, v43, v44
    v_exp_f32 v45, v77
    v_mfma_f32_32x32x16_bf16 v[48:63], v[236:239], a[212:215], v[48:63]
    v_fma_f32 v79, v79, s28, -v13
    v_add_f32 v43, v43, v45
    v_cvt_pk_bf16_f32 v32, v44, v45
    v_accvgpr_write_b32 a206, v32
    s_waitcnt lgkmcnt(0)
    v_exp_f32 v46, v78
    v_mfma_f32_32x32x16_bf16 v[48:63], v[248:251], v[208:211], v[48:63]
    v_add_f32 v43, v43, v46
    v_exp_f32 v47, v79
    s_nop 0
    v_add_f32 v43, v43, v47
    v_cvt_pk_bf16_f32 v33, v46, v47
    v_accvgpr_write_b32 a207, v33
    v_mfma_f32_32x32x16_bf16 v[48:63], v[252:255], v[212:215], v[48:63]
    v_cmp_ngt_f32 vcc, 2.0, v43
    s_cbranch_vccnz L_rare23
L_back23:
    v_add_f32 v41, v41, v43
    v_mfma_f32_32x32x16_bf16 v[64:79], v[216:219], a[0:3], 0
    s_add_u32 m0, s27, 24576
    s_add_u32 s29, s24, 98304
    buffer_load_dwordx4 v5, s[16:19], s29 offen nt lds
    v_mfma_f32_32x32x16_bf16 v[64:79], v[220:223], a[4:7], v[64:79]
    s_add_u32 m0, s27, 28672
    s_add_u32 s29, s24, 114688
    buffer_load_dwordx4 v5, s[16:19], s29 offen nt lds
    v_mfma_f32_32x32x16_bf16 v[64:79], a[240:243], a[8:11], v[64:79]
    v_fma_f32 v48, v48, s28, -v14
    v_fma_f32 v49, v49, s28, -v14
    v_exp_f32 v44, v48
    v_fma_f32 v50, v50, s28, -v14
    v_exp_f32 v45, v49
    v_mfma_f32_32x32x16_bf16 v[64:79], a[244:247], a[12:15], v[64:79]
    v_fma_f32 v51, v51, s28, -v14
    v_add_f32 v43, v44, v45
    v_cvt_pk_bf16_f32 v32, v44, v45
    v_accvgpr_write_b32 a208, v32
    v_exp_f32 v46, v50
    v_mfma_f32_32x32x16_bf16 v[64:79], v[224:227], a[16:19], v[64:79]
    v_fma_f32 v52, v52, s28, -v14
    v_add_f32 v43, v43, v46
    v_exp_f32 v47, v51
    v_mfma_f32_32x32x16_bf16 v[64:79], v[228:231], a[20:23], v[64:79]
    v_fma_f32 v53, v53, s28, -v14
    v_add_f32 v43, v43, v47
    v_cvt_pk_bf16_f32 v33, v46, v47
    v_accvgpr_write_b32 a209, v33
    v_exp_f32 v44, v52
    v_mfma_f32_32x32x16_bf16 v[64:79], a[248:251], a[24:27], v[64:79]
    v_fma_f32 v54, v54, s28, -v14
    v_add_f32 v43, v43, v44
    v_exp_f32 v45, v53
    v_mfma_f32_32x32x16_bf16 v[64:79], a[252:255], a[28:31], v[64:79]
    v_fma_f32 v55, v55, s28, -v14
    v_add_f32 v43, v43, v45
    v_cvt_pk_bf16_f32 v32, v44, v45
    v_accvgpr_write_b32 a210, v32
    v_exp_f32 v46, v54
    v_mfma_f32_32x32x16_bf16 v[64:79], v[240:243], v[80:83], v[64:79]
    v_fma_f32 v56, v56, s28, -v14
    v_add_f32 v43, v43, v46
    v_exp_f32 v47, v55
    v_mfma_f32_32x32x16_bf16 v[64:79], v[244:247], v[84:87], v[64:79]
    v_fma_f32 v57, v57, s28, -v14
    v_add_f32 v43, v43, v47
    v_cvt_pk_bf16_f32 v33, v46, v47
    v_accvgpr_write_b32 a211, v33
    v_exp_f32 v44, v56
    v_mfma_f32_32x32x16_bf16 v[64:79], a[232:235], v[88:91], v[64:79]
    v_fma_f32 v58, v58, s28, -v14
    v_add_f32 v43, v43, v44
    v_exp_f32 v45, v57
    v_fma_f32 v59, v59, s28, -v14
    v_add_f32 v43, v43, v45
    v_cvt_pk_bf16_f32 v32, v44, v45
    v_accvgpr_write_b32 a212, v32
    v_exp_f32 v46, v58
    v_mfma_f32_32x32x16_bf16 v[64:79], a[236:239], v[92:95], v[64:79]
    v_fma_f32 v60, v60, s28, -v14
    v_add_f32 v43, v43, v46
    v_exp_f32 v47, v59
    v_mfma_f32_32x32x16_bf16 v[64:79], v[232:235], v[96:99], v[64:79]
    v_fma_f32 v61, v61, s28, -v14
    v_add_f32 v43, v43, v47
    v_cvt_pk_bf16_f32 v33, v46, v47
    v_accvgpr_write_b32 a213, v33
    v_exp_f32 v44, v60
    v_mfma_f32_32x32x16_bf16 v[64:79], v[236:239], v[100:103], v[64:79]
    v_fma_f32 v62, v62, s28, -v14
    v_add_f32 v43, v43, v44
    v_exp_f32 v45, v61
    v_fma_f32 v63, v63, s28, -v14
    v_add_f32 v43, v43, v45
    v_cvt_pk_bf16_f32 v32, v44, v45
    v_accvgpr_write_b32 a214, v32
    v_exp_f32 v46, v62
    v_mfma_f32_32x32x16_bf16 v[64:79], v[248:251], v[104:107], v[64:79]
    v_add_f32 v43, v43, v46
    v_exp_f32 v47, v63
    s_nop 0
    v_add_f32 v43, v43, v47
    v_cvt_pk_bf16_f32 v33, v46, v47
    v_accvgpr_write_b32 a215, v33
    v_mfma_f32_32x32x16_bf16 v[64:79], v[252:255], v[108:111], v[64:79]
    v_cmp_ngt_f32 vcc, 2.0, v43
    s_cbranch_vccnz L_rare24
L_back24:
    v_add_f32 v42, v42, v43
    v_mfma_f32_32x32x16_bf16 v[48:63], v[216:219], a[32:35], 0
    v_mfma_f32_32x32x16_bf16 v[48:63], v[220:223], a[36:39], v[48:63]
    v_mfma_f32_32x32x16_bf16 v[48:63], a[240:243], a[40:43], v[48:63]
    v_xor_b32 v1, 0xc000, v1
    v_xor_b32 v2, 0xc000, v2
    ds_read_b128 a[240:243], v1 offset:512
    s_nop 2
    v_fma_f32 v64, v64, s28, -v12
    v_fma_f32 v65, v65, s28, -v12
    v_exp_f32 v44, v64
    v_mfma_f32_32x32x16_bf16 v[48:63], a[244:247], a[44:47], v[48:63]
    ds_read_b128 a[244:247], v2 offset:512
    v_fma_f32 v66, v66, s28, -v12
    v_exp_f32 v45, v65
    v_fma_f32 v67, v67, s28, -v12
    v_add_f32 v43, v44, v45
    v_cvt_pk_bf16_f32 v208, v44, v45
    v_exp_f32 v46, v66
    v_mfma_f32_32x32x16_bf16 v[48:63], v[224:227], a[48:51], v[48:63]
    ds_read_b128 v[224:227], v1 offset:4096
    v_fma_f32 v68, v68, s28, -v12
    v_add_f32 v43, v43, v46
    v_exp_f32 v47, v67
    v_mfma_f32_32x32x16_bf16 v[48:63], v[228:231], a[52:55], v[48:63]
    ds_read_b128 v[228:231], v2 offset:4096
    v_fma_f32 v69, v69, s28, -v12
    v_add_f32 v43, v43, v47
    v_cvt_pk_bf16_f32 v209, v46, v47
    v_exp_f32 v44, v68
    v_mfma_f32_32x32x16_bf16 v[48:63], a[248:251], a[56:59], v[48:63]
    ds_read_b128 a[248:251], v1 offset:4608
    v_fma_f32 v70, v70, s28, -v12
    v_add_f32 v43, v43, v44
    v_exp_f32 v45, v69
    v_mfma_f32_32x32x16_bf16 v[48:63], a[252:255], a[60:63], v[48:63]
    ds_read_b128 a[252:255], v2 offset:4608
    v_fma_f32 v71, v71, s28, -v12
    v_add_f32 v43, v43, v45
    v_cvt_pk_bf16_f32 v210, v44, v45
    v_exp_f32 v46, v70
    v_mfma_f32_32x32x16_bf16 v[48:63], v[240:243], v[112:115], v[48:63]
    ds_read_b128 v[240:243], v1 offset:8192
    v_fma_f32 v72, v72, s28, -v12
    v_add_f32 v43, v43, v46
    v_exp_f32 v47, v71
    v_mfma_f32_32x32x16_bf16 v[48:63], v[244:247], v[116:119], v[48:63]
    ds_read_b128 v[244:247], v2 offset:8192
    v_fma_f32 v73, v73, s28, -v12
    v_add_f32 v43, v43, v47
    v_cvt_pk_bf16_f32 v211, v46, v47
    v_exp_f32 v44, v72
    v_mfma_f32_32x32x16_bf16 v[48:63], a[232:235], v[120:123], v[48:63]
    v_fma_f32 v74, v74, s28, -v12
    v_add_f32 v43, v43, v44
    v_exp_f32 v45, v73
    v_fma_f32 v75, v75, s28, -v12
    v_add_f32 v43, v43, v45
    v_cvt_pk_bf16_f32 v212, v44, v45
    v_exp_f32 v46, v74
    v_mfma_f32_32x32x16_bf16 v[48:63], a[236:239], v[124:127], v[48:63]
    ds_read_b128 v[16:19], v1 offset:0
    v_fma_f32 v76, v76, s28, -v12
    v_add_f32 v43, v43, v46
    v_exp_f32 v47, v75
    v_fma_f32 v77, v77, s28, -v12
    v_add_f32 v43, v43, v47
    v_cvt_pk_bf16_f32 v213, v46, v47
    v_exp_f32 v44, v76
    v_mfma_f32_32x32x16_bf16 v[48:63], v[232:235], v[128:131], v[48:63]
    ds_read_b128 v[20:23], v2 offset:0
    ds_read_b128 v[232:235], v1 offset:12288
    v_fma_f32 v78, v78, s28, -v12
    v_add_f32 v43, v43, v44
    v_exp_f32 v45, v77
    v_mfma_f32_32x32x16_bf16 v[48:63], v[236:239], v[132:135], v[48:63]
    ds_read_b128 v[236:239], v2 offset:12288
    v_fma_f32 v79, v79, s28, -v12
    v_add_f32 v43, v43, v45
    v_cvt_pk_bf16_f32 v214, v44, v45
    v_exp_f32 v46, v78
    v_mfma_f32_32x32x16_bf16 v[48:63], v[248:251], v[136:139], v[48:63]
    ds_read_b128 v[248:251], v1 offset:12800
    v_add_f32 v43, v43, v46
    v_exp_f32 v47, v79
    s_nop 0
    v_add_f32 v43, v43, v47
    v_cvt_pk_bf16_f32 v215, v46, v47
    v_mfma_f32_32x32x16_bf16 v[48:63], v[252:255], v[140:143], v[48:63]
    ds_read_b128 v[24:27], v7 offset:0
    ds_read_b128 v[252:255], v2 offset:12800
    v_cmp_ngt_f32 vcc, 2.0, v43
    s_cbranch_vccnz L_rare25
L_back25:
    v_add_f32 v40, v40, v43
    s_waitcnt vmcnt(16)
    s_barrier
    s_waitcnt lgkmcnt(5)
    v_mfma_f32_32x32x16_bf16 v[64:79], v[16:19], a[64:67], 0
    ds_read_b128 v[28:31], v8 offset:0
    s_add_u32 m0, s27, 32768
    s_add_u32 s29, s24, 131072
    buffer_load_dwordx4 v5, s[16:19], s29 offen nt lds
    v_mfma_f32_32x32x16_bf16 v[64:79], v[20:23], a[68:71], v[64:79]
    ds_read_b128 a[224:227], v7 offset:512
    s_add_u32 m0, s27, 36864
    s_add_u32 s29, s24, 147456
    buffer_load_dwordx4 v5, s[16:19], s29 offen nt lds
    v_mfma_f32_32x32x16_bf16 v[64:79], a[240:243], a[72:75], v[64:79]
    ds_read_b128 a[228:231], v8 offset:512
    v_fma_f32 v48, v48, s28, -v13
    v_fma_f32 v49, v49, s28, -v13
    v_exp_f32 v44, v48
    v_fma_f32 v50, v50, s28, -v13
    v_exp_f32 v45, v49
    v_mfma_f32_32x32x16_bf16 v[64:79], a[244:247], a[76:79], v[64:79]
    ds_read_b128 v[216:219], v7 offset:16384
    v_fma_f32 v51, v51, s28, -v13
    v_add_f32 v43, v44, v45
    v_cvt_pk_bf16_f32 v32, v44, v45
    v_accvgpr_write_b32 a216, v32
    s_waitcnt lgkmcnt(3)
    v_exp_f32 v46, v50
    v_mfma_f32_32x32x16_bf16 v[64:79], v[224:227], v[24:27], v[64:79]
    ds_read_b128 v[220:223], v8 offset:16384
    v_fma_f32 v52, v52, s28, -v13
    v_add_f32 v43, v43, v46
    v_exp_f32 v47, v51
    v_fma_f32 v53, v53, s28, -v13
    v_add_f32 v43, v43, v47
    v_cvt_pk_bf16_f32 v33, v46, v47
    v_accvgpr_write_b32 a217, v33
    v_exp_f32 v44, v52
    v_mfma_f32_32x32x16_bf16 v[64:79], v[228:231], v[28:31], v[64:79]
    ds_read_b128 a[232:235], v1 offset:8704
    ds_read_b128 a[236:239], v7 offset:16896
    v_fma_f32 v54, v54, s28, -v13
    v_add_f32 v43, v43, v44
    s_waitcnt lgkmcnt(4)
    v_exp_f32 v45, v53
    v_mfma_f32_32x32x16_bf16 v[64:79], a[248:251], a[224:227], v[64:79]
    ds_read_b128 v[16:19], v2 offset:8704
    ds_read_b128 v[20:23], v8 offset:16896
    v_fma_f32 v55, v55, s28, -v13
    v_add_f32 v43, v43, v45
    v_cvt_pk_bf16_f32 v32, v44, v45
    v_accvgpr_write_b32 a218, v32
    v_exp_f32 v46, v54
    v_mfma_f32_32x32x16_bf16 v[64:79], a[252:255], a[228:231], v[64:79]
    ds_read_b128 v[24:27], v7 offset:32768
    v_fma_f32 v56, v56, s28, -v13
    v_add_f32 v43, v43, v46
    s_waitcnt lgkmcnt(5)
    v_exp_f32 v47, v55
    v_mfma_f32_32x32x16_bf16 v[64:79], v[240:243], v[216:219], v[64:79]
    ds_read_b128 v[28:31], v8 offset:32768
    v_fma_f32 v57, v57, s28, -v13
    v_add_f32 v43, v43, v47
    v_cvt_pk_bf16_f32 v33, v46, v47
    v_accvgpr_write_b32 a219, v33
    v_exp_f32 v44, v56
    v_mfma_f32_32x32x16_bf16 v[64:79], v[244:247], v[220:223], v[64:79]
    ds_read_b128 a[224:227], v7 offset:33280
    v_fma_f32 v58, v58, s28, -v13
    v_add_f32 v43, v43, v44
    s_waitcnt lgkmcnt(3)
    v_exp_f32 v45, v57
    v_mfma_f32_32x32x16_bf16 v[64:79], a[232:235], a[236:239], v[64:79]
    ds_read_b128 a[228:231], v8 offset:33280
    v_fma_f32 v59, v59, s28, -v13
    v_add_f32 v43, v43, v45
    v_cvt_pk_bf16_f32 v32, v44, v45
    v_accvgpr_write_b32 a220, v32
    v_exp_f32 v46, v58
    v_mfma_f32_32x32x16_bf16 v[64:79], v[16:19], v[20:23], v[64:79]
    ds_read_b128 v[16:19], v1 offset:0
    v_fma_f32 v60, v60, s28, -v13
    v_add_f32 v43, v43, v46
    s_waitcnt lgkmcnt(3)
    v_exp_f32 v47, v59
    v_mfma_f32_32x32x16_bf16 v[64:79], v[232:235], v[24:27], v[64:79]
    ds_read_b128 v[20:23], v2 offset:0
    v_fma_f32 v61, v61, s28, -v13
    v_add_f32 v43, v43, v47
    v_cvt_pk_bf16_f32 v33, v46, v47
    v_accvgpr_write_b32 a221, v33
    v_exp_f32 v44, v60
    v_mfma_f32_32x32x16_bf16 v[64:79], v[236:239], v[28:31], v[64:79]
    v_fma_f32 v62, v62, s28, -v13
    v_add_f32 v43, v43, v44
    v_exp_f32 v45, v61
    v_fma_f32 v63, v63, s28, -v13
    v_add_f32 v43, v43, v45
    v_cvt_pk_bf16_f32 v32, v44, v45
    v_accvgpr_write_b32 a222, v32
    s_waitcnt lgkmcnt(2)
    v_exp_f32 v46, v62
    v_mfma_f32_32x32x16_bf16 v[64:79], v[248:251], a[224:227], v[64:79]
    v_add_f32 v43, v43, v46
    v_exp_f32 v47, v63
    s_nop 0
    v_add_f32 v43, v43, v47
    v_cvt_pk_bf16_f32 v33, v46, v47
    v_accvgpr_write_b32 a223, v33
    v_mfma_f32_32x32x16_bf16 v[64:79], v[252:255], a[228:231], v[64:79]
    v_cmp_ngt_f32 vcc, 2.0, v43
    s_cbranch_vccnz L_rare26
L_back26:
    v_add_f32 v41, v41, v43
    s_waitcnt lgkmcnt(0)
    v_mfma_f32_32x32x16_bf16 v[48:63], v[16:19], a[0:3], 0
    s_add_u32 m0, s27, 40960
    s_add_u32 s29, s24, 163840
    buffer_load_dwordx4 v5, s[16:19], s29 offen nt lds
    v_mfma_f32_32x32x16_bf16 v[48:63], v[20:23], a[4:7], v[48:63]
    s_add_u32 m0, s27, 45056
    s_add_u32 s29, s24, 180224
    buffer_load_dwordx4 v5, s[16:19], s29 offen nt lds
    v_mfma_f32_32x32x16_bf16 v[48:63], a[240:243], a[8:11], v[48:63]
    v_fma_f32 v64, v64, s28, -v14
    v_fma_f32 v65, v65, s28, -v14
    v_exp_f32 v44, v64
    v_fma_f32 v66, v66, s28, -v14
    v_exp_f32 v45, v65
    v_mfma_f32_32x32x16_bf16 v[48:63], a[244:247], a[12:15], v[48:63]
    v_fma_f32 v67, v67, s28, -v14
    v_add_f32 v43, v44, v45
    v_cvt_pk_bf16_f32 v32, v44, v45
    v_accvgpr_write_b32 a224, v32
    v_exp_f32 v46, v66
    v_mfma_f32_32x32x16_bf16 v[48:63], v[224:227], a[16:19], v[48:63]
    v_fma_f32 v68, v68, s28, -v14
    v_add_f32 v43, v43, v46
    v_exp_f32 v47, v67
    v_mfma_f32_32x32x16_bf16 v[48:63], v[228:231], a[20:23], v[48:63]
    ds_read_b128 v[24:27], v1 offset:8704
    v_fma_f32 v69, v69, s28, -v14
    v_add_f32 v43, v43, v47
    v_cvt_pk_bf16_f32 v33, v46, v47
    v_accvgpr_write_b32 a225, v33
    v_exp_f32 v44, v68
    v_mfma_f32_32x32x16_bf16 v[48:63], a[248:251], a[24:27], v[48:63]
    ds_read_b128 v[28:31], v2 offset:8704
    v_fma_f32 v70, v70, s28, -v14
    v_add_f32 v43, v43, v44
    v_exp_f32 v45, v69
    v_mfma_f32_32x32x16_bf16 v[48:63], a[252:255], a[28:31], v[48:63]
    v_fma_f32 v71, v71, s28, -v14
    v_add_f32 v43, v43, v45
    v_cvt_pk_bf16_f32 v32, v44, v45
    v_accvgpr_write_b32 a226, v32
    v_exp_f32 v46, v70
    v_mfma_f32_32x32x16_bf16 v[48:63], v[240:243], v[80:83], v[48:63]
    v_fma_f32 v72, v72, s28, -v14
    v_add_f32 v43, v43, v46
    v_exp_f32 v47, v71
    v_fma_f32 v73, v73, s28, -v14
    v_add_f32 v43, v43, v47
    v_cvt_pk_bf16_f32 v33, v46, v47
    v_accvgpr_write_b32 a227, v33
    v_exp_f32 v44, v72
    v_mfma_f32_32x32x16_bf16 v[48:63], v[244:247], v[84:87], v[48:63]
    v_fma_f32 v74, v74, s28, -v14
    v_add_f32 v43, v43, v44
    s_waitcnt lgkmcnt(0)
    v_exp_f32 v45, v73
    v_mfma_f32_32x32x16_bf16 v[48:63], v[24:27], v[88:91], v[48:63]
    v_fma_f32 v75, v75, s28, -v14
    v_add_f32 v43, v43, v45
    v_cvt_pk_bf16_f32 v32, v44, v45
    v_accvgpr_write_b32 a228, v32
    v_exp_f32 v46, v74
    v_mfma_f32_32x32x16_bf16 v[48:63], v[28:31], v[92:95], v[48:63]
    ds_read_b128 v[16:19], v1 offset:0
    v_fma_f32 v76, v76, s28, -v14
    v_add_f32 v43, v43, v46
    v_exp_f32 v47, v75
    v_mfma_f32_32x32x16_bf16 v[48:63], v[232:235], v[96:99], v[48:63]
    ds_read_b128 v[20:23], v2 offset:0
    v_fma_f32 v77, v77, s28, -v14
    v_add_f32 v43, v43, v47
    v_cvt_pk_bf16_f32 v33, v46, v47
    v_accvgpr_write_b32 a229, v33
    v_exp_f32 v44, v76
    v_mfma_f32_32x32x16_bf16 v[48:63], v[236:239], v[100:103], v[48:63]
    v_fma_f32 v78, v78, s28, -v14
    v_add_f32 v43, v43, v44
    v_exp_f32 v45, v77
    v_fma_f32 v79, v79, s28, -v14
    v_add_f32 v43, v43, v45
    v_cvt_pk_bf16_f32 v32, v44, v45
    v_accvgpr_write_b32 a230, v32
    v_exp_f32 v46, v78
    v_mfma_f32_32x32x16_bf16 v[48:63], v[248:251], v[104:107], v[48:63]
    v_add_f32 v43, v43, v46
    v_exp_f32 v47, v79
    s_nop 0
    v_add_f32 v43, v43, v47
    v_cvt_pk_bf16_f32 v33, v46, v47
    v_accvgpr_write_b32 a231, v33
    v_mfma_f32_32x32x16_bf16 v[48:63], v[252:255], v[108:111], v[48:63]
    v_cmp_ngt_f32 vcc, 2.0, v43
    s_cbranch_vccnz L_rare27
L_back27:
    v_add_f32 v42, v42, v43
    s_waitcnt lgkmcnt(0)
    v_mfma_f32_32x32x16_bf16 v[64:79], v[16:19], a[32:35], 0
    v_mfma_f32_32x32x16_bf16 v[64:79], v[20:23], a[36:39], v[64:79]
    v_mfma_f32_32x32x16_bf16 v[64:79], a[240:243], a[40:43], v[64:79]
    s_nop 4
    v_fma_f32 v48, v48, s28, -v12
    v_fma_f32 v49, v49, s28, -v12
    v_exp_f32 v44, v48
    v_fma_f32 v50, v50, s28, -v12
    v_exp_f32 v45, v49
    v_mfma_f32_32x32x16_bf16 v[64:79], a[244:247], a[44:47], v[64:79]
    v_fma_f32 v51, v51, s28, -v12
    v_add_f32 v43, v44, v45
    v_cvt_pk_bf16_f32 v216, v44, v45
    v_exp_f32 v46, v50
    v_fma_f32 v52, v52, s28, -v12
    v_add_f32 v43, v43, v46
    v_exp_f32 v47, v51
    v_mfma_f32_32x32x16_bf16 v[64:79], v[224:227], a[48:51], v[64:79]
    v_fma_f32 v53, v53, s28, -v12
    v_add_f32 v43, v43, v47
    v_cvt_pk_bf16_f32 v217, v46, v47
    v_exp_f32 v44, v52
    v_fma_f32 v54, v54, s28, -v12
    v_add_f32 v43, v43, v44
    v_exp_f32 v45, v53
    v_mfma_f32_32x32x16_bf16 v[64:79], v[228:231], a[52:55], v[64:79]
    ds_read_b128 v[24:27], v1 offset:8704
    v_fma_f32 v55, v55, s28, -v12
    v_add_f32 v43, v43, v45
    v_cvt_pk_bf16_f32 v218, v44, v45
    v_exp_f32 v46, v54
    v_mfma_f32_32x32x16_bf16 v[64:79], a[248:251], a[56:59], v[64:79]
    ds_read_b128 v[28:31], v2 offset:8704
    ds_read_b128 a[248:251], v1 offset:20992
    v_fma_f32 v56, v56, s28, -v12
    v_add_f32 v43, v43, v46
    v_exp_f32 v47, v55
    v_mfma_f32_32x32x16_bf16 v[64:79], a[252:255], a[60:63], v[64:79]
    ds_read_b128 a[252:255], v2 offset:20992
    v_fma_f32 v57, v57, s28, -v12
    v_add_f32 v43, v43, v47
    v_cvt_pk_bf16_f32 v219, v46, v47
    v_exp_f32 v44, v56
    v_mfma_f32_32x32x16_bf16 v[64:79], v[240:243], v[112:115], v[64:79]
    ds_read_b128 v[240:243], v1 offset:24576
    v_fma_f32 v58, v58, s28, -v12
    v_add_f32 v43, v43, v44
    v_exp_f32 v45, v57
    v_mfma_f32_32x32x16_bf16 v[64:79], v[244:247], v[116:119], v[64:79]
    ds_read_b128 v[244:247], v2 offset:24576
    v_fma_f32 v59, v59, s28, -v12
    v_add_f32 v43, v43, v45
    v_cvt_pk_bf16_f32 v220, v44, v45
    s_waitcnt lgkmcnt(4)
    v_exp_f32 v46, v58
    v_mfma_f32_32x32x16_bf16 v[64:79], v[24:27], v[120:123], v[64:79]
    v_fma_f32 v60, v60, s28, -v12
    v_add_f32 v43, v43, v46
    v_exp_f32 v47, v59
    v_fma_f32 v61, v61, s28, -v12
    v_add_f32 v43, v43, v47
    v_cvt_pk_bf16_f32 v221, v46, v47
    v_exp_f32 v44, v60
    v_mfma_f32_32x32x16_bf16 v[64:79], v[28:31], v[124:127], v[64:79]
    ds_read_b128 v[16:19], v1 offset:16384
    v_fma_f32 v62, v62, s28, -v12
    v_add_f32 v43, v43, v44
    v_exp_f32 v45, v61
    v_mfma_f32_32x32x16_bf16 v[64:79], v[232:235], v[128:131], v[64:79]
    ds_read_b128 v[20:23], v2 offset:16384
    v_fma_f32 v63, v63, s28, -v12
    v_add_f32 v43, v43, v45
    v_cvt_pk_bf16_f32 v222, v44, v45
    v_exp_f32 v46, v62
    v_mfma_f32_32x32x16_bf16 v[64:79], v[236:239], v[132:135], v[64:79]
    ds_read_b128 v[24:27], v1 offset:16896
    v_add_f32 v43, v43, v46
    v_exp_f32 v47, v63
    s_nop 0
    v_add_f32 v43, v43, v47
    v_cvt_pk_bf16_f32 v223, v46, v47
    v_mfma_f32_32x32x16_bf16 v[64:79], v[248:251], v[136:139], v[64:79]
    ds_read_b128 v[28:31], v2 offset:16896
    ds_read_b128 v[248:251], v1 offset:29184
    v_cmp_ngt_f32 vcc, 2.0, v43
    s_cbranch_vccnz L_rare28
L_back28:
    v_add_f32 v40, v40, v43
    v_mfma_f32_32x32x16_bf16 v[64:79], v[252:255], v[140:143], v[64:79]
    ds_read_b128 a[240:243], v1 offset:20480
    ds_read_b128 a[244:247], v7 offset:0
    ds_read_b128 v[252:255], v2 offset:29184
    s_waitcnt vmcnt(15)
    s_barrier
    s_waitcnt lgkmcnt(6)
    v_mfma_f32_32x32x16_bf16 v[48:63], v[16:19], a[64:67], 0
    ds_read_b128 v[224:227], v2 offset:20480
    ds_read_b128 v[228:231], v8 offset:0
    s_add_u32 m0, s27, 49152
    s_add_u32 s29, s24, 128
    buffer_load_dwordx4 v5, s[16:19], s29 offen nt lds
    v_mfma_f32_32x32x16_bf16 v[48:63], v[20:23], a[68:71], v[48:63]
    ds_read_b128 v[232:235], v7 offset:512
    s_add_u32 m0, s27, 53248
    s_add_u32 s29, s24, 16512
    buffer_load_dwordx4 v5, s[16:19], s29 offen nt lds
    s_waitcnt lgkmcnt(7)
    v_mfma_f32_32x32x16_bf16 v[48:63], v[24:27], a[72:75], v[48:63]
    ds_read_b128 v[236:239], v8 offset:512
    v_fma_f32 v64, v64, s28, -v13
    v_fma_f32 v65, v65, s28, -v13
    v_exp_f32 v44, v64
    v_fma_f32 v66, v66, s28, -v13
    v_exp_f32 v45, v65
    v_mfma_f32_32x32x16_bf16 v[48:63], v[28:31], a[76:79], v[48:63]
    ds_read_b128 v[16:19], v7 offset:16384
    v_fma_f32 v67, v67, s28, -v13
    v_add_f32 v43, v44, v45
    v_cvt_pk_bf16_f32 v32, v44, v45
    v_accvgpr_write_b32 a232, v32
    s_waitcnt lgkmcnt(3)
    v_exp_f32 v46, v66
    v_mfma_f32_32x32x16_bf16 v[48:63], a[240:243], a[244:247], v[48:63]
    ds_read_b128 v[20:23], v8 offset:16384
    v_fma_f32 v68, v68, s28, -v13
    v_add_f32 v43, v43, v46
    v_exp_f32 v47, v67
    v_fma_f32 v69, v69, s28, -v13
    v_add_f32 v43, v43, v47
    v_cvt_pk_bf16_f32 v33, v46, v47
    v_accvgpr_write_b32 a233, v33
    v_exp_f32 v44, v68
    v_mfma_f32_32x32x16_bf16 v[48:63], v[224:227], v[228:231], v[48:63]
    ds_read_b128 v[24:27], v1 offset:25088
    ds_read_b128 v[28:31], v7 offset:16896
    v_fma_f32 v70, v70, s28, -v13
    v_add_f32 v43, v43, v44
    s_waitcnt lgkmcnt(4)
    v_exp_f32 v45, v69
    v_mfma_f32_32x32x16_bf16 v[48:63], a[248:251], v[232:235], v[48:63]
    ds_read_b128 a[240:243], v2 offset:25088
    ds_read_b128 a[244:247], v8 offset:16896
    v_fma_f32 v71, v71, s28, -v13
    v_add_f32 v43, v43, v45
    v_cvt_pk_bf16_f32 v32, v44, v45
    v_accvgpr_write_b32 a234, v32
    v_exp_f32 v46, v70
    v_mfma_f32_32x32x16_bf16 v[48:63], a[252:255], v[236:239], v[48:63]
    ds_read_b128 v[224:227], v1 offset:28672
    ds_read_b128 v[228:231], v7 offset:32768
    v_fma_f32 v72, v72, s28, -v13
    v_add_f32 v43, v43, v46
    s_waitcnt lgkmcnt(6)
    v_exp_f32 v47, v71
    v_mfma_f32_32x32x16_bf16 v[48:63], v[240:243], v[16:19], v[48:63]
    ds_read_b128 v[232:235], v2 offset:28672
    ds_read_b128 v[236:239], v8 offset:32768
    v_fma_f32 v73, v73, s28, -v13
    v_add_f32 v43, v43, v47
    v_cvt_pk_bf16_f32 v33, v46, v47
    v_accvgpr_write_b32 a235, v33
    v_exp_f32 v44, v72
    v_mfma_f32_32x32x16_bf16 v[48:63], v[244:247], v[20:23], v[48:63]
    ds_read_b128 v[16:19], v7 offset:33280
    v_fma_f32 v74, v74, s28, -v13
    v_add_f32 v43, v43, v44
    s_waitcnt lgkmcnt(5)
    v_exp_f32 v45, v73
    v_mfma_f32_32x32x16_bf16 v[48:63], v[24:27], v[28:31], v[48:63]
    ds_read_b128 v[20:23], v8 offset:33280
    v_fma_f32 v75, v75, s28, -v13
    v_add_f32 v43, v43, v45
    v_cvt_pk_bf16_f32 v32, v44, v45
    v_accvgpr_write_b32 a236, v32
    v_exp_f32 v46, v74
    v_mfma_f32_32x32x16_bf16 v[48:63], a[240:243], a[244:247], v[48:63]
    v_fma_f32 v76, v76, s28, -v13
    v_add_f32 v43, v43, v46
    s_waitcnt lgkmcnt(2)
    v_exp_f32 v47, v75
    v_mfma_f32_32x32x16_bf16 v[48:63], v[224:227], v[228:231], v[48:63]
    v_fma_f32 v77, v77, s28, -v13
    v_add_f32 v43, v43, v47
    v_cvt_pk_bf16_f32 v33, v46, v47
    v_accvgpr_write_b32 a237, v33
    v_exp_f32 v44, v76
    v_fma_f32 v78, v78, s28, -v13
    v_add_f32 v43, v43, v44
    v_exp_f32 v45, v77
    v_mfma_f32_32x32x16_bf16 v[48:63], v[232:235], v[236:239], v[48:63]
    v_fma_f32 v79, v79, s28, -v13
    v_add_f32 v43, v43, v45
    v_cvt_pk_bf16_f32 v32, v44, v45
    v_accvgpr_write_b32 a238, v32
    s_waitcnt lgkmcnt(0)
    v_exp_f32 v46, v78
    v_mfma_f32_32x32x16_bf16 v[48:63], v[248:251], v[16:19], v[48:63]
    ds_read_b128 v[16:19], v1 offset:16384
    v_add_f32 v43, v43, v46
    v_exp_f32 v47, v79
    s_nop 0
    v_add_f32 v43, v43, v47
    v_cvt_pk_bf16_f32 v33, v46, v47
    v_accvgpr_write_b32 a239, v33
    v_mfma_f32_32x32x16_bf16 v[48:63], v[252:255], v[20:23], v[48:63]
    ds_read_b128 v[20:23], v2 offset:16384
    ds_read_b128 v[24:27], v1 offset:16896
    ds_read_b128 v[28:31], v2 offset:16896
    ds_read_b128 v[224:227], v1 offset:20480
    v_cmp_ngt_f32 vcc, 2.0, v43
    s_cbranch_vccnz L_rare29
L_back29:
    v_add_f32 v41, v41, v43
    s_waitcnt lgkmcnt(3)
    v_mfma_f32_32x32x16_bf16 v[64:79], v[16:19], a[0:3], 0
    ds_read_b128 v[228:231], v2 offset:20480
    s_add_u32 m0, s27, 57344
    s_add_u32 s29, s24, 32896
    buffer_load_dwordx4 v5, s[16:19], s29 offen nt lds
    v_mfma_f32_32x32x16_bf16 v[64:79], v[20:23], a[4:7], v[64:79]
    s_add_u32 m0, s27, 61440
    s_add_u32 s29, s24, 49280
    buffer_load_dwordx4 v5, s[16:19], s29 offen nt lds
    s_waitcnt lgkmcnt(2)
    v_mfma_f32_32x32x16_bf16 v[64:79], v[24:27], a[8:11], v[64:79]
    v_fma_f32 v48, v48, s28, -v14
    v_fma_f32 v49, v49, s28, -v14
    v_exp_f32 v44, v48
    v_fma_f32 v50, v50, s28, -v14
    v_exp_f32 v45, v49
    v_mfma_f32_32x32x16_bf16 v[64:79], v[28:31], a[12:15], v[64:79]
    v_fma_f32 v51, v51, s28, -v14
    v_add_f32 v43, v44, v45
    v_cvt_pk_bf16_f32 v32, v44, v45
    v_accvgpr_write_b32 a240, v32
    s_waitcnt lgkmcnt(0)
    v_exp_f32 v46, v50
    v_mfma_f32_32x32x16_bf16 v[64:79], v[224:227], a[16:19], v[64:79]
    v_fma_f32 v52, v52, s28, -v14
    v_add_f32 v43, v43, v46
    v_exp_f32 v47, v51
    v_fma_f32 v53, v53, s28, -v14
    v_add_f32 v43, v43, v47
    v_cvt_pk_bf16_f32 v33, v46, v47
    v_accvgpr_write_b32 a241, v33
    v_exp_f32 v44, v52
    v_mfma_f32_32x32x16_bf16 v[64:79], v[228:231], a[20:23], v[64:79]
    ds_read_b128 v[232:235], v1 offset:25088
    v_fma_f32 v54, v54, s28, -v14
    v_add_f32 v43, v43, v44
    v_exp_f32 v45, v53
    v_mfma_f32_32x32x16_bf16 v[64:79], a[248:251], a[24:27], v[64:79]
    ds_read_b128 v[236:239], v2 offset:25088
    v_fma_f32 v55, v55, s28, -v14
    v_add_f32 v43, v43, v45
    v_cvt_pk_bf16_f32 v32, v44, v45
    v_accvgpr_write_b32 a242, v32
    v_exp_f32 v46, v54
    v_mfma_f32_32x32x16_bf16 v[64:79], a[252:255], a[28:31], v[64:79]
    ds_read_b128 v[16:19], v1 offset:28672
    v_fma_f32 v56, v56, s28, -v14
    v_add_f32 v43, v43, v46
    v_exp_f32 v47, v55
    v_mfma_f32_32x32x16_bf16 v[64:79], v[240:243], v[80:83], v[64:79]
    ds_read_b128 v[20:23], v2 offset:28672
    v_fma_f32 v57, v57, s28, -v14
    v_add_f32 v43, v43, v47
    v_cvt_pk_bf16_f32 v33, v46, v47
    v_accvgpr_write_b32 a243, v33
    v_exp_f32 v44, v56
    v_mfma_f32_32x32x16_bf16 v[64:79], v[244:247], v[84:87], v[64:79]
    v_fma_f32 v58, v58, s28, -v14
    v_add_f32 v43, v43, v44
    s_waitcnt lgkmcnt(2)
    v_exp_f32 v45, v57
    v_mfma_f32_32x32x16_bf16 v[64:79], v[232:235], v[88:91], v[64:79]
    v_fma_f32 v59, v59, s28, -v14
    v_add_f32 v43, v43, v45
    v_cvt_pk_bf16_f32 v32, v44, v45
    v_accvgpr_write_b32 a244, v32
    v_exp_f32 v46, v58
    v_fma_f32 v60, v60, s28, -v14
    v_add_f32 v43, v43, v46
    v_exp_f32 v47, v59
    v_mfma_f32_32x32x16_bf16 v[64:79], v[236:239], v[92:95], v[64:79]
    v_fma_f32 v61, v61, s28, -v14
    v_add_f32 v43, v43, v47
    v_cvt_pk_bf16_f32 v33, v46, v47
    v_accvgpr_write_b32 a245, v33
    s_waitcnt lgkmcnt(0)
    v_exp_f32 v44, v60
    v_mfma_f32_32x32x16_bf16 v[64:79], v[16:19], v[96:99], v[64:79]
    ds_read_b128 v[16:19], v1 offset:16384
    v_fma_f32 v62, v62, s28, -v14
    v_add_f32 v43, v43, v44
    v_exp_f32 v45, v61
    v_mfma_f32_32x32x16_bf16 v[64:79], v[20:23], v[100:103], v[64:79]
    ds_read_b128 v[20:23], v2 offset:16384
    ds_read_b128 v[24:27], v1 offset:16896
    v_fma_f32 v63, v63, s28, -v14
    v_add_f32 v43, v43, v45
    v_cvt_pk_bf16_f32 v32, v44, v45
    v_accvgpr_write_b32 a246, v32
    v_exp_f32 v46, v62
    v_mfma_f32_32x32x16_bf16 v[64:79], v[248:251], v[104:107], v[64:79]
    ds_read_b128 v[28:31], v2 offset:16896
    v_add_f32 v43, v43, v46
    v_exp_f32 v47, v63
    s_nop 0
    v_add_f32 v43, v43, v47
    v_cvt_pk_bf16_f32 v33, v46, v47
    v_accvgpr_write_b32 a247, v33
    v_mfma_f32_32x32x16_bf16 v[64:79], v[252:255], v[108:111], v[64:79]
    ds_read_b128 v[232:235], v1 offset:20480
    v_cmp_ngt_f32 vcc, 2.0, v43
    s_cbranch_vccnz L_rare30
L_back30:
    v_add_f32 v42, v42, v43
    s_waitcnt lgkmcnt(3)
    v_mfma_f32_32x32x16_bf16 v[48:63], v[16:19], a[32:35], 0
    ds_read_b128 v[236:239], v2 offset:20480
    v_mfma_f32_32x32x16_bf16 v[48:63], v[20:23], a[36:39], v[48:63]
    s_waitcnt lgkmcnt(2)
    v_mfma_f32_32x32x16_bf16 v[48:63], v[24:27], a[40:43], v[48:63]
    s_nop 1
    v_fma_f32 v64, v64, s28, -v12
    v_fma_f32 v65, v65, s28, -v12
    v_exp_f32 v44, v64
    v_fma_f32 v66, v66, s28, -v12
    v_exp_f32 v45, v65
    v_mfma_f32_32x32x16_bf16 v[48:63], v[28:31], a[44:47], v[48:63]
    v_fma_f32 v67, v67, s28, -v12
    v_add_f32 v43, v44, v45
    v_cvt_pk_bf16_f32 v224, v44, v45
    s_waitcnt lgkmcnt(0)
    v_exp_f32 v46, v66
    v_mfma_f32_32x32x16_bf16 v[48:63], v[232:235], a[48:51], v[48:63]
    v_fma_f32 v68, v68, s28, -v12
    v_add_f32 v43, v43, v46
    v_exp_f32 v47, v67
    v_fma_f32 v69, v69, s28, -v12
    v_add_f32 v43, v43, v47
    v_cvt_pk_bf16_f32 v225, v46, v47
    v_exp_f32 v44, v68
    v_mfma_f32_32x32x16_bf16 v[48:63], v[236:239], a[52:55], v[48:63]
    ds_read_b128 v[16:19], v1 offset:25088
    v_fma_f32 v70, v70, s28, -v12
    v_add_f32 v43, v43, v44
    v_exp_f32 v45, v69
    v_mfma_f32_32x32x16_bf16 v[48:63], a[248:251], a[56:59], v[48:63]
    ds_read_b128 v[20:23], v2 offset:25088
    v_fma_f32 v71, v71, s28, -v12
    v_add_f32 v43, v43, v45
    v_cvt_pk_bf16_f32 v226, v44, v45
    v_exp_f32 v46, v70
    v_mfma_f32_32x32x16_bf16 v[48:63], a[252:255], a[60:63], v[48:63]
    ds_read_b128 v[24:27], v1 offset:28672
    v_fma_f32 v72, v72, s28, -v12
    v_add_f32 v43, v43, v46
    v_exp_f32 v47, v71
    v_mfma_f32_32x32x16_bf16 v[48:63], v[240:243], v[112:115], v[48:63]
    ds_read_b128 v[28:31], v2 offset:28672
    v_fma_f32 v73, v73, s28, -v12
    v_add_f32 v43, v43, v47
    v_cvt_pk_bf16_f32 v227, v46, v47
    v_exp_f32 v44, v72
    v_mfma_f32_32x32x16_bf16 v[48:63], v[244:247], v[116:119], v[48:63]
    v_fma_f32 v74, v74, s28, -v12
    v_add_f32 v43, v43, v44
    s_waitcnt lgkmcnt(2)
    v_exp_f32 v45, v73
    v_mfma_f32_32x32x16_bf16 v[48:63], v[16:19], v[120:123], v[48:63]
    v_fma_f32 v75, v75, s28, -v12
    v_add_f32 v43, v43, v45
    v_cvt_pk_bf16_f32 v228, v44, v45
    v_exp_f32 v46, v74
    v_fma_f32 v76, v76, s28, -v12
    v_add_f32 v43, v43, v46
    v_exp_f32 v47, v75
    v_mfma_f32_32x32x16_bf16 v[48:63], v[20:23], v[124:127], v[48:63]
    ds_read_b128 v[16:19], v1 offset:32768
    v_fma_f32 v77, v77, s28, -v12
    v_add_f32 v43, v43, v47
    v_cvt_pk_bf16_f32 v229, v46, v47
    s_waitcnt lgkmcnt(1)
    v_exp_f32 v44, v76
    v_mfma_f32_32x32x16_bf16 v[48:63], v[24:27], v[128:131], v[48:63]
    ds_read_b128 v[20:23], v2 offset:32768
    v_fma_f32 v78, v78, s28, -v12
    v_add_f32 v43, v43, v44
    v_exp_f32 v45, v77
    v_mfma_f32_32x32x16_bf16 v[48:63], v[28:31], v[132:135], v[48:63]
    ds_read_b128 v[24:27], v1 offset:33280
    v_fma_f32 v79, v79, s28, -v12
    v_add_f32 v43, v43, v45
    v_cvt_pk_bf16_f32 v230, v44, v45
    v_exp_f32 v46, v78
    v_mfma_f32_32x32x16_bf16 v[48:63], v[248:251], v[136:139], v[48:63]
    ds_read_b128 v[28:31], v2 offset:33280
    v_add_f32 v43, v43, v46
    v_exp_f32 v47, v79
    s_nop 0
    v_add_f32 v43, v43, v47
    v_cvt_pk_bf16_f32 v231, v46, v47
    v_mfma_f32_32x32x16_bf16 v[48:63], v[252:255], v[140:143], v[48:63]
    ds_read_b128 a[248:251], v1 offset:36864
    ds_read_b128 a[252:255], v7 offset:0
    v_cmp_ngt_f32 vcc, 2.0, v43
    s_cbranch_vccnz L_rare31
L_back31:
    v_add_f32 v40, v40, v43
    s_waitcnt vmcnt(12)
    s_barrier
    s_waitcnt lgkmcnt(4)
    v_mfma_f32_32x32x16_bf16 v[64:79], v[16:19], a[64:67], 0
    ds_read_b128 v[240:243], v2 offset:36864
    ds_read_b128 v[244:247], v8 offset:0
    s_add_u32 m0, s27, 65536
    s_add_u32 s29, s24, 65664
    buffer_load_dwordx4 v5, s[16:19], s29 offen nt lds
    v_mfma_f32_32x32x16_bf16 v[64:79], v[20:23], a[68:71], v[64:79]
    ds_read_b128 v[248:251], v1 offset:37376
    ds_read_b128 v[252:255], v7 offset:512
    s_add_u32 m0, s27, 69632
    s_add_u32 s29, s24, 82048
    buffer_load_dwordx4 v5, s[16:19], s29 offen nt lds
    s_waitcnt lgkmcnt(6)
    v_mfma_f32_32x32x16_bf16 v[64:79], v[24:27], a[72:75], v[64:79]
    ds_read_b128 v[16:19], v2 offset:37376
    ds_read_b128 v[20:23], v8 offset:512
    v_fma_f32 v48, v48, s28, -v13
    v_fma_f32 v49, v49, s28, -v13
    v_exp_f32 v44, v48
    v_fma_f32 v50, v50, s28, -v13
    v_exp_f32 v45, v49
    v_mfma_f32_32x32x16_bf16 v[64:79], v[28:31], a[76:79], v[64:79]
    ds_read_b128 v[24:27], v1 offset:40960
    ds_read_b128 v[28:31], v7 offset:16384
    v_fma_f32 v51, v51, s28, -v13
    v_add_f32 v43, v44, v45
    v_cvt_pk_bf16_f32 v232, v44, v45
    s_waitcnt lgkmcnt(6)
    v_exp_f32 v46, v50
    v_mfma_f32_32x32x16_bf16 v[64:79], a[248:251], a[252:255], v[64:79]
    ds_read_b128 a[248:251], v2 offset:40960
    ds_read_b128 a[252:255], v8 offset:16384
    v_fma_f32 v52, v52, s28, -v13
    v_add_f32 v43, v43, v46
    v_exp_f32 v47, v51
    v_fma_f32 v53, v53, s28, -v13
    v_add_f32 v43, v43, v47
    v_cvt_pk_bf16_f32 v233, v46, v47
    v_exp_f32 v44, v52
    v_mfma_f32_32x32x16_bf16 v[64:79], v[240:243], v[244:247], v[64:79]
    ds_read_b128 v[240:243], v1 offset:41472
    ds_read_b128 v[244:247], v7 offset:16896
    v_fma_f32 v54, v54, s28, -v13
    v_add_f32 v43, v43, v44
    s_waitcnt lgkmcnt(6)
    v_exp_f32 v45, v53
    v_mfma_f32_32x32x16_bf16 v[64:79], v[248:251], v[252:255], v[64:79]
    ds_read_b128 v[248:251], v2 offset:41472
    ds_read_b128 v[252:255], v8 offset:16896
    v_fma_f32 v55, v55, s28, -v13
    v_add_f32 v43, v43, v45
    v_cvt_pk_bf16_f32 v234, v44, v45
    v_exp_f32 v46, v54
    v_mfma_f32_32x32x16_bf16 v[64:79], v[16:19], v[20:23], v[64:79]
    ds_read_b128 v[16:19], v1 offset:45056
    ds_read_b128 v[20:23], v7 offset:32768
    v_fma_f32 v56, v56, s28, -v13
    v_add_f32 v43, v43, v46
    s_waitcnt lgkmcnt(6)
    v_exp_f32 v47, v55
    v_mfma_f32_32x32x16_bf16 v[64:79], v[24:27], v[28:31], v[64:79]
    ds_read_b128 v[24:27], v2 offset:45056
    ds_read_b128 v[28:31], v8 offset:32768
    v_fma_f32 v57, v57, s28, -v13
    v_add_f32 v43, v43, v47
    v_cvt_pk_bf16_f32 v235, v46, v47
    v_exp_f32 v44, v56
    v_mfma_f32_32x32x16_bf16 v[64:79], a[248:251], a[252:255], v[64:79]
    ds_read_b128 a[248:251], v1 offset:45568
    ds_read_b128 a[252:255], v7 offset:33280
    v_fma_f32 v58, v58, s28, -v13
    v_add_f32 v43, v43, v44
    s_waitcnt lgkmcnt(6)
    v_exp_f32 v45, v57
    v_mfma_f32_32x32x16_bf16 v[64:79], v[240:243], v[244:247], v[64:79]
    ds_read_b128 v[240:243], v2 offset:45568
    ds_read_b128 v[244:247], v8 offset:33280
    v_fma_f32 v59, v59, s28, -v13
    v_add_f32 v43, v43, v45
    v_cvt_pk_bf16_f32 v236, v44, v45
    v_exp_f32 v46, v58
    v_mfma_f32_32x32x16_bf16 v[64:79], v[248:251], v[252:255], v[64:79]
    v_fma_f32 v60, v60, s28, -v13
    v_add_f32 v43, v43, v46
    v_exp_f32 v47, v59
    v_fma_f32 v61, v61, s28, -v13
    v_add_f32 v43, v43, v47
    v_cvt_pk_bf16_f32 v237, v46, v47
    s_waitcnt lgkmcnt(4)
    v_exp_f32 v44, v60
    v_mfma_f32_32x32x16_bf16 v[64:79], v[16:19], v[20:23], v[64:79]
    ds_read_b128 v[16:19], v1 offset:32768
    ds_read_b128 v[20:23], v2 offset:32768
    v_fma_f32 v62, v62, s28, -v13
    v_add_f32 v43, v43, v44
    v_exp_f32 v45, v61
    v_mfma_f32_32x32x16_bf16 v[64:79], v[24:27], v[28:31], v[64:79]
    ds_read_b128 v[24:27], v1 offset:33280
    v_fma_f32 v63, v63, s28, -v13
    v_add_f32 v43, v43, v45
    v_cvt_pk_bf16_f32 v238, v44, v45
    s_waitcnt lgkmcnt(3)
    v_exp_f32 v46, v62
    v_mfma_f32_32x32x16_bf16 v[64:79], a[248:251], a[252:255], v[64:79]
    ds_read_b128 v[28:31], v2 offset:33280
    v_add_f32 v43, v43, v46
    v_exp_f32 v47, v63
    s_nop 0
    v_add_f32 v43, v43, v47
    v_cvt_pk_bf16_f32 v239, v46, v47
    v_mfma_f32_32x32x16_bf16 v[64:79], v[240:243], v[244:247], v[64:79]
    ds_read_b128 v[240:243], v1 offset:36864
    v_cmp_ngt_f32 vcc, 2.0, v43
    s_cbranch_vccnz L_rare32
L_back32:
    v_add_f32 v41, v41, v43
    s_waitcnt lgkmcnt(3)
    v_mfma_f32_32x32x16_bf16 v[48:63], v[16:19], a[0:3], 0
    ds_read_b128 v[244:247], v2 offset:36864
    s_add_u32 m0, s27, 73728
    s_add_u32 s29, s24, 98432
    buffer_load_dwordx4 v5, s[16:19], s29 offen nt lds
    v_mfma_f32_32x32x16_bf16 v[48:63], v[20:23], a[4:7], v[48:63]
    ds_read_b128 v[248:251], v1 offset:37376
    s_add_u32 m0, s27, 77824
    s_add_u32 s29, s24, 114816
    buffer_load_dwordx4 v5, s[16:19], s29 offen nt lds
    s_waitcnt lgkmcnt(3)
    v_mfma_f32_32x32x16_bf16 v[48:63], v[24:27], a[8:11], v[48:63]
    ds_read_b128 v[252:255], v2 offset:37376
    v_fma_f32 v64, v64, s28, -v14
    v_fma_f32 v65, v65, s28, -v14
    v_exp_f32 v44, v64
    v_fma_f32 v66, v66, s28, -v14
    v_exp_f32 v45, v65
    v_mfma_f32_32x32x16_bf16 v[48:63], v[28:31], a[12:15], v[48:63]
    ds_read_b128 v[16:19], v1 offset:40960
    v_fma_f32 v67, v67, s28, -v14
    v_add_f32 v43, v44, v45
    v_cvt_pk_bf16_f32 v32, v44, v45
    v_accvgpr_write_b32 a248, v32
    s_waitcnt lgkmcnt(3)
    v_exp_f32 v46, v66
    v_mfma_f32_32x32x16_bf16 v[48:63], v[240:243], a[16:19], v[48:63]
    ds_read_b128 v[20:23], v2 offset:40960
    v_fma_f32 v68, v68, s28, -v14
    v_add_f32 v43, v43, v46
    v_exp_f32 v47, v67
    v_fma_f32 v69, v69, s28, -v14
    v_add_f32 v43, v43, v47
    v_cvt_pk_bf16_f32 v33, v46, v47
    v_accvgpr_write_b32 a249, v33
    v_exp_f32 v44, v68
    v_mfma_f32_32x32x16_bf16 v[48:63], v[244:247], a[20:23], v[48:63]
    ds_read_b128 v[24:27], v1 offset:41472
    v_fma_f32 v70, v70, s28, -v14
    v_add_f32 v43, v43, v44
    s_waitcnt lgkmcnt(3)
    v_exp_f32 v45, v69
    v_mfma_f32_32x32x16_bf16 v[48:63], v[248:251], a[24:27], v[48:63]
    ds_read_b128 v[28:31], v2 offset:41472
    v_fma_f32 v71, v71, s28, -v14
    v_add_f32 v43, v43, v45
    v_cvt_pk_bf16_f32 v32, v44, v45
    v_accvgpr_write_b32 a250, v32
    v_exp_f32 v46, v70
    v_mfma_f32_32x32x16_bf16 v[48:63], v[252:255], a[28:31], v[48:63]
    ds_read_b128 v[240:243], v1 offset:45056
    v_fma_f32 v72, v72, s28, -v14
    v_add_f32 v43, v43, v46
    s_waitcnt lgkmcnt(3)
    v_exp_f32 v47, v71
    v_mfma_f32_32x32x16_bf16 v[48:63], v[16:19], v[80:83], v[48:63]
    ds_read_b128 v[244:247], v2 offset:45056
    v_fma_f32 v73, v73, s28, -v14
    v_add_f32 v43, v43, v47
    v_cvt_pk_bf16_f32 v33, v46, v47
    v_accvgpr_write_b32 a251, v33
    v_exp_f32 v44, v72
    v_mfma_f32_32x32x16_bf16 v[48:63], v[20:23], v[84:87], v[48:63]
    ds_read_b128 v[248:251], v1 offset:45568
    v_fma_f32 v74, v74, s28, -v14
    v_add_f32 v43, v43, v44
    s_waitcnt lgkmcnt(3)
    v_exp_f32 v45, v73
    v_mfma_f32_32x32x16_bf16 v[48:63], v[24:27], v[88:91], v[48:63]
    ds_read_b128 v[252:255], v2 offset:45568
    v_fma_f32 v75, v75, s28, -v14
    v_add_f32 v43, v43, v45
    v_cvt_pk_bf16_f32 v32, v44, v45
    v_accvgpr_write_b32 a252, v32
    v_exp_f32 v46, v74
    v_mfma_f32_32x32x16_bf16 v[48:63], v[28:31], v[92:95], v[48:63]
    ds_read_b128 v[16:19], v1 offset:32768
    v_fma_f32 v76, v76, s28, -v14
    v_add_f32 v43, v43, v46
    s_waitcnt lgkmcnt(3)
    v_exp_f32 v47, v75
    v_mfma_f32_32x32x16_bf16 v[48:63], v[240:243], v[96:99], v[48:63]
    ds_read_b128 v[20:23], v2 offset:32768
    v_fma_f32 v77, v77, s28, -v14
    v_add_f32 v43, v43, v47
    v_cvt_pk_bf16_f32 v33, v46, v47
    v_accvgpr_write_b32 a253, v33
    v_exp_f32 v44, v76
    v_fma_f32 v78, v78, s28, -v14
    v_add_f32 v43, v43, v44
    v_exp_f32 v45, v77
    v_mfma_f32_32x32x16_bf16 v[48:63], v[244:247], v[100:103], v[48:63]
    ds_read_b128 v[24:27], v1 offset:33280
    v_fma_f32 v79, v79, s28, -v14
    v_add_f32 v43, v43, v45
    v_cvt_pk_bf16_f32 v32, v44, v45
    v_accvgpr_write_b32 a254, v32
    v_exp_f32 v46, v78
    s_nop 0
    v_add_f32 v43, v43, v46
    s_waitcnt lgkmcnt(3)
    v_exp_f32 v47, v79
    v_mfma_f32_32x32x16_bf16 v[48:63], v[248:251], v[104:107], v[48:63]
    ds_read_b128 v[28:31], v2 offset:33280
    v_add_f32 v43, v43, v47
    v_cvt_pk_bf16_f32 v33, v46, v47
    v_accvgpr_write_b32 a255, v33
    v_cmp_ngt_f32 vcc, 2.0, v43
    s_cbranch_vccnz L_rare33
L_back33:
    v_add_f32 v42, v42, v43
    v_mfma_f32_32x32x16_bf16 v[48:63], v[252:255], v[108:111], v[48:63]
    ds_read_b128 v[248:251], v1 offset:36864
    v_mov_b32 v43, v42
    s_nop 1
    v_permlane32_swap_b32 v43, v42
    v_add_f32 v43, v43, v42
    v_rcp_f32 v14, v43
    s_waitcnt lgkmcnt(3)
    v_mfma_f32_32x32x16_bf16 v[64:79], v[16:19], a[32:35], 0
    ds_read_b128 v[252:255], v2 offset:36864
    s_add_u32 m0, s27, 98304
    s_add_u32 s29, s25, 16384
    buffer_load_dwordx4 v6, s[8:11], s29 offen nt lds
    v_xor_b32 v6, 32, v6
    v_mfma_f32_32x32x16_bf16 v[64:79], v[20:23], a[36:39], v[64:79]
    ds_read_b128 v[16:19], v1 offset:37376
    s_add_u32 m0, s27, 102400
    s_add_u32 s29, s25, 20480
    buffer_load_dwordx4 v6, s[8:11], s29 offen nt lds
    v_xor_b32 v6, 32, v6
    s_waitcnt lgkmcnt(3)
    v_mfma_f32_32x32x16_bf16 v[64:79], v[24:27], a[40:43], v[64:79]
    ds_read_b128 v[20:23], v2 offset:37376
    v_fma_f32 v48, v48, s28, -v12
    v_fma_f32 v49, v49, s28, -v12
    v_exp_f32 v44, v48
    v_fma_f32 v50, v50, s28, -v12
    v_exp_f32 v45, v49
    v_mfma_f32_32x32x16_bf16 v[64:79], v[28:31], a[44:47], v[64:79]
    ds_read_b128 v[24:27], v1 offset:40960
    v_fma_f32 v51, v51, s28, -v12
    v_add_f32 v43, v44, v45
    v_cvt_pk_bf16_f32 v240, v44, v45
    s_waitcnt lgkmcnt(3)
    v_exp_f32 v46, v50
    v_mfma_f32_32x32x16_bf16 v[64:79], v[248:251], a[48:51], v[64:79]
    ds_read_b128 v[28:31], v2 offset:40960
    v_fma_f32 v52, v52, s28, -v12
    v_add_f32 v43, v43, v46
    v_exp_f32 v47, v51
    v_fma_f32 v53, v53, s28, -v12
    v_add_f32 v43, v43, v47
    v_cvt_pk_bf16_f32 v241, v46, v47
    v_exp_f32 v44, v52
    v_mfma_f32_32x32x16_bf16 v[64:79], v[252:255], a[52:55], v[64:79]
    ds_read_b128 v[248:251], v1 offset:41472
    v_fma_f32 v54, v54, s28, -v12
    v_add_f32 v43, v43, v44
    s_waitcnt lgkmcnt(3)
    v_exp_f32 v45, v53
    v_mfma_f32_32x32x16_bf16 v[64:79], v[16:19], a[56:59], v[64:79]
    ds_read_b128 v[252:255], v2 offset:41472
    v_fma_f32 v55, v55, s28, -v12
    v_add_f32 v43, v43, v45
    v_cvt_pk_bf16_f32 v242, v44, v45
    v_exp_f32 v46, v54
    v_mfma_f32_32x32x16_bf16 v[64:79], v[20:23], a[60:63], v[64:79]
    ds_read_b128 v[16:19], v1 offset:45056
    v_fma_f32 v56, v56, s28, -v12
    v_add_f32 v43, v43, v46
    s_waitcnt lgkmcnt(3)
    v_exp_f32 v47, v55
    v_mfma_f32_32x32x16_bf16 v[64:79], v[24:27], v[112:115], v[64:79]
    ds_read_b128 v[20:23], v2 offset:45056
    v_fma_f32 v57, v57, s28, -v12
    v_add_f32 v43, v43, v47
    v_cvt_pk_bf16_f32 v243, v46, v47
    v_exp_f32 v44, v56
    v_fma_f32 v58, v58, s28, -v12
    v_add_f32 v43, v43, v44
    v_exp_f32 v45, v57
    v_mfma_f32_32x32x16_bf16 v[64:79], v[28:31], v[116:119], v[64:79]
    ds_read_b128 v[24:27], v1 offset:45568
    v_fma_f32 v59, v59, s28, -v12
    v_add_f32 v43, v43, v45
    v_cvt_pk_bf16_f32 v244, v44, v45
    s_waitcnt lgkmcnt(3)
    v_exp_f32 v46, v58
    v_mfma_f32_32x32x16_bf16 v[64:79], v[248:251], v[120:123], v[64:79]
    ds_read_b128 v[28:31], v2 offset:45568
    v_fma_f32 v60, v60, s28, -v12
    v_add_f32 v43, v43, v46
    v_exp_f32 v47, v59
    v_fma_f32 v61, v61, s28, -v12
    v_add_f32 v43, v43, v47
    v_cvt_pk_bf16_f32 v245, v46, v47
    v_exp_f32 v44, v60
    v_mfma_f32_32x32x16_bf16 v[64:79], v[252:255], v[124:127], v[64:79]
    v_fma_f32 v62, v62, s28, -v12
    v_add_f32 v43, v43, v44
    v_exp_f32 v45, v61
    v_fma_f32 v63, v63, s28, -v12
    v_add_f32 v43, v43, v45
    v_cvt_pk_bf16_f32 v246, v44, v45
    s_waitcnt lgkmcnt(2)
    v_exp_f32 v46, v62
    v_mfma_f32_32x32x16_bf16 v[64:79], v[16:19], v[128:131], v[64:79]
    v_xor_b32 v3, 0xc000, v3
    ds_read_b64_tr_b16 v[16:17], v3 offset:0
    ds_read_b64_tr_b16 v[18:19], v3 offset:1024
    v_add_f32 v43, v43, v46
    v_exp_f32 v47, v63
    v_mfma_f32_32x32x16_bf16 v[64:79], v[20:23], v[132:135], v[64:79]
    ds_read_b64_tr_b16 v[20:21], v3 offset:512
    ds_read_b64_tr_b16 v[22:23], v3 offset:1536
    v_add_f32 v43, v43, v47
    v_cvt_pk_bf16_f32 v247, v46, v47
    s_waitcnt lgkmcnt(4)
    v_mfma_f32_32x32x16_bf16 v[64:79], v[24:27], v[136:139], v[64:79]
    ds_read_b64_tr_b16 v[24:25], v3 offset:2048
    ds_read_b64_tr_b16 v[26:27], v3 offset:3072
    v_cmp_ngt_f32 vcc, 2.0, v43
    s_cbranch_vccnz L_rare34
L_back34:
    v_add_f32 v40, v40, v43
    v_mfma_f32_32x32x16_bf16 v[64:79], v[28:31], v[140:143], v[64:79]
    ds_read_b64_tr_b16 v[28:29], v3 offset:2560
    ds_read_b64_tr_b16 v[30:31], v3 offset:3584
    v_mov_b32 v43, v40
    s_nop 1
    v_permlane32_swap_b32 v43, v40
    v_add_f32 v43, v43, v40
    v_rcp_f32 v12, v43
    s_waitcnt vmcnt(10)
    s_barrier
    s_waitcnt lgkmcnt(4)
    v_mfma_f32_32x32x16_bf16 v[80:95], v[16:19], a[80:83], 0
    ds_read_b64_tr_b16 v[16:17], v3 offset:4096
    ds_read_b64_tr_b16 v[18:19], v3 offset:5120
    v_mfma_f32_32x32x16_bf16 v[96:111], v[20:23], a[80:83], 0
    ds_read_b64_tr_b16 v[20:21], v3 offset:4608
    ds_read_b64_tr_b16 v[22:23], v3 offset:5632
    s_add_u32 m0, s27, 106496
    s_add_u32 s29, s25, 24576
    buffer_load_dwordx4 v6, s[8:11], s29 offen nt lds
    v_xor_b32 v6, 32, v6
    s_waitcnt lgkmcnt(4)
    v_mfma_f32_32x32x16_bf16 v[80:95], v[24:27], a[84:87], v[80:95]
    ds_read_b64_tr_b16 v[24:25], v3 offset:6144
    ds_read_b64_tr_b16 v[26:27], v3 offset:7168
    v_fma_f32 v64, v64, s28, -v13
    v_fma_f32 v65, v65, s28, -v13
    v_exp_f32 v44, v64
    v_fma_f32 v66, v66, s28, -v13
    v_exp_f32 v45, v65
    v_mfma_f32_32x32x16_bf16 v[96:111], v[28:31], a[84:87], v[96:111]
    ds_read_b64_tr_b16 v[28:29], v3 offset:6656
    ds_read_b64_tr_b16 v[30:31], v3 offset:7680
    v_fma_f32 v67, v67, s28, -v13
    v_add_f32 v43, v44, v45
    v_cvt_pk_bf16_f32 v248, v44, v45
    s_waitcnt lgkmcnt(4)
    v_exp_f32 v46, v66
    v_mfma_f32_32x32x16_bf16 v[80:95], v[16:19], a[96:99], v[80:95]
    ds_read_b64_tr_b16 v[16:17], v3 offset:8192
    ds_read_b64_tr_b16 v[18:19], v3 offset:9216
    s_add_u32 m0, s27, 110592
    s_add_u32 s29, s25, 28672
    buffer_load_dwordx4 v6, s[8:11], s29 offen nt lds
    v_xor_b32 v6, 32, v6
    v_fma_f32 v68, v68, s28, -v13
    v_add_f32 v43, v43, v46
    v_exp_f32 v47, v67
    v_mfma_f32_32x32x16_bf16 v[96:111], v[20:23], a[96:99], v[96:111]
    ds_read_b64_tr_b16 v[20:21], v3 offset:8704
    ds_read_b64_tr_b16 v[22:23], v3 offset:9728
    v_fma_f32 v69, v69, s28, -v13
    v_add_f32 v43, v43, v47
    v_cvt_pk_bf16_f32 v249, v46, v47
    s_waitcnt lgkmcnt(4)
    v_exp_f32 v44, v68
    v_mfma_f32_32x32x16_bf16 v[80:95], v[24:27], a[100:103], v[80:95]
    ds_read_b64_tr_b16 v[24:25], v3 offset:10240
    ds_read_b64_tr_b16 v[26:27], v3 offset:11264
    v_fma_f32 v70, v70, s28, -v13
    v_add_f32 v43, v43, v44
    v_exp_f32 v45, v69
    v_fma_f32 v71, v71, s28, -v13
    v_add_f32 v43, v43, v45
    v_cvt_pk_bf16_f32 v250, v44, v45
    v_exp_f32 v46, v70
    v_mfma_f32_32x32x16_bf16 v[96:111], v[28:31], a[100:103], v[96:111]
    ds_read_b64_tr_b16 v[28:29], v3 offset:10752
    ds_read_b64_tr_b16 v[30:31], v3 offset:11776
    s_add_u32 m0, s27, 114688
    s_add_u32 s29, s25, 16512
    buffer_load_dwordx4 v6, s[8:11], s29 offen nt lds
    v_xor_b32 v6, 32, v6
    v_fma_f32 v72, v72, s28, -v13
    v_add_f32 v43, v43, v46
    s_waitcnt lgkmcnt(4)
    v_exp_f32 v47, v71
    v_mfma_f32_32x32x16_bf16 v[80:95], v[16:19], a[112:115], v[80:95]
    ds_read_b64_tr_b16 v[16:17], v3 offset:12288
    ds_read_b64_tr_b16 v[18:19], v3 offset:13312
    v_fma_f32 v73, v73, s28, -v13
    v_add_f32 v43, v43, v47
    v_cvt_pk_bf16_f32 v251, v46, v47
    v_exp_f32 v44, v72
    v_mfma_f32_32x32x16_bf16 v[96:111], v[20:23], a[112:115], v[96:111]
    ds_read_b64_tr_b16 v[20:21], v3 offset:12800
    ds_read_b64_tr_b16 v[22:23], v3 offset:13824
    v_fma_f32 v74, v74, s28, -v13
    v_add_f32 v43, v43, v44
    s_waitcnt lgkmcnt(4)
    v_exp_f32 v45, v73
    v_mfma_f32_32x32x16_bf16 v[80:95], v[24:27], a[116:119], v[80:95]
    ds_read_b64_tr_b16 v[24:25], v3 offset:14336
    ds_read_b64_tr_b16 v[26:27], v3 offset:15360
    s_add_u32 m0, s27, 118784
    s_add_u32 s29, s25, 20608
    buffer_load_dwordx4 v6, s[8:11], s29 offen nt lds
    v_xor_b32 v6, 32, v6
    v_fma_f32 v75, v75, s28, -v13
    v_add_f32 v43, v43, v45
    v_cvt_pk_bf16_f32 v252, v44, v45
    v_exp_f32 v46, v74
    v_mfma_f32_32x32x16_bf16 v[96:111], v[28:31], a[116:119], v[96:111]
    ds_read_b64_tr_b16 v[28:29], v3 offset:14848
    ds_read_b64_tr_b16 v[30:31], v3 offset:15872
    v_fma_f32 v76, v76, s28, -v13
    v_add_f32 v43, v43, v46
    s_waitcnt lgkmcnt(4)
    v_exp_f32 v47, v75
    v_mfma_f32_32x32x16_bf16 v[80:95], v[16:19], a[128:131], v[80:95]
    ds_read_b64_tr_b16 v[16:17], v3 offset:0
    ds_read_b64_tr_b16 v[18:19], v3 offset:1024
    v_fma_f32 v77, v77, s28, -v13
    v_add_f32 v43, v43, v47
    v_cvt_pk_bf16_f32 v253, v46, v47
    v_exp_f32 v44, v76
    v_mfma_f32_32x32x16_bf16 v[96:111], v[20:23], a[128:131], v[96:111]
    ds_read_b64_tr_b16 v[20:21], v3 offset:512
    ds_read_b64_tr_b16 v[22:23], v3 offset:1536
    s_add_u32 m0, s27, 122880
    s_add_u32 s29, s25, 24704
    buffer_load_dwordx4 v6, s[8:11], s29 offen nt lds
    v_xor_b32 v6, 32, v6
    v_fma_f32 v78, v78, s28, -v13
    v_add_f32 v43, v43, v44
    s_waitcnt lgkmcnt(4)
    v_exp_f32 v45, v77
    v_mfma_f32_32x32x16_bf16 v[80:95], v[24:27], a[132:135], v[80:95]
    ds_read_b64_tr_b16 v[24:25], v3 offset:2048
    ds_read_b64_tr_b16 v[26:27], v3 offset:3072
    v_fma_f32 v79, v79, s28, -v13
    v_add_f32 v43, v43, v45
    v_cvt_pk_bf16_f32 v254, v44, v45
    v_exp_f32 v46, v78
    s_nop 0
    v_add_f32 v43, v43, v46
    v_exp_f32 v47, v79
    v_mfma_f32_32x32x16_bf16 v[96:111], v[28:31], a[132:135], v[96:111]
    ds_read_b64_tr_b16 v[28:29], v3 offset:2560
    ds_read_b64_tr_b16 v[30:31], v3 offset:3584
    ds_read_b64_tr_b16 a[64:65], v3 offset:4096
    ds_read_b64_tr_b16 a[66:67], v3 offset:5120
    ds_read_b64_tr_b16 a[68:69], v3 offset:4608
    ds_read_b64_tr_b16 a[70:71], v3 offset:5632
    ds_read_b64_tr_b16 a[72:73], v3 offset:6144
    ds_read_b64_tr_b16 a[74:75], v3 offset:7168
    v_add_f32 v43, v43, v47
    v_cvt_pk_bf16_f32 v255, v46, v47
    v_cmp_ngt_f32 vcc, 2.0, v43
    s_cbranch_vccnz L_rare35
L_back35:
    v_add_f32 v41, v41, v43
    v_mov_b32 v43, v41
    s_nop 1
    v_permlane32_swap_b32 v43, v41
    v_add_f32 v43, v43, v41
    v_rcp_f32 v13, v43
    s_waitcnt lgkmcnt(10)
    v_mfma_f32_32x32x16_bf16 v[48:63], v[16:19], v[144:147], 0
    ds_read_b64_tr_b16 a[76:77], v3 offset:6656
    ds_read_b64_tr_b16 a[78:79], v3 offset:7680
    s_add_u32 m0, s27, 126976
    s_add_u32 s29, s25, 28800
    buffer_load_dwordx4 v6, s[8:11], s29 offen nt lds
    v_xor_b32 v6, 32, v6
    v_mfma_f32_32x32x16_bf16 v[64:79], v[20:23], v[144:147], 0
    ds_read_b64_tr_b16 v[16:17], v3 offset:8192
    ds_read_b64_tr_b16 v[18:19], v3 offset:9216
    s_waitcnt lgkmcnt(10)
    v_mfma_f32_32x32x16_bf16 v[48:63], v[24:27], v[148:151], v[48:63]
    ds_read_b64_tr_b16 v[20:21], v3 offset:8704
    ds_read_b64_tr_b16 v[22:23], v3 offset:9728
    v_mfma_f32_32x32x16_bf16 v[64:79], v[28:31], v[148:151], v[64:79]
    ds_read_b64_tr_b16 v[24:25], v3 offset:10240
    ds_read_b64_tr_b16 v[26:27], v3 offset:11264
    s_add_u32 m0, s27, 81920
    s_add_u32 s29, s24, 131200
    buffer_load_dwordx4 v5, s[16:19], s29 offen nt lds
    s_waitcnt lgkmcnt(10)
    v_mfma_f32_32x32x16_bf16 v[48:63], a[64:67], v[152:155], v[48:63]
    ds_read_b64_tr_b16 v[28:29], v3 offset:10752
    ds_read_b64_tr_b16 v[30:31], v3 offset:11776
    v_mfma_f32_32x32x16_bf16 v[64:79], a[68:71], v[152:155], v[64:79]
    ds_read_b64_tr_b16 a[64:65], v3 offset:12288
    ds_read_b64_tr_b16 a[66:67], v3 offset:13312
    s_waitcnt lgkmcnt(10)
    v_mfma_f32_32x32x16_bf16 v[48:63], a[72:75], v[156:159], v[48:63]
    ds_read_b64_tr_b16 a[68:69], v3 offset:12800
    ds_read_b64_tr_b16 a[70:71], v3 offset:13824
    s_add_u32 m0, s27, 86016
    s_add_u32 s29, s24, 147584
    buffer_load_dwordx4 v5, s[16:19], s29 offen nt lds
    v_mfma_f32_32x32x16_bf16 v[64:79], a[76:79], v[156:159], v[64:79]
    ds_read_b64_tr_b16 a[72:73], v3 offset:14336
    ds_read_b64_tr_b16 a[74:75], v3 offset:15360
    s_waitcnt lgkmcnt(10)
    v_mfma_f32_32x32x16_bf16 v[48:63], v[16:19], v[160:163], v[48:63]
    ds_read_b64_tr_b16 a[76:77], v3 offset:14848
    ds_read_b64_tr_b16 a[78:79], v3 offset:15872
    v_mfma_f32_32x32x16_bf16 v[64:79], v[20:23], v[160:163], v[64:79]
    ds_read_b64_tr_b16 v[16:17], v3 offset:16384
    ds_read_b64_tr_b16 v[18:19], v3 offset:17408
    s_add_u32 m0, s27, 90112
    s_add_u32 s29, s24, 163968
    buffer_load_dwordx4 v5, s[16:19], s29 offen nt lds
    s_waitcnt lgkmcnt(10)
    v_mfma_f32_32x32x16_bf16 v[48:63], v[24:27], v[164:167], v[48:63]
    ds_read_b64_tr_b16 v[20:21], v3 offset:16896
    ds_read_b64_tr_b16 v[22:23], v3 offset:17920
    v_mfma_f32_32x32x16_bf16 v[64:79], v[28:31], v[164:167], v[64:79]
    ds_read_b64_tr_b16 v[24:25], v3 offset:18432
    ds_read_b64_tr_b16 v[26:27], v3 offset:19456
    s_waitcnt lgkmcnt(10)
    v_mfma_f32_32x32x16_bf16 v[48:63], a[64:67], v[168:171], v[48:63]
    ds_read_b64_tr_b16 v[28:29], v3 offset:18944
    ds_read_b64_tr_b16 v[30:31], v3 offset:19968
    s_add_u32 m0, s27, 94208
    s_add_u32 s29, s24, 180352
    buffer_load_dwordx4 v5, s[16:19], s29 offen nt lds
    v_mfma_f32_32x32x16_bf16 v[64:79], a[68:71], v[168:171], v[64:79]
    ds_read_b64_tr_b16 a[64:65], v3 offset:20480
    ds_read_b64_tr_b16 a[66:67], v3 offset:21504
    s_waitcnt lgkmcnt(10)
    v_mfma_f32_32x32x16_bf16 v[48:63], a[72:75], v[172:175], v[48:63]
    ds_read_b64_tr_b16 a[68:69], v3 offset:20992
    ds_read_b64_tr_b16 a[70:71], v3 offset:22016
    v_mfma_f32_32x32x16_bf16 v[64:79], a[76:79], v[172:175], v[64:79]
    ds_read_b64_tr_b16 a[72:73], v3 offset:22528
    ds_read_b64_tr_b16 a[74:75], v3 offset:23552
    s_add_u32 m0, s27, 131072
    s_add_u32 s29, s25, 32768
    buffer_load_dwordx4 v6, s[8:11], s29 offen nt lds
    v_xor_b32 v6, 32, v6
    s_waitcnt lgkmcnt(10)
    v_mfma_f32_32x32x16_bf16 v[80:95], v[16:19], a[144:147], v[80:95]
    ds_read_b64_tr_b16 a[76:77], v3 offset:23040
    ds_read_b64_tr_b16 a[78:79], v3 offset:24064
    v_mfma_f32_32x32x16_bf16 v[96:111], v[20:23], a[144:147], v[96:111]
    ds_read_b64_tr_b16 v[16:17], v3 offset:24576
    ds_read_b64_tr_b16 v[18:19], v3 offset:25600
    s_waitcnt lgkmcnt(10)
    v_mfma_f32_32x32x16_bf16 v[80:95], v[24:27], a[148:151], v[80:95]
    ds_read_b64_tr_b16 v[20:21], v3 offset:25088
    ds_read_b64_tr_b16 v[22:23], v3 offset:26112
    s_add_u32 m0, s27, 135168
    s_add_u32 s29, s25, 36864
    buffer_load_dwordx4 v6, s[8:11], s29 offen nt lds
    v_xor_b32 v6, 32, v6
    v_mfma_f32_32x32x16_bf16 v[96:111], v[28:31], a[148:151], v[96:111]
    ds_read_b64_tr_b16 v[24:25], v3 offset:26624
    ds_read_b64_tr_b16 v[26:27], v3 offset:27648
    s_waitcnt lgkmcnt(10)
    v_mfma_f32_32x32x16_bf16 v[80:95], a[64:67], a[160:163], v[80:95]
    ds_read_b64_tr_b16 v[28:29], v3 offset:27136
    ds_read_b64_tr_b16 v[30:31], v3 offset:28160
    v_mfma_f32_32x32x16_bf16 v[96:111], a[68:71], a[160:163], v[96:111]
    ds_read_b64_tr_b16 a[64:65], v3 offset:28672
    ds_read_b64_tr_b16 a[66:67], v3 offset:29696
    s_add_u32 m0, s27, 139264
    s_add_u32 s29, s25, 40960
    buffer_load_dwordx4 v6, s[8:11], s29 offen nt lds
    v_xor_b32 v6, 32, v6
    s_waitcnt lgkmcnt(10)
    v_mfma_f32_32x32x16_bf16 v[80:95], a[72:75], a[164:167], v[80:95]
    ds_read_b64_tr_b16 a[68:69], v3 offset:29184
    ds_read_b64_tr_b16 a[70:71], v3 offset:30208
    v_mfma_f32_32x32x16_bf16 v[96:111], a[76:79], a[164:167], v[96:111]
    ds_read_b64_tr_b16 a[72:73], v3 offset:30720
    ds_read_b64_tr_b16 a[74:75], v3 offset:31744
    s_waitcnt lgkmcnt(10)
    v_mfma_f32_32x32x16_bf16 v[80:95], v[16:19], a[176:179], v[80:95]
    ds_read_b64_tr_b16 a[76:77], v3 offset:31232
    ds_read_b64_tr_b16 a[78:79], v3 offset:32256
    s_add_u32 m0, s27, 143360
    s_add_u32 s29, s25, 45056
    buffer_load_dwordx4 v6, s[8:11], s29 offen nt lds
    v_xor_b32 v6, 32, v6
    v_mfma_f32_32x32x16_bf16 v[96:111], v[20:23], a[176:179], v[96:111]
    ds_read_b64_tr_b16 v[16:17], v3 offset:0
    ds_read_b64_tr_b16 v[18:19], v3 offset:1024
    s_waitcnt lgkmcnt(10)
    v_mfma_f32_32x32x16_bf16 v[80:95], v[24:27], a[180:183], v[80:95]
    ds_read_b64_tr_b16 v[20:21], v3 offset:512
    ds_read_b64_tr_b16 v[22:23], v3 offset:1536
    v_mfma_f32_32x32x16_bf16 v[96:111], v[28:31], a[180:183], v[96:111]
    ds_read_b64_tr_b16 v[24:25], v3 offset:2048
    ds_read_b64_tr_b16 v[26:27], v3 offset:3072
    s_waitcnt lgkmcnt(10)
    v_mfma_f32_32x32x16_bf16 v[80:95], a[64:67], a[192:195], v[80:95]
    ds_read_b64_tr_b16 v[28:29], v3 offset:2560
    ds_read_b64_tr_b16 v[30:31], v3 offset:3584
    v_mfma_f32_32x32x16_bf16 v[96:111], a[68:71], a[192:195], v[96:111]
    ds_read_b64_tr_b16 a[64:65], v3 offset:4096
    ds_read_b64_tr_b16 a[66:67], v3 offset:5120
    s_waitcnt lgkmcnt(10)
    v_mfma_f32_32x32x16_bf16 v[80:95], a[72:75], a[196:199], v[80:95]
    ds_read_b64_tr_b16 a[68:69], v3 offset:4608
    ds_read_b64_tr_b16 a[70:71], v3 offset:5632
    v_mfma_f32_32x32x16_bf16 v[96:111], a[76:79], a[196:199], v[96:111]
    ds_read_b64_tr_b16 a[72:73], v3 offset:6144
    ds_read_b64_tr_b16 a[74:75], v3 offset:7168
    s_waitcnt lgkmcnt(6)
    v_mfma_f32_32x32x16_bf16 v[112:127], v[16:19], a[88:91], 0
    ds_read_b64_tr_b16 a[76:77], v3 offset:6656
    ds_read_b64_tr_b16 a[78:79], v3 offset:7680
    v_mfma_f32_32x32x16_bf16 v[128:143], v[20:23], a[88:91], 0
    ds_read_b64_tr_b16 v[16:17], v3 offset:8192
    ds_read_b64_tr_b16 v[18:19], v3 offset:9216
    v_mfma_f32_32x32x16_bf16 v[112:127], v[24:27], a[92:95], v[112:127]
    ds_read_b64_tr_b16 v[20:21], v3 offset:8704
    ds_read_b64_tr_b16 v[22:23], v3 offset:9728
    v_mfma_f32_32x32x16_bf16 v[128:143], v[28:31], a[92:95], v[128:143]
    ds_read_b64_tr_b16 v[24:25], v3 offset:10240
    ds_read_b64_tr_b16 v[26:27], v3 offset:11264
    s_waitcnt lgkmcnt(6)
    v_mfma_f32_32x32x16_bf16 v[112:127], a[64:67], a[104:107], v[112:127]
    ds_read_b64_tr_b16 v[28:29], v3 offset:10752
    ds_read_b64_tr_b16 v[30:31], v3 offset:11776
    v_mfma_f32_32x32x16_bf16 v[128:143], a[68:71], a[104:107], v[128:143]
    ds_read_b64_tr_b16 a[64:65], v3 offset:12288
    ds_read_b64_tr_b16 a[66:67], v3 offset:13312
    v_mfma_f32_32x32x16_bf16 v[112:127], a[72:75], a[108:111], v[112:127]
    ds_read_b64_tr_b16 a[68:69], v3 offset:12800
    ds_read_b64_tr_b16 a[70:71], v3 offset:13824
    v_mfma_f32_32x32x16_bf16 v[128:143], a[76:79], a[108:111], v[128:143]
    ds_read_b64_tr_b16 a[72:73], v3 offset:14336
    ds_read_b64_tr_b16 a[74:75], v3 offset:15360
    s_waitcnt lgkmcnt(6)
    v_mfma_f32_32x32x16_bf16 v[112:127], v[16:19], a[120:123], v[112:127]
    ds_read_b64_tr_b16 a[76:77], v3 offset:14848
    ds_read_b64_tr_b16 a[78:79], v3 offset:15872
    v_mfma_f32_32x32x16_bf16 v[128:143], v[20:23], a[120:123], v[128:143]
    ds_read_b64_tr_b16 v[16:17], v3 offset:16384
    ds_read_b64_tr_b16 v[18:19], v3 offset:17408
    v_mfma_f32_32x32x16_bf16 v[112:127], v[24:27], a[124:127], v[112:127]
    ds_read_b64_tr_b16 v[20:21], v3 offset:16896
    ds_read_b64_tr_b16 v[22:23], v3 offset:17920
    v_mfma_f32_32x32x16_bf16 v[128:143], v[28:31], a[124:127], v[128:143]
    ds_read_b64_tr_b16 v[24:25], v3 offset:18432
    ds_read_b64_tr_b16 v[26:27], v3 offset:19456
    s_waitcnt lgkmcnt(6)
    v_mfma_f32_32x32x16_bf16 v[112:127], a[64:67], a[136:139], v[112:127]
    ds_read_b64_tr_b16 v[28:29], v3 offset:18944
    ds_read_b64_tr_b16 v[30:31], v3 offset:19968
    v_mfma_f32_32x32x16_bf16 v[128:143], a[68:71], a[136:139], v[128:143]
    ds_read_b64_tr_b16 a[64:65], v3 offset:20480
    ds_read_b64_tr_b16 a[66:67], v3 offset:21504
    v_mfma_f32_32x32x16_bf16 v[112:127], a[72:75], a[140:143], v[112:127]
    ds_read_b64_tr_b16 a[68:69], v3 offset:20992
    ds_read_b64_tr_b16 a[70:71], v3 offset:22016
    v_mfma_f32_32x32x16_bf16 v[128:143], a[76:79], a[140:143], v[128:143]
    ds_read_b64_tr_b16 a[72:73], v3 offset:22528
    ds_read_b64_tr_b16 a[74:75], v3 offset:23552
    s_waitcnt lgkmcnt(6)
    v_mfma_f32_32x32x16_bf16 v[48:63], v[16:19], v[176:179], v[48:63]
    ds_read_b64_tr_b16 a[76:77], v3 offset:23040
    ds_read_b64_tr_b16 a[78:79], v3 offset:24064
    v_mfma_f32_32x32x16_bf16 v[64:79], v[20:23], v[176:179], v[64:79]
    ds_read_b64_tr_b16 v[16:17], v3 offset:24576
    ds_read_b64_tr_b16 v[18:19], v3 offset:25600
    v_mfma_f32_32x32x16_bf16 v[48:63], v[24:27], v[180:183], v[48:63]
    ds_read_b64_tr_b16 v[20:21], v3 offset:25088
    ds_read_b64_tr_b16 v[22:23], v3 offset:26112
    v_mfma_f32_32x32x16_bf16 v[64:79], v[28:31], v[180:183], v[64:79]
    ds_read_b64_tr_b16 v[24:25], v3 offset:26624
    ds_read_b64_tr_b16 v[26:27], v3 offset:27648
    s_waitcnt lgkmcnt(6)
    v_mfma_f32_32x32x16_bf16 v[48:63], a[64:67], v[184:187], v[48:63]
    ds_read_b64_tr_b16 v[28:29], v3 offset:27136
    ds_read_b64_tr_b16 v[30:31], v3 offset:28160
    v_mfma_f32_32x32x16_bf16 v[64:79], a[68:71], v[184:187], v[64:79]
    ds_read_b64_tr_b16 a[64:65], v3 offset:28672
    ds_read_b64_tr_b16 a[66:67], v3 offset:29696
    v_mfma_f32_32x32x16_bf16 v[48:63], a[72:75], v[188:191], v[48:63]
    ds_read_b64_tr_b16 a[68:69], v3 offset:29184
    ds_read_b64_tr_b16 a[70:71], v3 offset:30208
    v_mfma_f32_32x32x16_bf16 v[64:79], a[76:79], v[188:191], v[64:79]
    ds_read_b64_tr_b16 a[72:73], v3 offset:30720
    ds_read_b64_tr_b16 a[74:75], v3 offset:31744
    s_waitcnt lgkmcnt(6)
    v_mfma_f32_32x32x16_bf16 v[48:63], v[16:19], v[192:195], v[48:63]
    ds_read_b64_tr_b16 a[76:77], v3 offset:31232
    ds_read_b64_tr_b16 a[78:79], v3 offset:32256
    v_mfma_f32_32x32x16_bf16 v[64:79], v[20:23], v[192:195], v[64:79]
    ds_read_b64_tr_b16 v[16:17], v3 offset:32768
    ds_read_b64_tr_b16 v[18:19], v3 offset:33792
    v_mfma_f32_32x32x16_bf16 v[48:63], v[24:27], v[196:199], v[48:63]
    ds_read_b64_tr_b16 v[20:21], v3 offset:33280
    ds_read_b64_tr_b16 v[22:23], v3 offset:34304
    v_mfma_f32_32x32x16_bf16 v[64:79], v[28:31], v[196:199], v[64:79]
    ds_read_b64_tr_b16 v[24:25], v3 offset:34816
    ds_read_b64_tr_b16 v[26:27], v3 offset:35840
    s_waitcnt lgkmcnt(6)
    v_mfma_f32_32x32x16_bf16 v[48:63], a[64:67], v[200:203], v[48:63]
    ds_read_b64_tr_b16 v[28:29], v3 offset:35328
    ds_read_b64_tr_b16 v[30:31], v3 offset:36352
    v_mfma_f32_32x32x16_bf16 v[64:79], a[68:71], v[200:203], v[64:79]
    ds_read_b64_tr_b16 a[64:65], v3 offset:36864
    ds_read_b64_tr_b16 a[66:67], v3 offset:37888
    v_mfma_f32_32x32x16_bf16 v[48:63], a[72:75], v[204:207], v[48:63]
    ds_read_b64_tr_b16 a[68:69], v3 offset:37376
    ds_read_b64_tr_b16 a[70:71], v3 offset:38400
    v_mfma_f32_32x32x16_bf16 v[64:79], a[76:79], v[204:207], v[64:79]
    ds_read_b64_tr_b16 a[72:73], v3 offset:38912
    ds_read_b64_tr_b16 a[74:75], v3 offset:39936
    s_waitcnt lgkmcnt(6)
    v_mfma_f32_32x32x16_bf16 v[80:95], v[16:19], a[208:211], v[80:95]
    ds_read_b64_tr_b16 a[76:77], v3 offset:39424
    ds_read_b64_tr_b16 a[78:79], v3 offset:40448
    v_mfma_f32_32x32x16_bf16 v[96:111], v[20:23], a[208:211], v[96:111]
    ds_read_b64_tr_b16 v[16:17], v3 offset:40960
    ds_read_b64_tr_b16 v[18:19], v3 offset:41984
    v_mfma_f32_32x32x16_bf16 v[80:95], v[24:27], a[212:215], v[80:95]
    ds_read_b64_tr_b16 v[20:21], v3 offset:41472
    ds_read_b64_tr_b16 v[22:23], v3 offset:42496
    v_mfma_f32_32x32x16_bf16 v[96:111], v[28:31], a[212:215], v[96:111]
    ds_read_b64_tr_b16 v[24:25], v3 offset:43008
    ds_read_b64_tr_b16 v[26:27], v3 offset:44032
    s_waitcnt lgkmcnt(6)
    v_mfma_f32_32x32x16_bf16 v[80:95], a[64:67], a[224:227], v[80:95]
    ds_read_b64_tr_b16 v[28:29], v3 offset:43520
    ds_read_b64_tr_b16 v[30:31], v3 offset:44544
    v_mfma_f32_32x32x16_bf16 v[96:111], a[68:71], a[224:227], v[96:111]
    ds_read_b64_tr_b16 a[64:65], v3 offset:45056
    ds_read_b64_tr_b16 a[66:67], v3 offset:46080
    v_mfma_f32_32x32x16_bf16 v[80:95], a[72:75], a[228:231], v[80:95]
    ds_read_b64_tr_b16 a[68:69], v3 offset:45568
    ds_read_b64_tr_b16 a[70:71], v3 offset:46592
    v_mfma_f32_32x32x16_bf16 v[96:111], a[76:79], a[228:231], v[96:111]
    ds_read_b64_tr_b16 a[72:73], v3 offset:47104
    ds_read_b64_tr_b16 a[74:75], v3 offset:48128
    s_waitcnt lgkmcnt(6)
    v_mfma_f32_32x32x16_bf16 v[80:95], v[16:19], a[240:243], v[80:95]
    ds_read_b64_tr_b16 a[76:77], v3 offset:47616
    ds_read_b64_tr_b16 a[78:79], v3 offset:48640
    v_mfma_f32_32x32x16_bf16 v[96:111], v[20:23], a[240:243], v[96:111]
    ds_read_b64_tr_b16 v[16:17], v3 offset:16384
    ds_read_b64_tr_b16 v[18:19], v3 offset:17408
    v_mfma_f32_32x32x16_bf16 v[80:95], v[24:27], a[244:247], v[80:95]
    ds_read_b64_tr_b16 v[20:21], v3 offset:16896
    ds_read_b64_tr_b16 v[22:23], v3 offset:17920
    v_mfma_f32_32x32x16_bf16 v[96:111], v[28:31], a[244:247], v[96:111]
    ds_read_b64_tr_b16 v[24:25], v3 offset:18432
    ds_read_b64_tr_b16 v[26:27], v3 offset:19456
    s_waitcnt lgkmcnt(6)
    v_mfma_f32_32x32x16_bf16 v[80:95], a[64:67], a[248:251], v[80:95]
    ds_read_b64_tr_b16 v[28:29], v3 offset:18944
    ds_read_b64_tr_b16 v[30:31], v3 offset:19968
    v_mfma_f32_32x32x16_bf16 v[96:111], a[68:71], a[248:251], v[96:111]
    ds_read_b64_tr_b16 a[64:65], v3 offset:20480
    ds_read_b64_tr_b16 a[66:67], v3 offset:21504
    v_mfma_f32_32x32x16_bf16 v[80:95], a[72:75], a[252:255], v[80:95]
    ds_read_b64_tr_b16 a[68:69], v3 offset:20992
    ds_read_b64_tr_b16 a[70:71], v3 offset:22016
    v_mfma_f32_32x32x16_bf16 v[96:111], a[76:79], a[252:255], v[96:111]
    ds_read_b64_tr_b16 a[72:73], v3 offset:22528
    ds_read_b64_tr_b16 a[74:75], v3 offset:23552
    s_waitcnt vmcnt(20)
    s_barrier
    s_waitcnt lgkmcnt(6)
    v_mfma_f32_32x32x16_bf16 v[112:127], v[16:19], a[152:155], v[112:127]
    ds_read_b64_tr_b16 a[76:77], v3 offset:23040
    ds_read_b64_tr_b16 a[78:79], v3 offset:24064
    v_mfma_f32_32x32x16_bf16 v[128:143], v[20:23], a[152:155], v[128:143]
    ds_read_b64_tr_b16 v[16:17], v3 offset:24576
    ds_read_b64_tr_b16 v[18:19], v3 offset:25600
    s_add_u32 m0, s27, 0
    s_add_u32 s29, s24, 256
    buffer_load_dwordx4 v5, s[16:19], s29 offen nt lds
    v_mfma_f32_32x32x16_bf16 v[112:127], v[24:27], a[156:159], v[112:127]
    ds_read_b64_tr_b16 v[20:21], v3 offset:25088
    ds_read_b64_tr_b16 v[22:23], v3 offset:26112
    v_mul_f32 v80, v80, v14
    v_mul_f32 v81, v81, v14
    v_cvt_pk_bf16_f32 v32, v80, v81
    v_mul_f32 v82, v82, v14
    v_mfma_f32_32x32x16_bf16 v[128:143], v[28:31], a[156:159], v[128:143]
    ds_read_b64_tr_b16 v[24:25], v3 offset:26624
    ds_read_b64_tr_b16 v[26:27], v3 offset:27648
    v_mul_f32 v83, v83, v14
    v_cvt_pk_bf16_f32 v33, v82, v83
    v_mul_f32 v84, v84, v14
    s_waitcnt lgkmcnt(6)
    v_mfma_f32_32x32x16_bf16 v[112:127], a[64:67], a[168:171], v[112:127]
    ds_read_b64_tr_b16 v[28:29], v3 offset:27136
    ds_read_b64_tr_b16 v[30:31], v3 offset:28160
    s_add_u32 m0, s27, 4096
    s_add_u32 s29, s24, 16640
    buffer_load_dwordx4 v5, s[16:19], s29 offen nt lds
    v_mfma_f32_32x32x16_bf16 v[128:143], a[68:71], a[168:171], v[128:143]
    ds_read_b64_tr_b16 a[64:65], v3 offset:28672
    ds_read_b64_tr_b16 a[66:67], v3 offset:29696
    s_waitcnt vmcnt(14)
    ds_read_b128 a[32:35], v7 offset:0
    v_mul_f32 v85, v85, v14
    v_cvt_pk_bf16_f32 v34, v84, v85
    v_mul_f32 v86, v86, v14
    v_mfma_f32_32x32x16_bf16 v[112:127], a[72:75], a[172:175], v[112:127]
    ds_read_b64_tr_b16 a[68:69], v3 offset:29184
    ds_read_b64_tr_b16 a[70:71], v3 offset:30208
    ds_read_b128 a[36:39], v8 offset:0
    ds_read_b128 a[40:43], v7 offset:512
    ds_read_b128 a[44:47], v8 offset:512
    v_mul_f32 v87, v87, v14
    v_cvt_pk_bf16_f32 v35, v86, v87
    v_mfma_f32_32x32x16_bf16 v[128:143], a[76:79], a[172:175], v[128:143]
    ds_read_b64_tr_b16 a[72:73], v3 offset:30720
    ds_read_b64_tr_b16 a[74:75], v3 offset:31744
    s_add_u32 m0, s27, 8192
    s_add_u32 s29, s24, 33024
    buffer_load_dwordx4 v5, s[16:19], s29 offen nt lds
    s_waitcnt lgkmcnt(10)
    v_mfma_f32_32x32x16_bf16 v[112:127], v[16:19], a[184:187], v[112:127]
    ds_read_b64_tr_b16 a[76:77], v3 offset:31232
    ds_read_b64_tr_b16 a[78:79], v3 offset:32256
    ds_write_b128 v9, v[32:35]
    v_mfma_f32_32x32x16_bf16 v[128:143], v[20:23], a[184:187], v[128:143]
    ds_read_b64_tr_b16 v[16:17], v3 offset:32768
    ds_read_b64_tr_b16 v[18:19], v3 offset:33792
    v_mul_f32 v88, v88, v14
    v_mul_f32 v89, v89, v14
    v_cvt_pk_bf16_f32 v36, v88, v89
    v_mul_f32 v90, v90, v14
    v_mfma_f32_32x32x16_bf16 v[112:127], v[24:27], a[188:191], v[112:127]
    ds_read_b64_tr_b16 v[20:21], v3 offset:33280
    ds_read_b64_tr_b16 v[22:23], v3 offset:34304
    s_add_u32 m0, s27, 12288
    s_add_u32 s29, s24, 49408
    buffer_load_dwordx4 v5, s[16:19], s29 offen nt lds
    s_waitcnt lgkmcnt(9)
    v_mfma_f32_32x32x16_bf16 v[128:143], v[28:31], a[188:191], v[128:143]
    ds_read_b64_tr_b16 v[24:25], v3 offset:34816
    ds_read_b64_tr_b16 v[26:27], v3 offset:35840
    v_mul_f32 v91, v91, v14
    v_cvt_pk_bf16_f32 v37, v90, v91
    v_mul_f32 v92, v92, v14
    s_waitcnt lgkmcnt(7)
    v_mfma_f32_32x32x16_bf16 v[112:127], a[64:67], a[200:203], v[112:127]
    ds_read_b64_tr_b16 v[28:29], v3 offset:35328
    ds_read_b64_tr_b16 v[30:31], v3 offset:36352
    v_mul_f32 v93, v93, v14
    v_cvt_pk_bf16_f32 v38, v92, v93
    v_mul_f32 v94, v94, v14
    v_mul_f32 v95, v95, v14
    v_cvt_pk_bf16_f32 v39, v94, v95
    v_mfma_f32_32x32x16_bf16 v[128:143], a[68:71], a[200:203], v[128:143]
    ds_read_b64_tr_b16 a[64:65], v3 offset:36864
    ds_read_b64_tr_b16 a[66:67], v3 offset:37888
    s_add_u32 m0, s27, 98304
    s_add_u32 s29, s25, 0
    buffer_load_dwordx4 v6, s[8:11], s29 offen nt lds
    v_xor_b32 v6, 32, v6
    v_mfma_f32_32x32x16_bf16 v[112:127], a[72:75], a[204:207], v[112:127]
    ds_read_b64_tr_b16 a[68:69], v3 offset:37376
    ds_read_b64_tr_b16 a[70:71], v3 offset:38400
    v_xor_b32 v0, 32, v9
    ds_write_b128 v0, v[36:39]
    v_mfma_f32_32x32x16_bf16 v[128:143], a[76:79], a[204:207], v[128:143]
    ds_read_b64_tr_b16 a[72:73], v3 offset:38912
    ds_read_b64_tr_b16 a[74:75], v3 offset:39936
    v_mul_f32 v96, v96, v14
    v_mul_f32 v97, v97, v14
    v_cvt_pk_bf16_f32 v32, v96, v97
    s_waitcnt lgkmcnt(7)
    v_mfma_f32_32x32x16_bf16 v[48:63], v[16:19], v[208:211], v[48:63]
    ds_read_b64_tr_b16 a[76:77], v3 offset:39424
    ds_read_b64_tr_b16 a[78:79], v3 offset:40448
    s_add_u32 m0, s27, 102400
    s_add_u32 s29, s25, 4096
    buffer_load_dwordx4 v6, s[8:11], s29 offen nt lds
    v_xor_b32 v6, 32, v6
    v_mfma_f32_32x32x16_bf16 v[64:79], v[20:23], v[208:211], v[64:79]
    ds_read_b64_tr_b16 v[16:17], v3 offset:40960
    ds_read_b64_tr_b16 v[18:19], v3 offset:41984
    v_mul_f32 v98, v98, v14
    v_mul_f32 v99, v99, v14
    v_cvt_pk_bf16_f32 v33, v98, v99
    v_mul_f32 v100, v100, v14
    v_mfma_f32_32x32x16_bf16 v[48:63], v[24:27], v[212:215], v[48:63]
    ds_read_b64_tr_b16 v[20:21], v3 offset:41472
    ds_read_b64_tr_b16 v[22:23], v3 offset:42496
    v_mul_f32 v101, v101, v14
    v_cvt_pk_bf16_f32 v34, v100, v101
    v_mul_f32 v102, v102, v14
    v_mul_f32 v103, v103, v14
    v_cvt_pk_bf16_f32 v35, v102, v103
    v_mfma_f32_32x32x16_bf16 v[64:79], v[28:31], v[212:215], v[64:79]
    ds_read_b64_tr_b16 v[24:25], v3 offset:43008
    ds_read_b64_tr_b16 v[26:27], v3 offset:44032
    s_add_u32 m0, s27, 106496
    s_add_u32 s29, s25, 8192
    buffer_load_dwordx4 v6, s[8:11], s29 offen nt lds
    v_xor_b32 v6, 32, v6
    s_waitcnt lgkmcnt(6)
    v_mfma_f32_32x32x16_bf16 v[48:63], a[64:67], v[216:219], v[48:63]
    ds_read_b64_tr_b16 v[28:29], v3 offset:43520
    ds_read_b64_tr_b16 v[30:31], v3 offset:44544
    v_xor_b32 v0, 64, v9
    ds_write_b128 v0, v[32:35]
    v_mfma_f32_32x32x16_bf16 v[64:79], a[68:71], v[216:219], v[64:79]
    ds_read_b64_tr_b16 a[64:65], v3 offset:45056
    ds_read_b64_tr_b16 a[66:67], v3 offset:46080
    v_mul_f32 v104, v104, v14
    v_mul_f32 v105, v105, v14
    v_cvt_pk_bf16_f32 v36, v104, v105
    v_mul_f32 v106, v106, v14
    v_mul_f32 v107, v107, v14
    v_cvt_pk_bf16_f32 v37, v106, v107
    v_mfma_f32_32x32x16_bf16 v[48:63], a[72:75], v[220:223], v[48:63]
    ds_read_b64_tr_b16 a[68:69], v3 offset:45568
    ds_read_b64_tr_b16 a[70:71], v3 offset:46592
    s_add_u32 m0, s27, 110592
    s_add_u32 s29, s25, 12288
    buffer_load_dwordx4 v6, s[8:11], s29 offen nt lds
    v_xor_b32 v6, 32, v6
    v_mfma_f32_32x32x16_bf16 v[64:79], a[76:79], v[220:223], v[64:79]
    ds_read_b64_tr_b16 a[72:73], v3 offset:47104
    ds_read_b64_tr_b16 a[74:75], v3 offset:48128
    v_mul_f32 v108, v108, v14
    v_mul_f32 v109, v109, v14
    v_cvt_pk_bf16_f32 v38, v108, v109
    v_mul_f32 v110, v110, v14
    v_mul_f32 v111, v111, v14
    v_cvt_pk_bf16_f32 v39, v110, v111
    s_waitcnt lgkmcnt(7)
    v_mfma_f32_32x32x16_bf16 v[48:63], v[16:19], v[224:227], v[48:63]
    ds_read_b64_tr_b16 a[76:77], v3 offset:47616
    ds_read_b64_tr_b16 a[78:79], v3 offset:48640
    v_xor_b32 v0, 96, v9
    ds_write_b128 v0, v[36:39]
    v_mfma_f32_32x32x16_bf16 v[64:79], v[20:23], v[224:227], v[64:79]
    v_xor_b32 v3, 0xc000, v3
    ds_read_b64_tr_b16 v[16:17], v3 offset:0
    ds_read_b64_tr_b16 v[18:19], v3 offset:1024
    v_mfma_f32_32x32x16_bf16 v[48:63], v[24:27], v[228:231], v[48:63]
    ds_read_b64_tr_b16 v[20:21], v3 offset:512
    ds_read_b64_tr_b16 v[22:23], v3 offset:1536
    ds_read_b128 v[32:35], v10 offset:0
    ds_read_b128 v[36:39], v10 offset:1024
    v_mfma_f32_32x32x16_bf16 v[64:79], v[28:31], v[228:231], v[64:79]
    ds_read_b64_tr_b16 v[24:25], v3 offset:2048
    ds_read_b64_tr_b16 v[26:27], v3 offset:3072
    s_waitcnt lgkmcnt(3)
    s_add_u32 s30, s24, 32768
    buffer_store_dwordx4 v[32:35], v11, s[20:23], s30 offen sc1
    v_mfma_f32_32x32x16_bf16 v[48:63], a[64:67], v[240:243], v[48:63]
    ds_read_b64_tr_b16 v[28:29], v3 offset:2560
    ds_read_b64_tr_b16 v[30:31], v3 offset:3584
    v_mfma_f32_32x32x16_bf16 v[64:79], a[68:71], v[240:243], v[64:79]
    ds_read_b64_tr_b16 a[64:65], v3 offset:4096
    ds_read_b64_tr_b16 a[66:67], v3 offset:5120
    s_waitcnt lgkmcnt(6)
    s_add_u32 s30, s24, 36864
    buffer_store_dwordx4 v[36:39], v11, s[20:23], s30 offen sc1
    v_mfma_f32_32x32x16_bf16 v[48:63], a[72:75], v[244:247], v[48:63]
    ds_read_b64_tr_b16 a[68:69], v3 offset:4608
    ds_read_b64_tr_b16 a[70:71], v3 offset:5632
    ds_read_b128 v[32:35], v10 offset:2048
    ds_read_b128 v[36:39], v10 offset:3072
    v_mfma_f32_32x32x16_bf16 v[64:79], a[76:79], v[244:247], v[64:79]
    ds_read_b64_tr_b16 a[72:73], v3 offset:6144
    ds_read_b64_tr_b16 a[74:75], v3 offset:7168
    s_waitcnt lgkmcnt(8)
    v_mfma_f32_32x32x16_bf16 v[80:95], v[16:19], a[80:83], 0
    ds_read_b64_tr_b16 a[76:77], v3 offset:6656
    ds_read_b64_tr_b16 a[78:79], v3 offset:7680
    s_waitcnt lgkmcnt(5)
    s_add_u32 s30, s24, 40960
    buffer_store_dwordx4 v[32:35], v11, s[20:23], s30 offen sc1
    v_mfma_f32_32x32x16_bf16 v[96:111], v[20:23], a[80:83], 0
    ds_read_b64_tr_b16 v[16:17], v3 offset:8192
    ds_read_b64_tr_b16 v[18:19], v3 offset:9216
    s_waitcnt lgkmcnt(6)
    s_add_u32 s30, s24, 45056
    buffer_store_dwordx4 v[36:39], v11, s[20:23], s30 offen sc1
    v_mfma_f32_32x32x16_bf16 v[80:95], v[24:27], a[84:87], v[80:95]
    ds_read_b64_tr_b16 v[20:21], v3 offset:8704
    ds_read_b64_tr_b16 v[22:23], v3 offset:9728
    v_mfma_f32_32x32x16_bf16 v[96:111], v[28:31], a[84:87], v[96:111]
    ds_read_b64_tr_b16 v[24:25], v3 offset:10240
    ds_read_b64_tr_b16 v[26:27], v3 offset:11264
    v_mul_f32 v48, v48, v12
    v_mul_f32 v49, v49, v12
    v_cvt_pk_bf16_f32 v32, v48, v49
    v_mul_f32 v50, v50, v12
    v_mul_f32 v51, v51, v12
    s_waitcnt lgkmcnt(6)
    v_mfma_f32_32x32x16_bf16 v[80:95], a[64:67], a[96:99], v[80:95]
    ds_read_b64_tr_b16 v[28:29], v3 offset:10752
    ds_read_b64_tr_b16 v[30:31], v3 offset:11776
    v_cvt_pk_bf16_f32 v33, v50, v51
    v_mul_f32 v52, v52, v12
    v_mul_f32 v53, v53, v12
    v_cvt_pk_bf16_f32 v34, v52, v53
    v_mul_f32 v54, v54, v12
    v_mul_f32 v55, v55, v12
    v_mfma_f32_32x32x16_bf16 v[96:111], a[68:71], a[96:99], v[96:111]
    ds_read_b64_tr_b16 a[64:65], v3 offset:12288
    ds_read_b64_tr_b16 a[66:67], v3 offset:13312
    v_cvt_pk_bf16_f32 v35, v54, v55
    v_mfma_f32_32x32x16_bf16 v[80:95], a[72:75], a[100:103], v[80:95]
    ds_read_b64_tr_b16 a[68:69], v3 offset:12800
    ds_read_b64_tr_b16 a[70:71], v3 offset:13824
    ds_write_b128 v9, v[32:35]
    v_mfma_f32_32x32x16_bf16 v[96:111], a[76:79], a[100:103], v[96:111]
    ds_read_b64_tr_b16 a[72:73], v3 offset:14336
    ds_read_b64_tr_b16 a[74:75], v3 offset:15360
    v_mul_f32 v56, v56, v12
    v_mul_f32 v57, v57, v12
    v_cvt_pk_bf16_f32 v36, v56, v57
    s_waitcnt lgkmcnt(7)
    v_mfma_f32_32x32x16_bf16 v[80:95], v[16:19], a[112:115], v[80:95]
    ds_read_b64_tr_b16 a[76:77], v3 offset:14848
    ds_read_b64_tr_b16 a[78:79], v3 offset:15872
    v_mfma_f32_32x32x16_bf16 v[96:111], v[20:23], a[112:115], v[96:111]
    v_xor_b32 v3, 0xc000, v3
    ds_read_b64_tr_b16 v[16:17], v3 offset:32768
    ds_read_b64_tr_b16 v[18:19], v3 offset:33792
    v_mul_f32 v58, v58, v12
    v_mul_f32 v59, v59, v12
    v_cvt_pk_bf16_f32 v37, v58, v59
    v_mul_f32 v60, v60, v12
    v_mfma_f32_32x32x16_bf16 v[80:95], v[24:27], a[116:119], v[80:95]
    ds_read_b64_tr_b16 v[20:21], v3 offset:33280
    ds_read_b64_tr_b16 v[22:23], v3 offset:34304
    v_mul_f32 v61, v61, v12
    v_cvt_pk_bf16_f32 v38, v60, v61
    v_mul_f32 v62, v62, v12
    v_mul_f32 v63, v63, v12
    v_cvt_pk_bf16_f32 v39, v62, v63
    v_mfma_f32_32x32x16_bf16 v[96:111], v[28:31], a[116:119], v[96:111]
    ds_read_b64_tr_b16 v[24:25], v3 offset:34816
    ds_read_b64_tr_b16 v[26:27], v3 offset:35840
    s_waitcnt lgkmcnt(6)
    v_mfma_f32_32x32x16_bf16 v[80:95], a[64:67], a[128:131], v[80:95]
    ds_read_b64_tr_b16 v[28:29], v3 offset:35328
    ds_read_b64_tr_b16 v[30:31], v3 offset:36352
    v_xor_b32 v0, 32, v9
    ds_write_b128 v0, v[36:39]
    v_mfma_f32_32x32x16_bf16 v[96:111], a[68:71], a[128:131], v[96:111]
    ds_read_b64_tr_b16 a[64:65], v3 offset:36864
    ds_read_b64_tr_b16 a[66:67], v3 offset:37888
    v_mul_f32 v64, v64, v12
    v_mul_f32 v65, v65, v12
    v_cvt_pk_bf16_f32 v32, v64, v65
    v_mul_f32 v66, v66, v12
    v_mfma_f32_32x32x16_bf16 v[80:95], a[72:75], a[132:135], v[80:95]
    ds_read_b64_tr_b16 a[68:69], v3 offset:37376
    ds_read_b64_tr_b16 a[70:71], v3 offset:38400
    v_mfma_f32_32x32x16_bf16 v[96:111], a[76:79], a[132:135], v[96:111]
    ds_read_b64_tr_b16 a[72:73], v3 offset:38912
    ds_read_b64_tr_b16 a[74:75], v3 offset:39936
    v_mul_f32 v67, v67, v12
    v_cvt_pk_bf16_f32 v33, v66, v67
    v_mul_f32 v68, v68, v12
    s_barrier
    s_waitcnt lgkmcnt(7)
    v_mfma_f32_32x32x16_bf16 v[112:127], v[16:19], a[216:219], v[112:127]
    ds_read_b64_tr_b16 a[76:77], v3 offset:39424
    ds_read_b64_tr_b16 a[78:79], v3 offset:40448
    v_mul_f32 v69, v69, v12
    v_cvt_pk_bf16_f32 v34, v68, v69
    v_mul_f32 v70, v70, v12
    v_mul_f32 v71, v71, v12
    v_cvt_pk_bf16_f32 v35, v70, v71
    v_mfma_f32_32x32x16_bf16 v[128:143], v[20:23], a[216:219], v[128:143]
    ds_read_b64_tr_b16 v[16:17], v3 offset:40960
    ds_read_b64_tr_b16 v[18:19], v3 offset:41984
    s_add_u32 m0, s27, 16384
    s_add_u32 s29, s24, 65792
    buffer_load_dwordx4 v5, s[16:19], s29 offen nt lds
    v_mfma_f32_32x32x16_bf16 v[112:127], v[24:27], a[220:223], v[112:127]
    ds_read_b64_tr_b16 v[20:21], v3 offset:41472
    ds_read_b64_tr_b16 v[22:23], v3 offset:42496
    v_xor_b32 v0, 64, v9
    ds_write_b128 v0, v[32:35]
    v_mfma_f32_32x32x16_bf16 v[128:143], v[28:31], a[220:223], v[128:143]
    ds_read_b64_tr_b16 v[24:25], v3 offset:43008
    ds_read_b64_tr_b16 v[26:27], v3 offset:44032
    v_mul_f32 v72, v72, v12
    v_mul_f32 v73, v73, v12
    v_cvt_pk_bf16_f32 v36, v72, v73
    s_waitcnt lgkmcnt(7)
    v_mfma_f32_32x32x16_bf16 v[112:127], a[64:67], a[232:235], v[112:127]
    ds_read_b64_tr_b16 v[28:29], v3 offset:43520
    ds_read_b64_tr_b16 v[30:31], v3 offset:44544
    s_add_u32 m0, s27, 20480
    s_add_u32 s29, s24, 82176
    buffer_load_dwordx4 v5, s[16:19], s29 offen nt lds
    v_mfma_f32_32x32x16_bf16 v[128:143], a[68:71], a[232:235], v[128:143]
    ds_read_b64_tr_b16 a[64:65], v3 offset:45056
    ds_read_b64_tr_b16 a[66:67], v3 offset:46080
    s_waitcnt vmcnt(22)
    ds_read_b128 a[48:51], v7 offset:16384
    v_mul_f32 v74, v74, v12
    v_mul_f32 v75, v75, v12
    v_mfma_f32_32x32x16_bf16 v[112:127], a[72:75], a[236:239], v[112:127]
    ds_read_b64_tr_b16 a[68:69], v3 offset:45568
    ds_read_b64_tr_b16 a[70:71], v3 offset:46592
    ds_read_b128 a[52:55], v8 offset:16384
    ds_read_b128 a[56:59], v7 offset:16896
    ds_read_b128 a[60:63], v8 offset:16896
    v_cvt_pk_bf16_f32 v37, v74, v75
    v_mul_f32 v76, v76, v12
    v_mfma_f32_32x32x16_bf16 v[128:143], a[76:79], a[236:239], v[128:143]
    ds_read_b64_tr_b16 a[72:73], v3 offset:47104
    ds_read_b64_tr_b16 a[74:75], v3 offset:48128
    s_add_u32 m0, s27, 24576
    s_add_u32 s29, s24, 98560
    buffer_load_dwordx4 v5, s[16:19], s29 offen nt lds
    s_waitcnt lgkmcnt(10)
    v_mfma_f32_32x32x16_bf16 v[112:127], v[16:19], v[232:235], v[112:127]
    ds_read_b64_tr_b16 a[76:77], v3 offset:47616
    ds_read_b64_tr_b16 a[78:79], v3 offset:48640
    v_mul_f32 v77, v77, v12
    v_cvt_pk_bf16_f32 v38, v76, v77
    v_mul_f32 v78, v78, v12
    v_mul_f32 v79, v79, v12
    v_cvt_pk_bf16_f32 v39, v78, v79
    v_mfma_f32_32x32x16_bf16 v[128:143], v[20:23], v[232:235], v[128:143]
    v_xor_b32 v3, 0xc000, v3
    ds_read_b64_tr_b16 v[16:17], v3 offset:0
    ds_read_b64_tr_b16 v[18:19], v3 offset:1024
    v_xor_b32 v0, 96, v9
    ds_write_b128 v0, v[36:39]
    v_mfma_f32_32x32x16_bf16 v[112:127], v[24:27], v[236:239], v[112:127]
    ds_read_b64_tr_b16 v[20:21], v3 offset:512
    ds_read_b64_tr_b16 v[22:23], v3 offset:1536
    s_add_u32 m0, s27, 28672
    s_add_u32 s29, s24, 114944
    buffer_load_dwordx4 v5, s[16:19], s29 offen nt lds
    s_waitcnt lgkmcnt(9)
    ds_read_b128 v[32:35], v10 offset:0
    v_mfma_f32_32x32x16_bf16 v[128:143], v[28:31], v[236:239], v[128:143]
    ds_read_b64_tr_b16 v[24:25], v3 offset:2048
    ds_read_b64_tr_b16 v[26:27], v3 offset:3072
    ds_read_b128 v[36:39], v10 offset:1024
    s_waitcnt lgkmcnt(9)
    v_mfma_f32_32x32x16_bf16 v[112:127], a[64:67], v[248:251], v[112:127]
    ds_read_b64_tr_b16 v[28:29], v3 offset:2560
    ds_read_b64_tr_b16 v[30:31], v3 offset:3584
    s_waitcnt lgkmcnt(5)
    s_add_u32 s30, s24, 0
    buffer_store_dwordx4 v[32:35], v11, s[20:23], s30 offen sc1
    v_mfma_f32_32x32x16_bf16 v[128:143], a[68:71], v[248:251], v[128:143]
    ds_read_b64_tr_b16 a[64:65], v3 offset:4096
    ds_read_b64_tr_b16 a[66:67], v3 offset:5120
    s_add_u32 m0, s27, 114688
    s_add_u32 s29, s25, 128
    buffer_load_dwordx4 v6, s[8:11], s29 offen nt lds
    v_xor_b32 v6, 32, v6
    v_mfma_f32_32x32x16_bf16 v[112:127], a[72:75], v[252:255], v[112:127]
    ds_read_b64_tr_b16 a[68:69], v3 offset:4608
    ds_read_b64_tr_b16 a[70:71], v3 offset:5632
    s_waitcnt lgkmcnt(6)
    s_add_u32 s30, s24, 4096
    buffer_store_dwordx4 v[36:39], v11, s[20:23], s30 offen sc1
    v_mfma_f32_32x32x16_bf16 v[128:143], a[76:79], v[252:255], v[128:143]
    ds_read_b64_tr_b16 a[72:73], v3 offset:6144
    ds_read_b64_tr_b16 a[74:75], v3 offset:7168
    ds_read_b128 v[32:35], v10 offset:2048
    ds_read_b128 v[36:39], v10 offset:3072
    s_waitcnt lgkmcnt(8)
    v_mfma_f32_32x32x16_bf16 v[48:63], v[16:19], v[144:147], 0
    ds_read_b64_tr_b16 a[76:77], v3 offset:6656
    ds_read_b64_tr_b16 a[78:79], v3 offset:7680
    s_add_u32 m0, s27, 118784
    s_add_u32 s29, s25, 4224
    buffer_load_dwordx4 v6, s[8:11], s29 offen nt lds
    v_xor_b32 v6, 32, v6
    s_waitcnt lgkmcnt(3)
    s_add_u32 s30, s24, 8192
    buffer_store_dwordx4 v[32:35], v11, s[20:23], s30 offen sc1
    v_mfma_f32_32x32x16_bf16 v[64:79], v[20:23], v[144:147], 0
    ds_read_b64_tr_b16 v[16:17], v3 offset:8192
    ds_read_b64_tr_b16 v[18:19], v3 offset:9216
    s_waitcnt lgkmcnt(4)
    s_add_u32 s30, s24, 12288
    buffer_store_dwordx4 v[36:39], v11, s[20:23], s30 offen sc1
    v_mfma_f32_32x32x16_bf16 v[48:63], v[24:27], v[148:151], v[48:63]
    ds_read_b64_tr_b16 v[20:21], v3 offset:8704
    ds_read_b64_tr_b16 v[22:23], v3 offset:9728
    v_mul_f32 v112, v112, v13
    v_mul_f32 v113, v113, v13
    v_cvt_pk_bf16_f32 v32, v112, v113
    v_mfma_f32_32x32x16_bf16 v[64:79], v[28:31], v[148:151], v[64:79]
    ds_read_b64_tr_b16 v[24:25], v3 offset:10240
    ds_read_b64_tr_b16 v[26:27], v3 offset:11264
    s_add_u32 m0, s27, 122880
    s_add_u32 s29, s25, 8320
    buffer_load_dwordx4 v6, s[8:11], s29 offen nt lds
    v_xor_b32 v6, 32, v6
    s_waitcnt lgkmcnt(6)
    v_mfma_f32_32x32x16_bf16 v[48:63], a[64:67], v[152:155], v[48:63]
    ds_read_b64_tr_b16 v[28:29], v3 offset:10752
    ds_read_b64_tr_b16 v[30:31], v3 offset:11776
    v_mul_f32 v114, v114, v13
    v_mul_f32 v115, v115, v13
    v_cvt_pk_bf16_f32 v33, v114, v115
    v_mfma_f32_32x32x16_bf16 v[64:79], a[68:71], v[152:155], v[64:79]
    ds_read_b64_tr_b16 a[64:65], v3 offset:12288
    ds_read_b64_tr_b16 a[66:67], v3 offset:13312
    v_mul_f32 v116, v116, v13
    v_mul_f32 v117, v117, v13
    v_cvt_pk_bf16_f32 v34, v116, v117
    v_mfma_f32_32x32x16_bf16 v[48:63], a[72:75], v[156:159], v[48:63]
    ds_read_b64_tr_b16 a[68:69], v3 offset:12800
    ds_read_b64_tr_b16 a[70:71], v3 offset:13824
    s_add_u32 m0, s27, 126976
    s_add_u32 s29, s25, 12416
    buffer_load_dwordx4 v6, s[8:11], s29 offen nt lds
    v_xor_b32 v6, 32, v6
    v_mfma_f32_32x32x16_bf16 v[64:79], a[76:79], v[156:159], v[64:79]
    ds_read_b64_tr_b16 a[72:73], v3 offset:14336
    ds_read_b64_tr_b16 a[74:75], v3 offset:15360
    v_mul_f32 v118, v118, v13
    v_mul_f32 v119, v119, v13
    v_cvt_pk_bf16_f32 v35, v118, v119
    s_waitcnt lgkmcnt(6)
    v_mfma_f32_32x32x16_bf16 v[48:63], v[16:19], v[160:163], v[48:63]
    ds_read_b64_tr_b16 a[76:77], v3 offset:14848
    ds_read_b64_tr_b16 a[78:79], v3 offset:15872
    ds_write_b128 v9, v[32:35]
    v_mfma_f32_32x32x16_bf16 v[64:79], v[20:23], v[160:163], v[64:79]
    ds_read_b64_tr_b16 v[16:17], v3 offset:16384
    ds_read_b64_tr_b16 v[18:19], v3 offset:17408
    v_mfma_f32_32x32x16_bf16 v[48:63], v[24:27], v[164:167], v[48:63]
    ds_read_b64_tr_b16 v[20:21], v3 offset:16896
    ds_read_b64_tr_b16 v[22:23], v3 offset:17920
    v_mul_f32 v120, v120, v13
    v_mul_f32 v121, v121, v13
    v_cvt_pk_bf16_f32 v36, v120, v121
    v_mfma_f32_32x32x16_bf16 v[64:79], v[28:31], v[164:167], v[64:79]
    ds_read_b64_tr_b16 v[24:25], v3 offset:18432
    ds_read_b64_tr_b16 v[26:27], v3 offset:19456
    v_mul_f32 v122, v122, v13
    v_mul_f32 v123, v123, v13
    s_waitcnt lgkmcnt(7)
    v_mfma_f32_32x32x16_bf16 v[48:63], a[64:67], v[168:171], v[48:63]
    ds_read_b64_tr_b16 v[28:29], v3 offset:18944
    ds_read_b64_tr_b16 v[30:31], v3 offset:19968
    v_mfma_f32_32x32x16_bf16 v[64:79], a[68:71], v[168:171], v[64:79]
    ds_read_b64_tr_b16 a[64:65], v3 offset:20480
    ds_read_b64_tr_b16 a[66:67], v3 offset:21504
    v_cvt_pk_bf16_f32 v37, v122, v123
    v_mul_f32 v124, v124, v13
    v_mul_f32 v125, v125, v13
    v_mfma_f32_32x32x16_bf16 v[48:63], a[72:75], v[172:175], v[48:63]
    ds_read_b64_tr_b16 a[68:69], v3 offset:20992
    ds_read_b64_tr_b16 a[70:71], v3 offset:22016
    v_cvt_pk_bf16_f32 v38, v124, v125
    v_mul_f32 v126, v126, v13
    v_mul_f32 v127, v127, v13
    v_cvt_pk_bf16_f32 v39, v126, v127
    v_mfma_f32_32x32x16_bf16 v[64:79], a[76:79], v[172:175], v[64:79]
    ds_read_b64_tr_b16 a[72:73], v3 offset:22528
    ds_read_b64_tr_b16 a[74:75], v3 offset:23552
    s_waitcnt lgkmcnt(6)
    v_mfma_f32_32x32x16_bf16 v[80:95], v[16:19], a[144:147], v[80:95]
    ds_read_b64_tr_b16 a[76:77], v3 offset:23040
    ds_read_b64_tr_b16 a[78:79], v3 offset:24064
    v_xor_b32 v0, 32, v9
    ds_write_b128 v0, v[36:39]
    v_mfma_f32_32x32x16_bf16 v[96:111], v[20:23], a[144:147], v[96:111]
    ds_read_b64_tr_b16 v[16:17], v3 offset:24576
    ds_read_b64_tr_b16 v[18:19], v3 offset:25600
    v_mul_f32 v128, v128, v13
    v_mul_f32 v129, v129, v13
    v_cvt_pk_bf16_f32 v32, v128, v129
    v_mul_f32 v130, v130, v13
    v_mfma_f32_32x32x16_bf16 v[80:95], v[24:27], a[148:151], v[80:95]
    ds_read_b64_tr_b16 v[20:21], v3 offset:25088
    ds_read_b64_tr_b16 v[22:23], v3 offset:26112
    v_mfma_f32_32x32x16_bf16 v[96:111], v[28:31], a[148:151], v[96:111]
    ds_read_b64_tr_b16 v[24:25], v3 offset:26624
    ds_read_b64_tr_b16 v[26:27], v3 offset:27648
    v_mul_f32 v131, v131, v13
    v_cvt_pk_bf16_f32 v33, v130, v131
    v_mul_f32 v132, v132, v13
    s_waitcnt lgkmcnt(7)
    v_mfma_f32_32x32x16_bf16 v[80:95], a[64:67], a[160:163], v[80:95]
    ds_read_b64_tr_b16 v[28:29], v3 offset:27136
    ds_read_b64_tr_b16 v[30:31], v3 offset:28160
    v_mul_f32 v133, v133, v13
    v_cvt_pk_bf16_f32 v34, v132, v133
    v_mul_f32 v134, v134, v13
    v_mul_f32 v135, v135, v13
    v_cvt_pk_bf16_f32 v35, v134, v135
    v_mfma_f32_32x32x16_bf16 v[96:111], a[68:71], a[160:163], v[96:111]
    ds_read_b64_tr_b16 a[64:65], v3 offset:28672
    ds_read_b64_tr_b16 a[66:67], v3 offset:29696
    v_mfma_f32_32x32x16_bf16 v[80:95], a[72:75], a[164:167], v[80:95]
    ds_read_b64_tr_b16 a[68:69], v3 offset:29184
    ds_read_b64_tr_b16 a[70:71], v3 offset:30208
    v_xor_b32 v0, 64, v9
    ds_write_b128 v0, v[32:35]
    v_mfma_f32_32x32x16_bf16 v[96:111], a[76:79], a[164:167], v[96:111]
    ds_read_b64_tr_b16 a[72:73], v3 offset:30720
    ds_read_b64_tr_b16 a[74:75], v3 offset:31744
    v_mul_f32 v136, v136, v13
    v_mul_f32 v137, v137, v13
    s_waitcnt lgkmcnt(7)
    v_mfma_f32_32x32x16_bf16 v[80:95], v[16:19], a[176:179], v[80:95]
    ds_read_b64_tr_b16 a[76:77], v3 offset:31232
    ds_read_b64_tr_b16 a[78:79], v3 offset:32256
    v_mfma_f32_32x32x16_bf16 v[96:111], v[20:23], a[176:179], v[96:111]
    ds_read_b64_tr_b16 v[16:17], v3 offset:0
    ds_read_b64_tr_b16 v[18:19], v3 offset:1024
    v_cvt_pk_bf16_f32 v36, v136, v137
    v_mul_f32 v138, v138, v13
    v_mul_f32 v139, v139, v13
    v_mfma_f32_32x32x16_bf16 v[80:95], v[24:27], a[180:183], v[80:95]
    ds_read_b64_tr_b16 v[20:21], v3 offset:512
    ds_read_b64_tr_b16 v[22:23], v3 offset:1536
    v_cvt_pk_bf16_f32 v37, v138, v139
    v_mul_f32 v140, v140, v13
    v_mul_f32 v141, v141, v13
    v_mfma_f32_32x32x16_bf16 v[96:111], v[28:31], a[180:183], v[96:111]
    ds_read_b64_tr_b16 v[24:25], v3 offset:2048
    ds_read_b64_tr_b16 v[26:27], v3 offset:3072
    s_waitcnt lgkmcnt(6)
    v_mfma_f32_32x32x16_bf16 v[80:95], a[64:67], a[192:195], v[80:95]
    ds_read_b64_tr_b16 v[28:29], v3 offset:2560
    ds_read_b64_tr_b16 v[30:31], v3 offset:3584
    v_cvt_pk_bf16_f32 v38, v140, v141
    v_mul_f32 v142, v142, v13
    v_mul_f32 v143, v143, v13
    v_cvt_pk_bf16_f32 v39, v142, v143
    v_mfma_f32_32x32x16_bf16 v[96:111], a[68:71], a[192:195], v[96:111]
    ds_read_b64_tr_b16 a[64:65], v3 offset:4096
    ds_read_b64_tr_b16 a[66:67], v3 offset:5120
    v_xor_b32 v0, 96, v9
    ds_write_b128 v0, v[36:39]
    v_mfma_f32_32x32x16_bf16 v[80:95], a[72:75], a[196:199], v[80:95]
    ds_read_b64_tr_b16 a[68:69], v3 offset:4608
    ds_read_b64_tr_b16 a[70:71], v3 offset:5632
    v_mfma_f32_32x32x16_bf16 v[96:111], a[76:79], a[196:199], v[96:111]
    ds_read_b64_tr_b16 a[72:73], v3 offset:6144
    ds_read_b64_tr_b16 a[74:75], v3 offset:7168
    s_waitcnt vmcnt(28)
    s_barrier
    s_waitcnt lgkmcnt(7)
    v_mfma_f32_32x32x16_bf16 v[112:127], v[16:19], a[88:91], 0
    ds_read_b64_tr_b16 a[76:77], v3 offset:6656
    ds_read_b64_tr_b16 a[78:79], v3 offset:7680
    v_mfma_f32_32x32x16_bf16 v[128:143], v[20:23], a[88:91], 0
    ds_read_b64_tr_b16 v[16:17], v3 offset:8192
    ds_read_b64_tr_b16 v[18:19], v3 offset:9216
    s_add_u32 m0, s27, 32768
    s_add_u32 s29, s24, 131328
    buffer_load_dwordx4 v5, s[16:19], s29 offen nt lds
    v_mfma_f32_32x32x16_bf16 v[112:127], v[24:27], a[92:95], v[112:127]
    ds_read_b64_tr_b16 v[20:21], v3 offset:8704
    ds_read_b64_tr_b16 v[22:23], v3 offset:9728
    v_mfma_f32_32x32x16_bf16 v[128:143], v[28:31], a[92:95], v[128:143]
    ds_read_b64_tr_b16 v[24:25], v3 offset:10240
    ds_read_b64_tr_b16 v[26:27], v3 offset:11264
    s_waitcnt lgkmcnt(6)
    v_mfma_f32_32x32x16_bf16 v[112:127], a[64:67], a[104:107], v[112:127]
    ds_read_b64_tr_b16 v[28:29], v3 offset:10752
    ds_read_b64_tr_b16 v[30:31], v3 offset:11776
    s_add_u32 m0, s27, 36864
    s_add_u32 s29, s24, 147712
    buffer_load_dwordx4 v5, s[16:19], s29 offen nt lds
    v_mfma_f32_32x32x16_bf16 v[128:143], a[68:71], a[104:107], v[128:143]
    ds_read_b64_tr_b16 a[64:65], v3 offset:12288
    ds_read_b64_tr_b16 a[66:67], v3 offset:13312
    ds_read_b128 v[32:35], v10 offset:0
    v_mfma_f32_32x32x16_bf16 v[112:127], a[72:75], a[108:111], v[112:127]
    ds_read_b64_tr_b16 a[68:69], v3 offset:12800
    ds_read_b64_tr_b16 a[70:71], v3 offset:13824
    ds_read_b128 v[36:39], v10 offset:1024
    v_mfma_f32_32x32x16_bf16 v[128:143], a[76:79], a[108:111], v[128:143]
    ds_read_b64_tr_b16 a[72:73], v3 offset:14336
    ds_read_b64_tr_b16 a[74:75], v3 offset:15360
    s_add_u32 m0, s27, 40960
    s_add_u32 s29, s24, 164096
    buffer_load_dwordx4 v5, s[16:19], s29 offen nt lds
    s_waitcnt lgkmcnt(8)
    v_mfma_f32_32x32x16_bf16 v[112:127], v[16:19], a[120:123], v[112:127]
    ds_read_b64_tr_b16 a[76:77], v3 offset:14848
    ds_read_b64_tr_b16 a[78:79], v3 offset:15872
    v_mfma_f32_32x32x16_bf16 v[128:143], v[20:23], a[120:123], v[128:143]
    ds_read_b64_tr_b16 v[16:17], v3 offset:16384
    ds_read_b64_tr_b16 v[18:19], v3 offset:17408
    s_waitcnt lgkmcnt(9)
    s_add_u32 s30, s24, 16384
    buffer_store_dwordx4 v[32:35], v11, s[20:23], s30 offen sc1
    v_mfma_f32_32x32x16_bf16 v[112:127], v[24:27], a[124:127], v[112:127]
    ds_read_b64_tr_b16 v[20:21], v3 offset:16896
    ds_read_b64_tr_b16 v[22:23], v3 offset:17920
    s_add_u32 m0, s27, 45056
    s_add_u32 s29, s24, 180480
    buffer_load_dwordx4 v5, s[16:19], s29 offen nt lds
    v_mfma_f32_32x32x16_bf16 v[128:143], v[28:31], a[124:127], v[128:143]
    ds_read_b64_tr_b16 v[24:25], v3 offset:18432
    ds_read_b64_tr_b16 v[26:27], v3 offset:19456
    s_waitcnt lgkmcnt(6)
    v_mfma_f32_32x32x16_bf16 v[112:127], a[64:67], a[136:139], v[112:127]
    ds_read_b64_tr_b16 v[28:29], v3 offset:18944
    ds_read_b64_tr_b16 v[30:31], v3 offset:19968
    s_add_u32 s30, s24, 20480
    buffer_store_dwordx4 v[36:39], v11, s[20:23], s30 offen sc1
    v_mfma_f32_32x32x16_bf16 v[128:143], a[68:71], a[136:139], v[128:143]
    ds_read_b64_tr_b16 a[64:65], v3 offset:20480
    ds_read_b64_tr_b16 a[66:67], v3 offset:21504
    v_mfma_f32_32x32x16_bf16 v[112:127], a[72:75], a[140:143], v[112:127]
    ds_read_b64_tr_b16 a[68:69], v3 offset:20992
    ds_read_b64_tr_b16 a[70:71], v3 offset:22016
    ds_read_b128 v[32:35], v10 offset:2048
    v_mfma_f32_32x32x16_bf16 v[128:143], a[76:79], a[140:143], v[128:143]
    ds_read_b64_tr_b16 a[72:73], v3 offset:22528
    ds_read_b64_tr_b16 a[74:75], v3 offset:23552
    s_waitcnt lgkmcnt(7)
    v_mfma_f32_32x32x16_bf16 v[48:63], v[16:19], v[176:179], v[48:63]
    ds_read_b64_tr_b16 a[76:77], v3 offset:23040
    ds_read_b64_tr_b16 a[78:79], v3 offset:24064
    v_mfma_f32_32x32x16_bf16 v[64:79], v[20:23], v[176:179], v[64:79]
    ds_read_b64_tr_b16 v[16:17], v3 offset:24576
    ds_read_b64_tr_b16 v[18:19], v3 offset:25600
    ds_read_b128 v[36:39], v10 offset:3072
    v_mfma_f32_32x32x16_bf16 v[48:63], v[24:27], v[180:183], v[48:63]
    ds_read_b64_tr_b16 v[20:21], v3 offset:25088
    ds_read_b64_tr_b16 v[22:23], v3 offset:26112
    v_mfma_f32_32x32x16_bf16 v[64:79], v[28:31], v[180:183], v[64:79]
    ds_read_b64_tr_b16 v[24:25], v3 offset:26624
    ds_read_b64_tr_b16 v[26:27], v3 offset:27648
    s_waitcnt lgkmcnt(7)
    v_mfma_f32_32x32x16_bf16 v[48:63], a[64:67], v[184:187], v[48:63]
    ds_read_b64_tr_b16 v[28:29], v3 offset:27136
    ds_read_b64_tr_b16 v[30:31], v3 offset:28160
    s_add_u32 s30, s24, 24576
    buffer_store_dwordx4 v[32:35], v11, s[20:23], s30 offen sc1
    v_mfma_f32_32x32x16_bf16 v[64:79], a[68:71], v[184:187], v[64:79]
    ds_read_b64_tr_b16 a[64:65], v3 offset:28672
    ds_read_b64_tr_b16 a[66:67], v3 offset:29696
    s_waitcnt lgkmcnt(8)
    s_add_u32 s30, s24, 28672
    buffer_store_dwordx4 v[36:39], v11, s[20:23], s30 offen sc1
    v_mfma_f32_32x32x16_bf16 v[48:63], a[72:75], v[188:191], v[48:63]
    ds_read_b64_tr_b16 a[68:69], v3 offset:29184
    ds_read_b64_tr_b16 a[70:71], v3 offset:30208
    v_mfma_f32_32x32x16_bf16 v[64:79], a[76:79], v[188:191], v[64:79]
    ds_read_b64_tr_b16 a[72:73], v3 offset:30720
    ds_read_b64_tr_b16 a[74:75], v3 offset:31744
    s_waitcnt lgkmcnt(6)
    v_mfma_f32_32x32x16_bf16 v[48:63], v[16:19], v[192:195], v[48:63]
    ds_read_b64_tr_b16 a[76:77], v3 offset:31232
    ds_read_b64_tr_b16 a[78:79], v3 offset:32256
    v_mfma_f32_32x32x16_bf16 v[64:79], v[20:23], v[192:195], v[64:79]
    ds_read_b64_tr_b16 v[16:17], v3 offset:32768
    ds_read_b64_tr_b16 v[18:19], v3 offset:33792
    v_mfma_f32_32x32x16_bf16 v[48:63], v[24:27], v[196:199], v[48:63]
    ds_read_b64_tr_b16 v[20:21], v3 offset:33280
    ds_read_b64_tr_b16 v[22:23], v3 offset:34304
    v_mfma_f32_32x32x16_bf16 v[64:79], v[28:31], v[196:199], v[64:79]
    ds_read_b64_tr_b16 v[24:25], v3 offset:34816
    ds_read_b64_tr_b16 v[26:27], v3 offset:35840
    s_waitcnt lgkmcnt(6)
    v_mfma_f32_32x32x16_bf16 v[48:63], a[64:67], v[200:203], v[48:63]
    ds_read_b64_tr_b16 v[28:29], v3 offset:35328
    ds_read_b64_tr_b16 v[30:31], v3 offset:36352
    v_mfma_f32_32x32x16_bf16 v[64:79], a[68:71], v[200:203], v[64:79]
    ds_read_b64_tr_b16 a[64:65], v3 offset:36864
    ds_read_b64_tr_b16 a[66:67], v3 offset:37888
    v_mfma_f32_32x32x16_bf16 v[48:63], a[72:75], v[204:207], v[48:63]
    ds_read_b64_tr_b16 a[68:69], v3 offset:37376
    ds_read_b64_tr_b16 a[70:71], v3 offset:38400
    v_mfma_f32_32x32x16_bf16 v[64:79], a[76:79], v[204:207], v[64:79]
    ds_read_b64_tr_b16 a[72:73], v3 offset:38912
    ds_read_b64_tr_b16 a[74:75], v3 offset:39936
    s_waitcnt lgkmcnt(6)
    v_mfma_f32_32x32x16_bf16 v[80:95], v[16:19], a[208:211], v[80:95]
    ds_read_b64_tr_b16 a[76:77], v3 offset:39424
    ds_read_b64_tr_b16 a[78:79], v3 offset:40448
    v_mfma_f32_32x32x16_bf16 v[96:111], v[20:23], a[208:211], v[96:111]
    ds_read_b64_tr_b16 v[16:17], v3 offset:40960
    ds_read_b64_tr_b16 v[18:19], v3 offset:41984
    v_mfma_f32_32x32x16_bf16 v[80:95], v[24:27], a[212:215], v[80:95]
    ds_read_b64_tr_b16 v[20:21], v3 offset:41472
    ds_read_b64_tr_b16 v[22:23], v3 offset:42496
    v_mfma_f32_32x32x16_bf16 v[96:111], v[28:31], a[212:215], v[96:111]
    ds_read_b64_tr_b16 v[24:25], v3 offset:43008
    ds_read_b64_tr_b16 v[26:27], v3 offset:44032
    s_waitcnt lgkmcnt(6)
    v_mfma_f32_32x32x16_bf16 v[80:95], a[64:67], a[224:227], v[80:95]
    ds_read_b64_tr_b16 v[28:29], v3 offset:43520
    ds_read_b64_tr_b16 v[30:31], v3 offset:44544
    v_mfma_f32_32x32x16_bf16 v[96:111], a[68:71], a[224:227], v[96:111]
    ds_read_b64_tr_b16 a[64:65], v3 offset:45056
    ds_read_b64_tr_b16 a[66:67], v3 offset:46080
    v_mfma_f32_32x32x16_bf16 v[80:95], a[72:75], a[228:231], v[80:95]
    ds_read_b64_tr_b16 a[68:69], v3 offset:45568
    ds_read_b64_tr_b16 a[70:71], v3 offset:46592
    v_mfma_f32_32x32x16_bf16 v[96:111], a[76:79], a[228:231], v[96:111]
    ds_read_b64_tr_b16 a[72:73], v3 offset:47104
    ds_read_b64_tr_b16 a[74:75], v3 offset:48128
    s_waitcnt lgkmcnt(6)
    v_mfma_f32_32x32x16_bf16 v[80:95], v[16:19], a[240:243], v[80:95]
    ds_read_b64_tr_b16 a[76:77], v3 offset:47616
    ds_read_b64_tr_b16 a[78:79], v3 offset:48640
    v_mfma_f32_32x32x16_bf16 v[96:111], v[20:23], a[240:243], v[96:111]
    ds_read_b64_tr_b16 v[16:17], v3 offset:16384
    ds_read_b64_tr_b16 v[18:19], v3 offset:17408
    v_mfma_f32_32x32x16_bf16 v[80:95], v[24:27], a[244:247], v[80:95]
    ds_read_b64_tr_b16 v[20:21], v3 offset:16896
    ds_read_b64_tr_b16 v[22:23], v3 offset:17920
    v_mfma_f32_32x32x16_bf16 v[96:111], v[28:31], a[244:247], v[96:111]
    ds_read_b64_tr_b16 v[24:25], v3 offset:18432
    ds_read_b64_tr_b16 v[26:27], v3 offset:19456
    s_waitcnt lgkmcnt(6)
    v_mfma_f32_32x32x16_bf16 v[80:95], a[64:67], a[248:251], v[80:95]
    ds_read_b64_tr_b16 v[28:29], v3 offset:18944
    ds_read_b64_tr_b16 v[30:31], v3 offset:19968
    v_mfma_f32_32x32x16_bf16 v[96:111], a[68:71], a[248:251], v[96:111]
    ds_read_b64_tr_b16 a[64:65], v3 offset:20480
    ds_read_b64_tr_b16 a[66:67], v3 offset:21504
    v_mfma_f32_32x32x16_bf16 v[80:95], a[72:75], a[252:255], v[80:95]
    ds_read_b64_tr_b16 a[68:69], v3 offset:20992
    ds_read_b64_tr_b16 a[70:71], v3 offset:22016
    v_mfma_f32_32x32x16_bf16 v[96:111], a[76:79], a[252:255], v[96:111]
    ds_read_b64_tr_b16 a[72:73], v3 offset:22528
    ds_read_b64_tr_b16 a[74:75], v3 offset:23552
    s_waitcnt vmcnt(28)
    s_barrier
    s_waitcnt lgkmcnt(6)
    v_mfma_f32_32x32x16_bf16 v[112:127], v[16:19], a[152:155], v[112:127]
    ds_read_b64_tr_b16 a[76:77], v3 offset:23040
    ds_read_b64_tr_b16 a[78:79], v3 offset:24064
    v_mfma_f32_32x32x16_bf16 v[128:143], v[20:23], a[152:155], v[128:143]
    ds_read_b64_tr_b16 v[16:17], v3 offset:24576
    ds_read_b64_tr_b16 v[18:19], v3 offset:25600
    s_add_u32 m0, s27, 49152
    s_add_u32 s29, s24, 384
    buffer_load_dwordx4 v5, s[16:19], s29 offen nt lds
    v_mfma_f32_32x32x16_bf16 v[112:127], v[24:27], a[156:159], v[112:127]
    ds_read_b64_tr_b16 v[20:21], v3 offset:25088
    ds_read_b64_tr_b16 v[22:23], v3 offset:26112
    v_mul_f32 v80, v80, v14
    v_mul_f32 v81, v81, v14
    v_cvt_pk_bf16_f32 v32, v80, v81
    v_mul_f32 v82, v82, v14
    v_mfma_f32_32x32x16_bf16 v[128:143], v[28:31], a[156:159], v[128:143]
    ds_read_b64_tr_b16 v[24:25], v3 offset:26624
    ds_read_b64_tr_b16 v[26:27], v3 offset:27648
    v_mul_f32 v83, v83, v14
    v_cvt_pk_bf16_f32 v33, v82, v83
    v_mul_f32 v84, v84, v14
    s_waitcnt lgkmcnt(6)
    v_mfma_f32_32x32x16_bf16 v[112:127], a[64:67], a[168:171], v[112:127]
    ds_read_b64_tr_b16 v[28:29], v3 offset:27136
    ds_read_b64_tr_b16 v[30:31], v3 offset:28160
    s_add_u32 m0, s27, 53248
    s_add_u32 s29, s24, 16768
    buffer_load_dwordx4 v5, s[16:19], s29 offen nt lds
    v_mfma_f32_32x32x16_bf16 v[128:143], a[68:71], a[168:171], v[128:143]
    ds_read_b64_tr_b16 a[64:65], v3 offset:28672
    ds_read_b64_tr_b16 a[66:67], v3 offset:29696
    s_waitcnt vmcnt(26)
    ds_read_b128 a[0:3], v7 offset:0
    v_mul_f32 v85, v85, v14
    v_cvt_pk_bf16_f32 v34, v84, v85
    v_mul_f32 v86, v86, v14
    v_mfma_f32_32x32x16_bf16 v[112:127], a[72:75], a[172:175], v[112:127]
    ds_read_b64_tr_b16 a[68:69], v3 offset:29184
    ds_read_b64_tr_b16 a[70:71], v3 offset:30208
    ds_read_b128 a[4:7], v8 offset:0
    ds_read_b128 a[8:11], v7 offset:512
    ds_read_b128 a[12:15], v8 offset:512
    v_mul_f32 v87, v87, v14
    v_cvt_pk_bf16_f32 v35, v86, v87
    v_mfma_f32_32x32x16_bf16 v[128:143], a[76:79], a[172:175], v[128:143]
    ds_read_b64_tr_b16 a[72:73], v3 offset:30720
    ds_read_b64_tr_b16 a[74:75], v3 offset:31744
    s_add_u32 m0, s27, 57344
    s_add_u32 s29, s24, 33152
    buffer_load_dwordx4 v5, s[16:19], s29 offen nt lds
    s_waitcnt lgkmcnt(10)
    v_mfma_f32_32x32x16_bf16 v[112:127], v[16:19], a[184:187], v[112:127]
    ds_read_b64_tr_b16 a[76:77], v3 offset:31232
    ds_read_b64_tr_b16 a[78:79], v3 offset:32256
    ds_write_b128 v9, v[32:35]
    v_mfma_f32_32x32x16_bf16 v[128:143], v[20:23], a[184:187], v[128:143]
    ds_read_b64_tr_b16 v[16:17], v3 offset:32768
    ds_read_b64_tr_b16 v[18:19], v3 offset:33792
    v_mul_f32 v88, v88, v14
    v_mul_f32 v89, v89, v14
    v_cvt_pk_bf16_f32 v36, v88, v89
    v_mul_f32 v90, v90, v14
    v_mfma_f32_32x32x16_bf16 v[112:127], v[24:27], a[188:191], v[112:127]
    ds_read_b64_tr_b16 v[20:21], v3 offset:33280
    ds_read_b64_tr_b16 v[22:23], v3 offset:34304
    s_add_u32 m0, s27, 61440
    s_add_u32 s29, s24, 49536
    buffer_load_dwordx4 v5, s[16:19], s29 offen nt lds
    s_waitcnt lgkmcnt(9)
    v_mfma_f32_32x32x16_bf16 v[128:143], v[28:31], a[188:191], v[128:143]
    ds_read_b64_tr_b16 v[24:25], v3 offset:34816
    ds_read_b64_tr_b16 v[26:27], v3 offset:35840
    v_mul_f32 v91, v91, v14
    v_cvt_pk_bf16_f32 v37, v90, v91
    v_mul_f32 v92, v92, v14
    s_waitcnt lgkmcnt(7)
    v_mfma_f32_32x32x16_bf16 v[112:127], a[64:67], a[200:203], v[112:127]
    ds_read_b64_tr_b16 v[28:29], v3 offset:35328
    ds_read_b64_tr_b16 v[30:31], v3 offset:36352
    v_mul_f32 v93, v93, v14
    v_cvt_pk_bf16_f32 v38, v92, v93
    v_mul_f32 v94, v94, v14
    v_mul_f32 v95, v95, v14
    v_cvt_pk_bf16_f32 v39, v94, v95
    v_mfma_f32_32x32x16_bf16 v[128:143], a[68:71], a[200:203], v[128:143]
    ds_read_b64_tr_b16 a[64:65], v3 offset:36864
    ds_read_b64_tr_b16 a[66:67], v3 offset:37888
    s_add_u32 m0, s27, 98304
    s_add_u32 s29, s25, 32896
    buffer_load_dwordx4 v6, s[8:11], s29 offen nt lds
    v_xor_b32 v6, 32, v6
    v_mfma_f32_32x32x16_bf16 v[112:127], a[72:75], a[204:207], v[112:127]
    ds_read_b64_tr_b16 a[68:69], v3 offset:37376
    ds_read_b64_tr_b16 a[70:71], v3 offset:38400
    v_xor_b32 v0, 32, v9
    ds_write_b128 v0, v[36:39]
    v_mfma_f32_32x32x16_bf16 v[128:143], a[76:79], a[204:207], v[128:143]
    ds_read_b64_tr_b16 a[72:73], v3 offset:38912
    ds_read_b64_tr_b16 a[74:75], v3 offset:39936
    v_mul_f32 v96, v96, v14
    v_mul_f32 v97, v97, v14
    v_cvt_pk_bf16_f32 v32, v96, v97
    s_waitcnt lgkmcnt(7)
    v_mfma_f32_32x32x16_bf16 v[48:63], v[16:19], v[208:211], v[48:63]
    ds_read_b64_tr_b16 a[76:77], v3 offset:39424
    ds_read_b64_tr_b16 a[78:79], v3 offset:40448
    s_add_u32 m0, s27, 102400
    s_add_u32 s29, s25, 36992
    buffer_load_dwordx4 v6, s[8:11], s29 offen nt lds
    v_xor_b32 v6, 32, v6
    v_mfma_f32_32x32x16_bf16 v[64:79], v[20:23], v[208:211], v[64:79]
    ds_read_b64_tr_b16 v[16:17], v3 offset:40960
    ds_read_b64_tr_b16 v[18:19], v3 offset:41984
    v_mul_f32 v98, v98, v14
    v_mul_f32 v99, v99, v14
    v_cvt_pk_bf16_f32 v33, v98, v99
    v_mul_f32 v100, v100, v14
    v_mfma_f32_32x32x16_bf16 v[48:63], v[24:27], v[212:215], v[48:63]
    ds_read_b64_tr_b16 v[20:21], v3 offset:41472
    ds_read_b64_tr_b16 v[22:23], v3 offset:42496
    v_mul_f32 v101, v101, v14
    v_cvt_pk_bf16_f32 v34, v100, v101
    v_mul_f32 v102, v102, v14
    v_mul_f32 v103, v103, v14
    v_cvt_pk_bf16_f32 v35, v102, v103
    v_mfma_f32_32x32x16_bf16 v[64:79], v[28:31], v[212:215], v[64:79]
    ds_read_b64_tr_b16 v[24:25], v3 offset:43008
    ds_read_b64_tr_b16 v[26:27], v3 offset:44032
    s_add_u32 m0, s27, 106496
    s_add_u32 s29, s25, 41088
    buffer_load_dwordx4 v6, s[8:11], s29 offen nt lds
    v_xor_b32 v6, 32, v6
    s_waitcnt lgkmcnt(6)
    v_mfma_f32_32x32x16_bf16 v[48:63], a[64:67], v[216:219], v[48:63]
    ds_read_b64_tr_b16 v[28:29], v3 offset:43520
    ds_read_b64_tr_b16 v[30:31], v3 offset:44544
    v_xor_b32 v0, 64, v9
    ds_write_b128 v0, v[32:35]
    v_mfma_f32_32x32x16_bf16 v[64:79], a[68:71], v[216:219], v[64:79]
    ds_read_b64_tr_b16 a[64:65], v3 offset:45056
    ds_read_b64_tr_b16 a[66:67], v3 offset:46080
    v_mul_f32 v104, v104, v14
    v_mul_f32 v105, v105, v14
    v_cvt_pk_bf16_f32 v36, v104, v105
    v_mul_f32 v106, v106, v14
    v_mul_f32 v107, v107, v14
    v_cvt_pk_bf16_f32 v37, v106, v107
    v_mfma_f32_32x32x16_bf16 v[48:63], a[72:75], v[220:223], v[48:63]
    ds_read_b64_tr_b16 a[68:69], v3 offset:45568
    ds_read_b64_tr_b16 a[70:71], v3 offset:46592
    s_add_u32 m0, s27, 110592
    s_add_u32 s29, s25, 45184
    buffer_load_dwordx4 v6, s[8:11], s29 offen nt lds
    v_xor_b32 v6, 32, v6
    v_mfma_f32_32x32x16_bf16 v[64:79], a[76:79], v[220:223], v[64:79]
    ds_read_b64_tr_b16 a[72:73], v3 offset:47104
    ds_read_b64_tr_b16 a[74:75], v3 offset:48128
    v_mul_f32 v108, v108, v14
    v_mul_f32 v109, v109, v14
    v_cvt_pk_bf16_f32 v38, v108, v109
    v_mul_f32 v110, v110, v14
    v_mul_f32 v111, v111, v14
    v_cvt_pk_bf16_f32 v39, v110, v111
    s_waitcnt lgkmcnt(7)
    v_mfma_f32_32x32x16_bf16 v[48:63], v[16:19], v[224:227], v[48:63]
    ds_read_b64_tr_b16 a[76:77], v3 offset:47616
    ds_read_b64_tr_b16 a[78:79], v3 offset:48640
    v_xor_b32 v0, 96, v9
    ds_write_b128 v0, v[36:39]
    v_mfma_f32_32x32x16_bf16 v[64:79], v[20:23], v[224:227], v[64:79]
    v_xor_b32 v3, 0xc000, v3
    ds_read_b64_tr_b16 v[16:17], v3 offset:0
    ds_read_b64_tr_b16 v[18:19], v3 offset:1024
    v_mfma_f32_32x32x16_bf16 v[48:63], v[24:27], v[228:231], v[48:63]
    ds_read_b64_tr_b16 v[20:21], v3 offset:512
    ds_read_b64_tr_b16 v[22:23], v3 offset:1536
    ds_read_b128 v[32:35], v10 offset:0
    ds_read_b128 v[36:39], v10 offset:1024
    v_mfma_f32_32x32x16_bf16 v[64:79], v[28:31], v[228:231], v[64:79]
    ds_read_b64_tr_b16 v[24:25], v3 offset:2048
    ds_read_b64_tr_b16 v[26:27], v3 offset:3072
    s_waitcnt lgkmcnt(3)
    s_add_u32 s30, s24, 32896
    buffer_store_dwordx4 v[32:35], v11, s[20:23], s30 offen sc1
    v_mfma_f32_32x32x16_bf16 v[48:63], a[64:67], v[240:243], v[48:63]
    ds_read_b64_tr_b16 v[28:29], v3 offset:2560
    ds_read_b64_tr_b16 v[30:31], v3 offset:3584
    v_mfma_f32_32x32x16_bf16 v[64:79], a[68:71], v[240:243], v[64:79]
    ds_read_b64_tr_b16 a[64:65], v3 offset:4096
    ds_read_b64_tr_b16 a[66:67], v3 offset:5120
    s_waitcnt lgkmcnt(6)
    s_add_u32 s30, s24, 36992
    buffer_store_dwordx4 v[36:39], v11, s[20:23], s30 offen sc1
    v_mfma_f32_32x32x16_bf16 v[48:63], a[72:75], v[244:247], v[48:63]
    ds_read_b64_tr_b16 a[68:69], v3 offset:4608
    ds_read_b64_tr_b16 a[70:71], v3 offset:5632
    ds_read_b128 v[32:35], v10 offset:2048
    ds_read_b128 v[36:39], v10 offset:3072
    v_mfma_f32_32x32x16_bf16 v[64:79], a[76:79], v[244:247], v[64:79]
    ds_read_b64_tr_b16 a[72:73], v3 offset:6144
    ds_read_b64_tr_b16 a[74:75], v3 offset:7168
    s_waitcnt lgkmcnt(8)
    v_mfma_f32_32x32x16_bf16 v[80:95], v[16:19], a[80:83], 0
    ds_read_b64_tr_b16 a[76:77], v3 offset:6656
    ds_read_b64_tr_b16 a[78:79], v3 offset:7680
    s_waitcnt lgkmcnt(5)
    s_add_u32 s30, s24, 41088
    buffer_store_dwordx4 v[32:35], v11, s[20:23], s30 offen sc1
    v_mfma_f32_32x32x16_bf16 v[96:111], v[20:23], a[80:83], 0
    ds_read_b64_tr_b16 v[16:17], v3 offset:8192
    ds_read_b64_tr_b16 v[18:19], v3 offset:9216
    s_waitcnt lgkmcnt(6)
    s_add_u32 s30, s24, 45184
    buffer_store_dwordx4 v[36:39], v11, s[20:23], s30 offen sc1
    v_mfma_f32_32x32x16_bf16 v[80:95], v[24:27], a[84:87], v[80:95]
    ds_read_b64_tr_b16 v[20:21], v3 offset:8704
    ds_read_b64_tr_b16 v[22:23], v3 offset:9728
    v_mfma_f32_32x32x16_bf16 v[96:111], v[28:31], a[84:87], v[96:111]
    ds_read_b64_tr_b16 v[24:25], v3 offset:10240
    ds_read_b64_tr_b16 v[26:27], v3 offset:11264
    v_mul_f32 v48, v48, v12
    v_mul_f32 v49, v49, v12
    v_cvt_pk_bf16_f32 v32, v48, v49
    v_mul_f32 v50, v50, v12
    v_mul_f32 v51, v51, v12
    s_waitcnt lgkmcnt(6)
    v_mfma_f32_32x32x16_bf16 v[80:95], a[64:67], a[96:99], v[80:95]
    ds_read_b64_tr_b16 v[28:29], v3 offset:10752
    ds_read_b64_tr_b16 v[30:31], v3 offset:11776
    v_cvt_pk_bf16_f32 v33, v50, v51
    v_mul_f32 v52, v52, v12
    v_mul_f32 v53, v53, v12
    v_cvt_pk_bf16_f32 v34, v52, v53
    v_mul_f32 v54, v54, v12
    v_mul_f32 v55, v55, v12
    v_mfma_f32_32x32x16_bf16 v[96:111], a[68:71], a[96:99], v[96:111]
    ds_read_b64_tr_b16 a[64:65], v3 offset:12288
    ds_read_b64_tr_b16 a[66:67], v3 offset:13312
    v_cvt_pk_bf16_f32 v35, v54, v55
    v_mfma_f32_32x32x16_bf16 v[80:95], a[72:75], a[100:103], v[80:95]
    ds_read_b64_tr_b16 a[68:69], v3 offset:12800
    ds_read_b64_tr_b16 a[70:71], v3 offset:13824
    ds_write_b128 v9, v[32:35]
    v_mfma_f32_32x32x16_bf16 v[96:111], a[76:79], a[100:103], v[96:111]
    ds_read_b64_tr_b16 a[72:73], v3 offset:14336
    ds_read_b64_tr_b16 a[74:75], v3 offset:15360
    v_mul_f32 v56, v56, v12
    v_mul_f32 v57, v57, v12
    v_cvt_pk_bf16_f32 v36, v56, v57
    s_waitcnt lgkmcnt(7)
    v_mfma_f32_32x32x16_bf16 v[80:95], v[16:19], a[112:115], v[80:95]
    ds_read_b64_tr_b16 a[76:77], v3 offset:14848
    ds_read_b64_tr_b16 a[78:79], v3 offset:15872
    v_mfma_f32_32x32x16_bf16 v[96:111], v[20:23], a[112:115], v[96:111]
    v_xor_b32 v3, 0xc000, v3
    ds_read_b64_tr_b16 v[16:17], v3 offset:32768
    ds_read_b64_tr_b16 v[18:19], v3 offset:33792
    v_mul_f32 v58, v58, v12
    v_mul_f32 v59, v59, v12
    v_cvt_pk_bf16_f32 v37, v58, v59
    v_mul_f32 v60, v60, v12
    v_mfma_f32_32x32x16_bf16 v[80:95], v[24:27], a[116:119], v[80:95]
    ds_read_b64_tr_b16 v[20:21], v3 offset:33280
    ds_read_b64_tr_b16 v[22:23], v3 offset:34304
    v_mul_f32 v61, v61, v12
    v_cvt_pk_bf16_f32 v38, v60, v61
    v_mul_f32 v62, v62, v12
    v_mul_f32 v63, v63, v12
    v_cvt_pk_bf16_f32 v39, v62, v63
    v_mfma_f32_32x32x16_bf16 v[96:111], v[28:31], a[116:119], v[96:111]
    ds_read_b64_tr_b16 v[24:25], v3 offset:34816
    ds_read_b64_tr_b16 v[26:27], v3 offset:35840
    s_waitcnt lgkmcnt(6)
    v_mfma_f32_32x32x16_bf16 v[80:95], a[64:67], a[128:131], v[80:95]
    ds_read_b64_tr_b16 v[28:29], v3 offset:35328
    ds_read_b64_tr_b16 v[30:31], v3 offset:36352
    v_xor_b32 v0, 32, v9
    ds_write_b128 v0, v[36:39]
    v_mfma_f32_32x32x16_bf16 v[96:111], a[68:71], a[128:131], v[96:111]
    ds_read_b64_tr_b16 a[64:65], v3 offset:36864
    ds_read_b64_tr_b16 a[66:67], v3 offset:37888
    v_mul_f32 v64, v64, v12
    v_mul_f32 v65, v65, v12
    v_cvt_pk_bf16_f32 v32, v64, v65
    v_mul_f32 v66, v66, v12
    v_mfma_f32_32x32x16_bf16 v[80:95], a[72:75], a[132:135], v[80:95]
    ds_read_b64_tr_b16 a[68:69], v3 offset:37376
    ds_read_b64_tr_b16 a[70:71], v3 offset:38400
    v_mfma_f32_32x32x16_bf16 v[96:111], a[76:79], a[132:135], v[96:111]
    ds_read_b64_tr_b16 a[72:73], v3 offset:38912
    ds_read_b64_tr_b16 a[74:75], v3 offset:39936
    v_mul_f32 v67, v67, v12
    v_cvt_pk_bf16_f32 v33, v66, v67
    v_mul_f32 v68, v68, v12
    s_waitcnt vmcnt(28)
    s_barrier
    s_waitcnt lgkmcnt(7)
    v_mfma_f32_32x32x16_bf16 v[112:127], v[16:19], a[216:219], v[112:127]
    ds_read_b64_tr_b16 a[76:77], v3 offset:39424
    ds_read_b64_tr_b16 a[78:79], v3 offset:40448
    v_mul_f32 v69, v69, v12
    v_cvt_pk_bf16_f32 v34, v68, v69
    v_mul_f32 v70, v70, v12
    v_mul_f32 v71, v71, v12
    v_cvt_pk_bf16_f32 v35, v70, v71
    v_mfma_f32_32x32x16_bf16 v[128:143], v[20:23], a[216:219], v[128:143]
    ds_read_b64_tr_b16 v[16:17], v3 offset:40960
    ds_read_b64_tr_b16 v[18:19], v3 offset:41984
    s_add_u32 m0, s27, 65536
    s_add_u32 s29, s24, 65920
    buffer_load_dwordx4 v5, s[16:19], s29 offen nt lds
    v_mfma_f32_32x32x16_bf16 v[112:127], v[24:27], a[220:223], v[112:127]
    ds_read_b64_tr_b16 v[20:21], v3 offset:41472
    ds_read_b64_tr_b16 v[22:23], v3 offset:42496
    v_xor_b32 v0, 64, v9
    ds_write_b128 v0, v[32:35]
    v_mfma_f32_32x32x16_bf16 v[128:143], v[28:31], a[220:223], v[128:143]
    ds_read_b64_tr_b16 v[24:25], v3 offset:43008
    ds_read_b64_tr_b16 v[26:27], v3 offset:44032
    v_mul_f32 v72, v72, v12
    v_mul_f32 v73, v73, v12
    v_cvt_pk_bf16_f32 v36, v72, v73
    s_waitcnt lgkmcnt(7)
    v_mfma_f32_32x32x16_bf16 v[112:127], a[64:67], a[232:235], v[112:127]
    ds_read_b64_tr_b16 v[28:29], v3 offset:43520
    ds_read_b64_tr_b16 v[30:31], v3 offset:44544
    s_add_u32 m0, s27, 69632
    s_add_u32 s29, s24, 82304
    buffer_load_dwordx4 v5, s[16:19], s29 offen nt lds
    v_mfma_f32_32x32x16_bf16 v[128:143], a[68:71], a[232:235], v[128:143]
    ds_read_b64_tr_b16 a[64:65], v3 offset:45056
    ds_read_b64_tr_b16 a[66:67], v3 offset:46080
    s_waitcnt vmcnt(22)
    ds_read_b128 a[16:19], v7 offset:16384
    v_mul_f32 v74, v74, v12
    v_mul_f32 v75, v75, v12
    v_mfma_f32_32x32x16_bf16 v[112:127], a[72:75], a[236:239], v[112:127]
    ds_read_b64_tr_b16 a[68:69], v3 offset:45568
    ds_read_b64_tr_b16 a[70:71], v3 offset:46592
    ds_read_b128 a[20:23], v8 offset:16384
    ds_read_b128 a[24:27], v7 offset:16896
    ds_read_b128 a[28:31], v8 offset:16896
    v_cvt_pk_bf16_f32 v37, v74, v75
    v_mul_f32 v76, v76, v12
    v_mfma_f32_32x32x16_bf16 v[128:143], a[76:79], a[236:239], v[128:143]
    ds_read_b64_tr_b16 a[72:73], v3 offset:47104
    ds_read_b64_tr_b16 a[74:75], v3 offset:48128
    s_add_u32 m0, s27, 73728
    s_add_u32 s29, s24, 98688
    buffer_load_dwordx4 v5, s[16:19], s29 offen nt lds
    s_waitcnt lgkmcnt(10)
    v_mfma_f32_32x32x16_bf16 v[112:127], v[16:19], v[232:235], v[112:127]
    ds_read_b64_tr_b16 a[76:77], v3 offset:47616
    ds_read_b64_tr_b16 a[78:79], v3 offset:48640
    v_mul_f32 v77, v77, v12
    v_cvt_pk_bf16_f32 v38, v76, v77
    v_mul_f32 v78, v78, v12
    v_mul_f32 v79, v79, v12
    v_cvt_pk_bf16_f32 v39, v78, v79
    v_mfma_f32_32x32x16_bf16 v[128:143], v[20:23], v[232:235], v[128:143]
    v_xor_b32 v3, 0xc000, v3
    ds_read_b64_tr_b16 v[16:17], v3 offset:0
    ds_read_b64_tr_b16 v[18:19], v3 offset:1024
    v_xor_b32 v0, 96, v9
    ds_write_b128 v0, v[36:39]
    v_mfma_f32_32x32x16_bf16 v[112:127], v[24:27], v[236:239], v[112:127]
    ds_read_b64_tr_b16 v[20:21], v3 offset:512
    ds_read_b64_tr_b16 v[22:23], v3 offset:1536
    s_add_u32 m0, s27, 77824
    s_add_u32 s29, s24, 115072
    buffer_load_dwordx4 v5, s[16:19], s29 offen nt lds
    s_waitcnt lgkmcnt(9)
    ds_read_b128 v[32:35], v10 offset:0
    v_mfma_f32_32x32x16_bf16 v[128:143], v[28:31], v[236:239], v[128:143]
    ds_read_b64_tr_b16 v[24:25], v3 offset:2048
    ds_read_b64_tr_b16 v[26:27], v3 offset:3072
    ds_read_b128 v[36:39], v10 offset:1024
    s_waitcnt lgkmcnt(9)
    v_mfma_f32_32x32x16_bf16 v[112:127], a[64:67], v[248:251], v[112:127]
    ds_read_b64_tr_b16 v[28:29], v3 offset:2560
    ds_read_b64_tr_b16 v[30:31], v3 offset:3584
    s_waitcnt lgkmcnt(5)
    s_add_u32 s30, s24, 128
    buffer_store_dwordx4 v[32:35], v11, s[20:23], s30 offen sc1
    v_mfma_f32_32x32x16_bf16 v[128:143], a[68:71], v[248:251], v[128:143]
    ds_read_b64_tr_b16 a[64:65], v3 offset:4096
    ds_read_b64_tr_b16 a[66:67], v3 offset:5120
    s_add_u32 m0, s27, 114688
    s_add_u32 s29, s25, 33024
    buffer_load_dwordx4 v6, s[8:11], s29 offen nt lds
    v_xor_b32 v6, 32, v6
    v_mfma_f32_32x32x16_bf16 v[112:127], a[72:75], v[252:255], v[112:127]
    ds_read_b64_tr_b16 a[68:69], v3 offset:4608
    ds_read_b64_tr_b16 a[70:71], v3 offset:5632
    s_waitcnt lgkmcnt(6)
    s_add_u32 s30, s24, 4224
    buffer_store_dwordx4 v[36:39], v11, s[20:23], s30 offen sc1
    v_mfma_f32_32x32x16_bf16 v[128:143], a[76:79], v[252:255], v[128:143]
    ds_read_b64_tr_b16 a[72:73], v3 offset:6144
    ds_read_b64_tr_b16 a[74:75], v3 offset:7168
    ds_read_b128 v[32:35], v10 offset:2048
    ds_read_b128 v[36:39], v10 offset:3072
    s_waitcnt lgkmcnt(8)
    v_mfma_f32_32x32x16_bf16 v[48:63], v[16:19], v[144:147], 0
    ds_read_b64_tr_b16 a[76:77], v3 offset:6656
    ds_read_b64_tr_b16 a[78:79], v3 offset:7680
    s_add_u32 m0, s27, 118784
    s_add_u32 s29, s25, 37120
    buffer_load_dwordx4 v6, s[8:11], s29 offen nt lds
    v_xor_b32 v6, 32, v6
    s_waitcnt lgkmcnt(3)
    s_add_u32 s30, s24, 8320
    buffer_store_dwordx4 v[32:35], v11, s[20:23], s30 offen sc1
    v_mfma_f32_32x32x16_bf16 v[64:79], v[20:23], v[144:147], 0
    ds_read_b64_tr_b16 v[16:17], v3 offset:8192
    ds_read_b64_tr_b16 v[18:19], v3 offset:9216
    s_waitcnt lgkmcnt(4)
    s_add_u32 s30, s24, 12416
    buffer_store_dwordx4 v[36:39], v11, s[20:23], s30 offen sc1
    v_mfma_f32_32x32x16_bf16 v[48:63], v[24:27], v[148:151], v[48:63]
    ds_read_b64_tr_b16 v[20:21], v3 offset:8704
    ds_read_b64_tr_b16 v[22:23], v3 offset:9728
    v_mul_f32 v112, v112, v13
    v_mul_f32 v113, v113, v13
    v_cvt_pk_bf16_f32 v32, v112, v113
    v_mfma_f32_32x32x16_bf16 v[64:79], v[28:31], v[148:151], v[64:79]
    ds_read_b64_tr_b16 v[24:25], v3 offset:10240
    ds_read_b64_tr_b16 v[26:27], v3 offset:11264
    s_add_u32 m0, s27, 122880
    s_add_u32 s29, s25, 41216
    buffer_load_dwordx4 v6, s[8:11], s29 offen nt lds
    v_xor_b32 v6, 32, v6
    s_waitcnt lgkmcnt(6)
    v_mfma_f32_32x32x16_bf16 v[48:63], a[64:67], v[152:155], v[48:63]
    ds_read_b64_tr_b16 v[28:29], v3 offset:10752
    ds_read_b64_tr_b16 v[30:31], v3 offset:11776
    v_mul_f32 v114, v114, v13
    v_mul_f32 v115, v115, v13
    v_cvt_pk_bf16_f32 v33, v114, v115
    v_mfma_f32_32x32x16_bf16 v[64:79], a[68:71], v[152:155], v[64:79]
    ds_read_b64_tr_b16 a[64:65], v3 offset:12288
    ds_read_b64_tr_b16 a[66:67], v3 offset:13312
    v_mul_f32 v116, v116, v13
    v_mul_f32 v117, v117, v13
    v_cvt_pk_bf16_f32 v34, v116, v117
    v_mfma_f32_32x32x16_bf16 v[48:63], a[72:75], v[156:159], v[48:63]
    ds_read_b64_tr_b16 a[68:69], v3 offset:12800
    ds_read_b64_tr_b16 a[70:71], v3 offset:13824
    s_add_u32 m0, s27, 126976
    s_add_u32 s29, s25, 45312
    buffer_load_dwordx4 v6, s[8:11], s29 offen nt lds
    v_xor_b32 v6, 32, v6
    v_mfma_f32_32x32x16_bf16 v[64:79], a[76:79], v[156:159], v[64:79]
    ds_read_b64_tr_b16 a[72:73], v3 offset:14336
    ds_read_b64_tr_b16 a[74:75], v3 offset:15360
    v_mul_f32 v118, v118, v13
    v_mul_f32 v119, v119, v13
    v_cvt_pk_bf16_f32 v35, v118, v119
    s_waitcnt lgkmcnt(6)
    v_mfma_f32_32x32x16_bf16 v[48:63], v[16:19], v[160:163], v[48:63]
    ds_read_b64_tr_b16 a[76:77], v3 offset:14848
    ds_read_b64_tr_b16 a[78:79], v3 offset:15872
    ds_write_b128 v9, v[32:35]
    v_mfma_f32_32x32x16_bf16 v[64:79], v[20:23], v[160:163], v[64:79]
    ds_read_b64_tr_b16 v[16:17], v3 offset:16384
    ds_read_b64_tr_b16 v[18:19], v3 offset:17408
    v_mfma_f32_32x32x16_bf16 v[48:63], v[24:27], v[164:167], v[48:63]
    ds_read_b64_tr_b16 v[20:21], v3 offset:16896
    ds_read_b64_tr_b16 v[22:23], v3 offset:17920
    v_mul_f32 v120, v120, v13
    v_mul_f32 v121, v121, v13
    v_cvt_pk_bf16_f32 v36, v120, v121
    v_mfma_f32_32x32x16_bf16 v[64:79], v[28:31], v[164:167], v[64:79]
    ds_read_b64_tr_b16 v[24:25], v3 offset:18432
    ds_read_b64_tr_b16 v[26:27], v3 offset:19456
    v_mul_f32 v122, v122, v13
    v_mul_f32 v123, v123, v13
    s_waitcnt lgkmcnt(7)
    v_mfma_f32_32x32x16_bf16 v[48:63], a[64:67], v[168:171], v[48:63]
    ds_read_b64_tr_b16 v[28:29], v3 offset:18944
    ds_read_b64_tr_b16 v[30:31], v3 offset:19968
    v_mfma_f32_32x32x16_bf16 v[64:79], a[68:71], v[168:171], v[64:79]
    ds_read_b64_tr_b16 a[64:65], v3 offset:20480
    ds_read_b64_tr_b16 a[66:67], v3 offset:21504
    v_cvt_pk_bf16_f32 v37, v122, v123
    v_mul_f32 v124, v124, v13
    v_mul_f32 v125, v125, v13
    v_mfma_f32_32x32x16_bf16 v[48:63], a[72:75], v[172:175], v[48:63]
    ds_read_b64_tr_b16 a[68:69], v3 offset:20992
    ds_read_b64_tr_b16 a[70:71], v3 offset:22016
    v_cvt_pk_bf16_f32 v38, v124, v125
    v_mul_f32 v126, v126, v13
    v_mul_f32 v127, v127, v13
    v_cvt_pk_bf16_f32 v39, v126, v127
    v_mfma_f32_32x32x16_bf16 v[64:79], a[76:79], v[172:175], v[64:79]
    ds_read_b64_tr_b16 a[72:73], v3 offset:22528
    ds_read_b64_tr_b16 a[74:75], v3 offset:23552
    s_waitcnt lgkmcnt(6)
    v_mfma_f32_32x32x16_bf16 v[80:95], v[16:19], a[144:147], v[80:95]
    ds_read_b64_tr_b16 a[76:77], v3 offset:23040
    ds_read_b64_tr_b16 a[78:79], v3 offset:24064
    v_xor_b32 v0, 32, v9
    ds_write_b128 v0, v[36:39]
    v_mfma_f32_32x32x16_bf16 v[96:111], v[20:23], a[144:147], v[96:111]
    ds_read_b64_tr_b16 v[16:17], v3 offset:24576
    ds_read_b64_tr_b16 v[18:19], v3 offset:25600
    v_mul_f32 v128, v128, v13
    v_mul_f32 v129, v129, v13
    v_cvt_pk_bf16_f32 v32, v128, v129
    v_mul_f32 v130, v130, v13
    v_mfma_f32_32x32x16_bf16 v[80:95], v[24:27], a[148:151], v[80:95]
    ds_read_b64_tr_b16 v[20:21], v3 offset:25088
    ds_read_b64_tr_b16 v[22:23], v3 offset:26112
    v_mfma_f32_32x32x16_bf16 v[96:111], v[28:31], a[148:151], v[96:111]
    ds_read_b64_tr_b16 v[24:25], v3 offset:26624
    ds_read_b64_tr_b16 v[26:27], v3 offset:27648
    v_mul_f32 v131, v131, v13
    v_cvt_pk_bf16_f32 v33, v130, v131
    v_mul_f32 v132, v132, v13
    s_waitcnt lgkmcnt(7)
    v_mfma_f32_32x32x16_bf16 v[80:95], a[64:67], a[160:163], v[80:95]
    ds_read_b64_tr_b16 v[28:29], v3 offset:27136
    ds_read_b64_tr_b16 v[30:31], v3 offset:28160
    v_mul_f32 v133, v133, v13
    v_cvt_pk_bf16_f32 v34, v132, v133
    v_mul_f32 v134, v134, v13
    v_mul_f32 v135, v135, v13
    v_cvt_pk_bf16_f32 v35, v134, v135
    v_mfma_f32_32x32x16_bf16 v[96:111], a[68:71], a[160:163], v[96:111]
    ds_read_b64_tr_b16 a[64:65], v3 offset:28672
    ds_read_b64_tr_b16 a[66:67], v3 offset:29696
    v_mfma_f32_32x32x16_bf16 v[80:95], a[72:75], a[164:167], v[80:95]
    ds_read_b64_tr_b16 a[68:69], v3 offset:29184
    ds_read_b64_tr_b16 a[70:71], v3 offset:30208
    v_xor_b32 v0, 64, v9
    ds_write_b128 v0, v[32:35]
    v_mfma_f32_32x32x16_bf16 v[96:111], a[76:79], a[164:167], v[96:111]
    ds_read_b64_tr_b16 a[72:73], v3 offset:30720
    ds_read_b64_tr_b16 a[74:75], v3 offset:31744
    v_mul_f32 v136, v136, v13
    v_mul_f32 v137, v137, v13
    s_waitcnt lgkmcnt(7)
    v_mfma_f32_32x32x16_bf16 v[80:95], v[16:19], a[176:179], v[80:95]
    ds_read_b64_tr_b16 a[76:77], v3 offset:31232
    ds_read_b64_tr_b16 a[78:79], v3 offset:32256
    v_mfma_f32_32x32x16_bf16 v[96:111], v[20:23], a[176:179], v[96:111]
    ds_read_b64_tr_b16 v[16:17], v3 offset:0
    ds_read_b64_tr_b16 v[18:19], v3 offset:1024
    v_cvt_pk_bf16_f32 v36, v136, v137
    v_mul_f32 v138, v138, v13
    v_mul_f32 v139, v139, v13
    v_mfma_f32_32x32x16_bf16 v[80:95], v[24:27], a[180:183], v[80:95]
    ds_read_b64_tr_b16 v[20:21], v3 offset:512
    ds_read_b64_tr_b16 v[22:23], v3 offset:1536
    v_cvt_pk_bf16_f32 v37, v138, v139
    v_mul_f32 v140, v140, v13
    v_mul_f32 v141, v141, v13
    v_mfma_f32_32x32x16_bf16 v[96:111], v[28:31], a[180:183], v[96:111]
    ds_read_b64_tr_b16 v[24:25], v3 offset:2048
    ds_read_b64_tr_b16 v[26:27], v3 offset:3072
    s_waitcnt lgkmcnt(6)
    v_mfma_f32_32x32x16_bf16 v[80:95], a[64:67], a[192:195], v[80:95]
    ds_read_b64_tr_b16 v[28:29], v3 offset:2560
    ds_read_b64_tr_b16 v[30:31], v3 offset:3584
    v_cvt_pk_bf16_f32 v38, v140, v141
    v_mul_f32 v142, v142, v13
    v_mul_f32 v143, v143, v13
    v_cvt_pk_bf16_f32 v39, v142, v143
    v_mfma_f32_32x32x16_bf16 v[96:111], a[68:71], a[192:195], v[96:111]
    ds_read_b64_tr_b16 a[64:65], v3 offset:4096
    ds_read_b64_tr_b16 a[66:67], v3 offset:5120
    v_xor_b32 v0, 96, v9
    ds_write_b128 v0, v[36:39]
    v_mfma_f32_32x32x16_bf16 v[80:95], a[72:75], a[196:199], v[80:95]
    ds_read_b64_tr_b16 a[68:69], v3 offset:4608
    ds_read_b64_tr_b16 a[70:71], v3 offset:5632
    v_mfma_f32_32x32x16_bf16 v[96:111], a[76:79], a[196:199], v[96:111]
    ds_read_b64_tr_b16 a[72:73], v3 offset:6144
    ds_read_b64_tr_b16 a[74:75], v3 offset:7168
    s_waitcnt vmcnt(27)
    s_barrier
    s_waitcnt lgkmcnt(7)
    v_mfma_f32_32x32x16_bf16 v[112:127], v[16:19], a[88:91], 0
    ds_read_b64_tr_b16 a[76:77], v3 offset:6656
    ds_read_b64_tr_b16 a[78:79], v3 offset:7680
    v_mfma_f32_32x32x16_bf16 v[128:143], v[20:23], a[88:91], 0
    ds_read_b64_tr_b16 v[16:17], v3 offset:8192
    ds_read_b64_tr_b16 v[18:19], v3 offset:9216
    s_add_u32 m0, s27, 81920
    s_add_u32 s29, s24, 131456
    buffer_load_dwordx4 v5, s[16:19], s29 offen nt lds
    v_mfma_f32_32x32x16_bf16 v[112:127], v[24:27], a[92:95], v[112:127]
    ds_read_b64_tr_b16 v[20:21], v3 offset:8704
    ds_read_b64_tr_b16 v[22:23], v3 offset:9728
    v_mfma_f32_32x32x16_bf16 v[128:143], v[28:31], a[92:95], v[128:143]
    ds_read_b64_tr_b16 v[24:25], v3 offset:10240
    ds_read_b64_tr_b16 v[26:27], v3 offset:11264
    s_waitcnt lgkmcnt(6)
    v_mfma_f32_32x32x16_bf16 v[112:127], a[64:67], a[104:107], v[112:127]
    ds_read_b64_tr_b16 v[28:29], v3 offset:10752
    ds_read_b64_tr_b16 v[30:31], v3 offset:11776
    s_add_u32 m0, s27, 86016
    s_add_u32 s29, s24, 147840
    buffer_load_dwordx4 v5, s[16:19], s29 offen nt lds
    v_mfma_f32_32x32x16_bf16 v[128:143], a[68:71], a[104:107], v[128:143]
    ds_read_b64_tr_b16 a[64:65], v3 offset:12288
    ds_read_b64_tr_b16 a[66:67], v3 offset:13312
    ds_read_b128 v[32:35], v10 offset:0
    v_mfma_f32_32x32x16_bf16 v[112:127], a[72:75], a[108:111], v[112:127]
    ds_read_b64_tr_b16 a[68:69], v3 offset:12800
    ds_read_b64_tr_b16 a[70:71], v3 offset:13824
    ds_read_b128 v[36:39], v10 offset:1024
    v_mfma_f32_32x32x16_bf16 v[128:143], a[76:79], a[108:111], v[128:143]
    ds_read_b64_tr_b16 a[72:73], v3 offset:14336
    ds_read_b64_tr_b16 a[74:75], v3 offset:15360
    s_add_u32 m0, s27, 90112
    s_add_u32 s29, s24, 164224
    buffer_load_dwordx4 v5, s[16:19], s29 offen nt lds
    s_waitcnt lgkmcnt(8)
    v_mfma_f32_32x32x16_bf16 v[112:127], v[16:19], a[120:123], v[112:127]
    ds_read_b64_tr_b16 a[76:77], v3 offset:14848
    ds_read_b64_tr_b16 a[78:79], v3 offset:15872
    v_mfma_f32_32x32x16_bf16 v[128:143], v[20:23], a[120:123], v[128:143]
    ds_read_b64_tr_b16 v[16:17], v3 offset:16384
    ds_read_b64_tr_b16 v[18:19], v3 offset:17408
    s_waitcnt lgkmcnt(9)
    s_add_u32 s30, s24, 16512
    buffer_store_dwordx4 v[32:35], v11, s[20:23], s30 offen sc1
    v_mfma_f32_32x32x16_bf16 v[112:127], v[24:27], a[124:127], v[112:127]
    ds_read_b64_tr_b16 v[20:21], v3 offset:16896
    ds_read_b64_tr_b16 v[22:23], v3 offset:17920
    s_add_u32 m0, s27, 94208
    s_add_u32 s29, s24, 180608
    buffer_load_dwordx4 v5, s[16:19], s29 offen nt lds
    v_mfma_f32_32x32x16_bf16 v[128:143], v[28:31], a[124:127], v[128:143]
    ds_read_b64_tr_b16 v[24:25], v3 offset:18432
    ds_read_b64_tr_b16 v[26:27], v3 offset:19456
    s_waitcnt lgkmcnt(6)
    v_mfma_f32_32x32x16_bf16 v[112:127], a[64:67], a[136:139], v[112:127]
    ds_read_b64_tr_b16 v[28:29], v3 offset:18944
    ds_read_b64_tr_b16 v[30:31], v3 offset:19968
    s_add_u32 s30, s24, 20608
    buffer_store_dwordx4 v[36:39], v11, s[20:23], s30 offen sc1
    v_mfma_f32_32x32x16_bf16 v[128:143], a[68:71], a[136:139], v[128:143]
    ds_read_b64_tr_b16 a[64:65], v3 offset:20480
    ds_read_b64_tr_b16 a[66:67], v3 offset:21504
    v_mfma_f32_32x32x16_bf16 v[112:127], a[72:75], a[140:143], v[112:127]
    ds_read_b64_tr_b16 a[68:69], v3 offset:20992
    ds_read_b64_tr_b16 a[70:71], v3 offset:22016
    ds_read_b128 v[32:35], v10 offset:2048
    v_mfma_f32_32x32x16_bf16 v[128:143], a[76:79], a[140:143], v[128:143]
    ds_read_b64_tr_b16 a[72:73], v3 offset:22528
    ds_read_b64_tr_b16 a[74:75], v3 offset:23552
    s_waitcnt lgkmcnt(7)
    v_mfma_f32_32x32x16_bf16 v[48:63], v[16:19], v[176:179], v[48:63]
    ds_read_b64_tr_b16 a[76:77], v3 offset:23040
    ds_read_b64_tr_b16 a[78:79], v3 offset:24064
    v_mfma_f32_32x32x16_bf16 v[64:79], v[20:23], v[176:179], v[64:79]
    ds_read_b64_tr_b16 v[16:17], v3 offset:24576
    ds_read_b64_tr_b16 v[18:19], v3 offset:25600
    ds_read_b128 v[36:39], v10 offset:3072
    v_mfma_f32_32x32x16_bf16 v[48:63], v[24:27], v[180:183], v[48:63]
    ds_read_b64_tr_b16 v[20:21], v3 offset:25088
    ds_read_b64_tr_b16 v[22:23], v3 offset:26112
    v_mfma_f32_32x32x16_bf16 v[64:79], v[28:31], v[180:183], v[64:79]
    ds_read_b64_tr_b16 v[24:25], v3 offset:26624
    ds_read_b64_tr_b16 v[26:27], v3 offset:27648
    s_waitcnt lgkmcnt(7)
    v_mfma_f32_32x32x16_bf16 v[48:63], a[64:67], v[184:187], v[48:63]
    ds_read_b64_tr_b16 v[28:29], v3 offset:27136
    ds_read_b64_tr_b16 v[30:31], v3 offset:28160
    s_add_u32 s30, s24, 24704
    buffer_store_dwordx4 v[32:35], v11, s[20:23], s30 offen sc1
    v_mfma_f32_32x32x16_bf16 v[64:79], a[68:71], v[184:187], v[64:79]
    ds_read_b64_tr_b16 a[64:65], v3 offset:28672
    ds_read_b64_tr_b16 a[66:67], v3 offset:29696
    s_waitcnt lgkmcnt(8)
    s_add_u32 s30, s24, 28800
    buffer_store_dwordx4 v[36:39], v11, s[20:23], s30 offen sc1
    v_mfma_f32_32x32x16_bf16 v[48:63], a[72:75], v[188:191], v[48:63]
    ds_read_b64_tr_b16 a[68:69], v3 offset:29184
    ds_read_b64_tr_b16 a[70:71], v3 offset:30208
    v_mfma_f32_32x32x16_bf16 v[64:79], a[76:79], v[188:191], v[64:79]
    ds_read_b64_tr_b16 a[72:73], v3 offset:30720
    ds_read_b64_tr_b16 a[74:75], v3 offset:31744
    s_waitcnt lgkmcnt(6)
    v_mfma_f32_32x32x16_bf16 v[48:63], v[16:19], v[192:195], v[48:63]
    ds_read_b64_tr_b16 a[76:77], v3 offset:31232
    ds_read_b64_tr_b16 a[78:79], v3 offset:32256
    v_mfma_f32_32x32x16_bf16 v[64:79], v[20:23], v[192:195], v[64:79]
    ds_read_b64_tr_b16 v[16:17], v3 offset:32768
    ds_read_b64_tr_b16 v[18:19], v3 offset:33792
    v_mfma_f32_32x32x16_bf16 v[48:63], v[24:27], v[196:199], v[48:63]
    ds_read_b64_tr_b16 v[20:21], v3 offset:33280
    ds_read_b64_tr_b16 v[22:23], v3 offset:34304
    v_mfma_f32_32x32x16_bf16 v[64:79], v[28:31], v[196:199], v[64:79]
    ds_read_b64_tr_b16 v[24:25], v3 offset:34816
    ds_read_b64_tr_b16 v[26:27], v3 offset:35840
    s_waitcnt lgkmcnt(6)
    v_mfma_f32_32x32x16_bf16 v[48:63], a[64:67], v[200:203], v[48:63]
    ds_read_b64_tr_b16 v[28:29], v3 offset:35328
    ds_read_b64_tr_b16 v[30:31], v3 offset:36352
    v_mfma_f32_32x32x16_bf16 v[64:79], a[68:71], v[200:203], v[64:79]
    ds_read_b64_tr_b16 a[64:65], v3 offset:36864
    ds_read_b64_tr_b16 a[66:67], v3 offset:37888
    v_mfma_f32_32x32x16_bf16 v[48:63], a[72:75], v[204:207], v[48:63]
    ds_read_b64_tr_b16 a[68:69], v3 offset:37376
    ds_read_b64_tr_b16 a[70:71], v3 offset:38400
    v_mfma_f32_32x32x16_bf16 v[64:79], a[76:79], v[204:207], v[64:79]
    ds_read_b64_tr_b16 a[72:73], v3 offset:38912
    ds_read_b64_tr_b16 a[74:75], v3 offset:39936
    s_waitcnt lgkmcnt(6)
    v_mfma_f32_32x32x16_bf16 v[80:95], v[16:19], a[208:211], v[80:95]
    ds_read_b64_tr_b16 a[76:77], v3 offset:39424
    ds_read_b64_tr_b16 a[78:79], v3 offset:40448
    v_mfma_f32_32x32x16_bf16 v[96:111], v[20:23], a[208:211], v[96:111]
    ds_read_b64_tr_b16 v[16:17], v3 offset:40960
    ds_read_b64_tr_b16 v[18:19], v3 offset:41984
    v_mfma_f32_32x32x16_bf16 v[80:95], v[24:27], a[212:215], v[80:95]
    ds_read_b64_tr_b16 v[20:21], v3 offset:41472
    ds_read_b64_tr_b16 v[22:23], v3 offset:42496
    v_mfma_f32_32x32x16_bf16 v[96:111], v[28:31], a[212:215], v[96:111]
    ds_read_b64_tr_b16 v[24:25], v3 offset:43008
    ds_read_b64_tr_b16 v[26:27], v3 offset:44032
    s_waitcnt lgkmcnt(6)
    v_mfma_f32_32x32x16_bf16 v[80:95], a[64:67], a[224:227], v[80:95]
    ds_read_b64_tr_b16 v[28:29], v3 offset:43520
    ds_read_b64_tr_b16 v[30:31], v3 offset:44544
    v_mfma_f32_32x32x16_bf16 v[96:111], a[68:71], a[224:227], v[96:111]
    ds_read_b64_tr_b16 a[64:65], v3 offset:45056
    ds_read_b64_tr_b16 a[66:67], v3 offset:46080
    v_mfma_f32_32x32x16_bf16 v[80:95], a[72:75], a[228:231], v[80:95]
    ds_read_b64_tr_b16 a[68:69], v3 offset:45568
    ds_read_b64_tr_b16 a[70:71], v3 offset:46592
    v_mfma_f32_32x32x16_bf16 v[96:111], a[76:79], a[228:231], v[96:111]
    ds_read_b64_tr_b16 a[72:73], v3 offset:47104
    ds_read_b64_tr_b16 a[74:75], v3 offset:48128
    s_waitcnt lgkmcnt(6)
    v_mfma_f32_32x32x16_bf16 v[80:95], v[16:19], a[240:243], v[80:95]
    ds_read_b64_tr_b16 a[76:77], v3 offset:47616
    ds_read_b64_tr_b16 a[78:79], v3 offset:48640
    v_mfma_f32_32x32x16_bf16 v[96:111], v[20:23], a[240:243], v[96:111]
    ds_read_b64_tr_b16 v[16:17], v3 offset:16384
    ds_read_b64_tr_b16 v[18:19], v3 offset:17408
    v_mfma_f32_32x32x16_bf16 v[80:95], v[24:27], a[244:247], v[80:95]
    ds_read_b64_tr_b16 v[20:21], v3 offset:16896
    ds_read_b64_tr_b16 v[22:23], v3 offset:17920
    v_mfma_f32_32x32x16_bf16 v[96:111], v[28:31], a[244:247], v[96:111]
    ds_read_b64_tr_b16 v[24:25], v3 offset:18432
    ds_read_b64_tr_b16 v[26:27], v3 offset:19456
    s_waitcnt lgkmcnt(6)
    v_mfma_f32_32x32x16_bf16 v[80:95], a[64:67], a[248:251], v[80:95]
    ds_read_b64_tr_b16 v[28:29], v3 offset:18944
    ds_read_b64_tr_b16 v[30:31], v3 offset:19968
    v_mfma_f32_32x32x16_bf16 v[96:111], a[68:71], a[248:251], v[96:111]
    ds_read_b64_tr_b16 a[64:65], v3 offset:20480
    ds_read_b64_tr_b16 a[66:67], v3 offset:21504
    v_mfma_f32_32x32x16_bf16 v[80:95], a[72:75], a[252:255], v[80:95]
    ds_read_b64_tr_b16 a[68:69], v3 offset:20992
    ds_read_b64_tr_b16 a[70:71], v3 offset:22016
    v_mfma_f32_32x32x16_bf16 v[96:111], a[76:79], a[252:255], v[96:111]
    ds_read_b64_tr_b16 a[72:73], v3 offset:22528
    ds_read_b64_tr_b16 a[74:75], v3 offset:23552
    s_waitcnt vmcnt(28)
    s_barrier
    s_waitcnt lgkmcnt(6)
    v_mfma_f32_32x32x16_bf16 v[112:127], v[16:19], a[152:155], v[112:127]
    ds_read_b64_tr_b16 a[76:77], v3 offset:23040
    ds_read_b64_tr_b16 a[78:79], v3 offset:24064
    v_mfma_f32_32x32x16_bf16 v[128:143], v[20:23], a[152:155], v[128:143]
    ds_read_b64_tr_b16 v[16:17], v3 offset:24576
    ds_read_b64_tr_b16 v[18:19], v3 offset:25600
    s_add_u32 m0, s27, 0
    s_add_u32 s29, s25, 0
    buffer_load_dwordx4 v4, s[12:15], s29 offen offset:0 nt lds
    v_mfma_f32_32x32x16_bf16 v[112:127], v[24:27], a[156:159], v[112:127]
    ds_read_b64_tr_b16 v[20:21], v3 offset:25088
    ds_read_b64_tr_b16 v[22:23], v3 offset:26112
    v_mul_f32 v80, v80, v14
    v_mul_f32 v81, v81, v14
    v_cvt_pk_bf16_f32 v32, v80, v81
    v_mul_f32 v82, v82, v14
    v_mfma_f32_32x32x16_bf16 v[128:143], v[28:31], a[156:159], v[128:143]
    ds_read_b64_tr_b16 v[24:25], v3 offset:26624
    ds_read_b64_tr_b16 v[26:27], v3 offset:27648
    v_mul_f32 v83, v83, v14
    v_cvt_pk_bf16_f32 v33, v82, v83
    v_mul_f32 v84, v84, v14
    s_waitcnt lgkmcnt(6)
    v_mfma_f32_32x32x16_bf16 v[112:127], a[64:67], a[168:171], v[112:127]
    ds_read_b64_tr_b16 v[28:29], v3 offset:27136
    ds_read_b64_tr_b16 v[30:31], v3 offset:28160
    s_add_u32 m0, s27, 3968
    s_add_u32 s29, s25, 0
    buffer_load_dwordx4 v4, s[12:15], s29 offen offset:128 nt lds
    v_mfma_f32_32x32x16_bf16 v[128:143], a[68:71], a[168:171], v[128:143]
    ds_read_b64_tr_b16 a[64:65], v3 offset:28672
    ds_read_b64_tr_b16 a[66:67], v3 offset:29696
    v_mul_f32 v85, v85, v14
    v_cvt_pk_bf16_f32 v34, v84, v85
    v_mul_f32 v86, v86, v14
    v_mul_f32 v87, v87, v14
    v_cvt_pk_bf16_f32 v35, v86, v87
    v_mfma_f32_32x32x16_bf16 v[112:127], a[72:75], a[172:175], v[112:127]
    ds_read_b64_tr_b16 a[68:69], v3 offset:29184
    ds_read_b64_tr_b16 a[70:71], v3 offset:30208
    ds_write_b128 v9, v[32:35]
    v_mfma_f32_32x32x16_bf16 v[128:143], a[76:79], a[172:175], v[128:143]
    ds_read_b64_tr_b16 a[72:73], v3 offset:30720
    ds_read_b64_tr_b16 a[74:75], v3 offset:31744
    s_add_u32 m0, s27, 7936
    s_add_u32 s29, s25, 0
    buffer_load_dwordx4 v4, s[12:15], s29 offen offset:256 nt lds
    s_waitcnt lgkmcnt(7)
    v_mfma_f32_32x32x16_bf16 v[112:127], v[16:19], a[184:187], v[112:127]
    ds_read_b64_tr_b16 a[76:77], v3 offset:31232
    ds_read_b64_tr_b16 a[78:79], v3 offset:32256
    v_mul_f32 v88, v88, v14
    v_mul_f32 v89, v89, v14
    v_cvt_pk_bf16_f32 v36, v88, v89
    v_mul_f32 v90, v90, v14
    v_mfma_f32_32x32x16_bf16 v[128:143], v[20:23], a[184:187], v[128:143]
    ds_read_b64_tr_b16 v[16:17], v3 offset:32768
    ds_read_b64_tr_b16 v[18:19], v3 offset:33792
    v_mul_f32 v91, v91, v14
    v_cvt_pk_bf16_f32 v37, v90, v91
    v_mul_f32 v92, v92, v14
    v_mul_f32 v93, v93, v14
    v_mfma_f32_32x32x16_bf16 v[112:127], v[24:27], a[188:191], v[112:127]
    ds_read_b64_tr_b16 v[20:21], v3 offset:33280
    ds_read_b64_tr_b16 v[22:23], v3 offset:34304
    s_add_u32 m0, s27, 11904
    s_add_u32 s29, s25, 0
    buffer_load_dwordx4 v4, s[12:15], s29 offen offset:384 nt lds
    v_mfma_f32_32x32x16_bf16 v[128:143], v[28:31], a[188:191], v[128:143]
    ds_read_b64_tr_b16 v[24:25], v3 offset:34816
    ds_read_b64_tr_b16 v[26:27], v3 offset:35840
    v_cvt_pk_bf16_f32 v38, v92, v93
    v_mul_f32 v94, v94, v14
    v_mul_f32 v95, v95, v14
    v_cvt_pk_bf16_f32 v39, v94, v95
    s_waitcnt lgkmcnt(6)
    v_mfma_f32_32x32x16_bf16 v[112:127], a[64:67], a[200:203], v[112:127]
    ds_read_b64_tr_b16 v[28:29], v3 offset:35328
    ds_read_b64_tr_b16 v[30:31], v3 offset:36352
    v_xor_b32 v0, 32, v9
    ds_write_b128 v0, v[36:39]
    v_mfma_f32_32x32x16_bf16 v[128:143], a[68:71], a[200:203], v[128:143]
    ds_read_b64_tr_b16 a[64:65], v3 offset:36864
    ds_read_b64_tr_b16 a[66:67], v3 offset:37888
    v_mfma_f32_32x32x16_bf16 v[112:127], a[72:75], a[204:207], v[112:127]
    ds_read_b64_tr_b16 a[68:69], v3 offset:37376
    ds_read_b64_tr_b16 a[70:71], v3 offset:38400
    v_mul_f32 v96, v96, v14
    v_mul_f32 v97, v97, v14
    v_cvt_pk_bf16_f32 v32, v96, v97
    v_mul_f32 v98, v98, v14
    v_mfma_f32_32x32x16_bf16 v[128:143], a[76:79], a[204:207], v[128:143]
    ds_read_b64_tr_b16 a[72:73], v3 offset:38912
    ds_read_b64_tr_b16 a[74:75], v3 offset:39936
    v_mul_f32 v99, v99, v14
    v_cvt_pk_bf16_f32 v33, v98, v99
    v_mul_f32 v100, v100, v14
    s_waitcnt lgkmcnt(7)
    v_mfma_f32_32x32x16_bf16 v[48:63], v[16:19], v[208:211], v[48:63]
    ds_read_b64_tr_b16 a[76:77], v3 offset:39424
    ds_read_b64_tr_b16 a[78:79], v3 offset:40448
    v_mfma_f32_32x32x16_bf16 v[64:79], v[20:23], v[208:211], v[64:79]
    ds_read_b64_tr_b16 v[16:17], v3 offset:40960
    ds_read_b64_tr_b16 v[18:19], v3 offset:41984
    v_mul_f32 v101, v101, v14
    v_cvt_pk_bf16_f32 v34, v100, v101
    v_mul_f32 v102, v102, v14
    v_mul_f32 v103, v103, v14
    v_cvt_pk_bf16_f32 v35, v102, v103
    v_mfma_f32_32x32x16_bf16 v[48:63], v[24:27], v[212:215], v[48:63]
    ds_read_b64_tr_b16 v[20:21], v3 offset:41472
    ds_read_b64_tr_b16 v[22:23], v3 offset:42496
    v_xor_b32 v0, 64, v9
    ds_write_b128 v0, v[32:35]
    v_mfma_f32_32x32x16_bf16 v[64:79], v[28:31], v[212:215], v[64:79]
    ds_read_b64_tr_b16 v[24:25], v3 offset:43008
    ds_read_b64_tr_b16 v[26:27], v3 offset:44032
    s_waitcnt lgkmcnt(7)
    v_mfma_f32_32x32x16_bf16 v[48:63], a[64:67], v[216:219], v[48:63]
    ds_read_b64_tr_b16 v[28:29], v3 offset:43520
    ds_read_b64_tr_b16 v[30:31], v3 offset:44544
    v_mul_f32 v104, v104, v14
    v_mul_f32 v105, v105, v14
    v_cvt_pk_bf16_f32 v36, v104, v105
    v_mul_f32 v106, v106, v14
    v_mfma_f32_32x32x16_bf16 v[64:79], a[68:71], v[216:219], v[64:79]
    ds_read_b64_tr_b16 a[64:65], v3 offset:45056
    ds_read_b64_tr_b16 a[66:67], v3 offset:46080
    v_mul_f32 v107, v107, v14
    v_cvt_pk_bf16_f32 v37, v106, v107
    v_mul_f32 v108, v108, v14
    v_mul_f32 v109, v109, v14
    v_mfma_f32_32x32x16_bf16 v[48:63], a[72:75], v[220:223], v[48:63]
    ds_read_b64_tr_b16 a[68:69], v3 offset:45568
    ds_read_b64_tr_b16 a[70:71], v3 offset:46592
    v_mfma_f32_32x32x16_bf16 v[64:79], a[76:79], v[220:223], v[64:79]
    ds_read_b64_tr_b16 a[72:73], v3 offset:47104
    ds_read_b64_tr_b16 a[74:75], v3 offset:48128
    v_cvt_pk_bf16_f32 v38, v108, v109
    v_mul_f32 v110, v110, v14
    v_mul_f32 v111, v111, v14
    v_cvt_pk_bf16_f32 v39, v110, v111
    s_waitcnt lgkmcnt(6)
    v_mfma_f32_32x32x16_bf16 v[48:63], v[16:19], v[224:227], v[48:63]
    ds_read_b64_tr_b16 a[76:77], v3 offset:47616
    ds_read_b64_tr_b16 a[78:79], v3 offset:48640
    v_xor_b32 v0, 96, v9
    ds_write_b128 v0, v[36:39]
    v_mfma_f32_32x32x16_bf16 v[64:79], v[20:23], v[224:227], v[64:79]
    v_xor_b32 v3, 0xc000, v3
    ds_read_b64_tr_b16 v[16:17], v3 offset:0
    ds_read_b64_tr_b16 v[18:19], v3 offset:1024
    v_mfma_f32_32x32x16_bf16 v[48:63], v[24:27], v[228:231], v[48:63]
    ds_read_b64_tr_b16 v[20:21], v3 offset:512
    ds_read_b64_tr_b16 v[22:23], v3 offset:1536
    ds_read_b128 v[32:35], v10 offset:0
    ds_read_b128 v[36:39], v10 offset:1024
    v_mfma_f32_32x32x16_bf16 v[64:79], v[28:31], v[228:231], v[64:79]
    ds_read_b64_tr_b16 v[24:25], v3 offset:2048
    ds_read_b64_tr_b16 v[26:27], v3 offset:3072
    s_waitcnt lgkmcnt(3)
    s_add_u32 s30, s24, 33024
    buffer_store_dwordx4 v[32:35], v11, s[20:23], s30 offen sc1
    v_mfma_f32_32x32x16_bf16 v[48:63], a[64:67], v[240:243], v[48:63]
    ds_read_b64_tr_b16 v[28:29], v3 offset:2560
    ds_read_b64_tr_b16 v[30:31], v3 offset:3584
    v_mfma_f32_32x32x16_bf16 v[64:79], a[68:71], v[240:243], v[64:79]
    ds_read_b64_tr_b16 a[64:65], v3 offset:4096
    ds_read_b64_tr_b16 a[66:67], v3 offset:5120
    s_waitcnt lgkmcnt(6)
    s_add_u32 s30, s24, 37120
    buffer_store_dwordx4 v[36:39], v11, s[20:23], s30 offen sc1
    v_mfma_f32_32x32x16_bf16 v[48:63], a[72:75], v[244:247], v[48:63]
    ds_read_b64_tr_b16 a[68:69], v3 offset:4608
    ds_read_b64_tr_b16 a[70:71], v3 offset:5632
    ds_read_b128 v[32:35], v10 offset:2048
    ds_read_b128 v[36:39], v10 offset:3072
    v_mfma_f32_32x32x16_bf16 v[64:79], a[76:79], v[244:247], v[64:79]
    ds_read_b64_tr_b16 a[72:73], v3 offset:6144
    ds_read_b64_tr_b16 a[74:75], v3 offset:7168
    s_waitcnt lgkmcnt(8)
    v_mfma_f32_32x32x16_bf16 v[80:95], v[16:19], a[80:83], 0
    ds_read_b64_tr_b16 a[76:77], v3 offset:6656
    ds_read_b64_tr_b16 a[78:79], v3 offset:7680
    s_waitcnt lgkmcnt(5)
    s_add_u32 s30, s24, 41216
    buffer_store_dwordx4 v[32:35], v11, s[20:23], s30 offen sc1
    v_mfma_f32_32x32x16_bf16 v[96:111], v[20:23], a[80:83], 0
    ds_read_b64_tr_b16 v[16:17], v3 offset:8192
    ds_read_b64_tr_b16 v[18:19], v3 offset:9216
    s_waitcnt lgkmcnt(6)
    s_add_u32 s30, s24, 45312
    buffer_store_dwordx4 v[36:39], v11, s[20:23], s30 offen sc1
    v_mfma_f32_32x32x16_bf16 v[80:95], v[24:27], a[84:87], v[80:95]
    ds_read_b64_tr_b16 v[20:21], v3 offset:8704
    ds_read_b64_tr_b16 v[22:23], v3 offset:9728
    v_mfma_f32_32x32x16_bf16 v[96:111], v[28:31], a[84:87], v[96:111]
    ds_read_b64_tr_b16 v[24:25], v3 offset:10240
    ds_read_b64_tr_b16 v[26:27], v3 offset:11264
    v_mul_f32 v48, v48, v12
    v_mul_f32 v49, v49, v12
    v_cvt_pk_bf16_f32 v32, v48, v49
    v_mul_f32 v50, v50, v12
    v_mul_f32 v51, v51, v12
    s_waitcnt lgkmcnt(6)
    v_mfma_f32_32x32x16_bf16 v[80:95], a[64:67], a[96:99], v[80:95]
    ds_read_b64_tr_b16 v[28:29], v3 offset:10752
    ds_read_b64_tr_b16 v[30:31], v3 offset:11776
    v_cvt_pk_bf16_f32 v33, v50, v51
    v_mul_f32 v52, v52, v12
    v_mul_f32 v53, v53, v12
    v_cvt_pk_bf16_f32 v34, v52, v53
    v_mul_f32 v54, v54, v12
    v_mul_f32 v55, v55, v12
    v_mfma_f32_32x32x16_bf16 v[96:111], a[68:71], a[96:99], v[96:111]
    ds_read_b64_tr_b16 a[64:65], v3 offset:12288
    ds_read_b64_tr_b16 a[66:67], v3 offset:13312
    v_cvt_pk_bf16_f32 v35, v54, v55
    v_mfma_f32_32x32x16_bf16 v[80:95], a[72:75], a[100:103], v[80:95]
    ds_read_b64_tr_b16 a[68:69], v3 offset:12800
    ds_read_b64_tr_b16 a[70:71], v3 offset:13824
    ds_write_b128 v9, v[32:35]
    v_mfma_f32_32x32x16_bf16 v[96:111], a[76:79], a[100:103], v[96:111]
    ds_read_b64_tr_b16 a[72:73], v3 offset:14336
    ds_read_b64_tr_b16 a[74:75], v3 offset:15360
    v_mul_f32 v56, v56, v12
    v_mul_f32 v57, v57, v12
    v_cvt_pk_bf16_f32 v36, v56, v57
    v_mul_f32 v58, v58, v12
    s_waitcnt lgkmcnt(7)
    v_mfma_f32_32x32x16_bf16 v[80:95], v[16:19], a[112:115], v[80:95]
    ds_read_b64_tr_b16 a[76:77], v3 offset:14848
    ds_read_b64_tr_b16 a[78:79], v3 offset:15872
    v_mfma_f32_32x32x16_bf16 v[96:111], v[20:23], a[112:115], v[96:111]
    v_mul_f32 v59, v59, v12
    v_cvt_pk_bf16_f32 v37, v58, v59
    v_mul_f32 v60, v60, v12
    v_mul_f32 v61, v61, v12
    v_cvt_pk_bf16_f32 v38, v60, v61
    v_mul_f32 v62, v62, v12
    v_mul_f32 v63, v63, v12
    v_cvt_pk_bf16_f32 v39, v62, v63
    v_mfma_f32_32x32x16_bf16 v[80:95], v[24:27], a[116:119], v[80:95]
    v_xor_b32 v0, 32, v9
    ds_write_b128 v0, v[36:39]
    v_mfma_f32_32x32x16_bf16 v[96:111], v[28:31], a[116:119], v[96:111]
    s_waitcnt lgkmcnt(1)
    v_mfma_f32_32x32x16_bf16 v[80:95], a[64:67], a[128:131], v[80:95]
    v_xor_b32 v3, 0xc000, v3
    ds_read_b64_tr_b16 v[16:17], v3 offset:32768
    ds_read_b64_tr_b16 v[18:19], v3 offset:33792
    v_mul_f32 v64, v64, v12
    v_mul_f32 v65, v65, v12
    v_mfma_f32_32x32x16_bf16 v[96:111], a[68:71], a[128:131], v[96:111]
    ds_read_b64_tr_b16 v[20:21], v3 offset:33280
    ds_read_b64_tr_b16 v[22:23], v3 offset:34304
    v_cvt_pk_bf16_f32 v32, v64, v65
    v_mul_f32 v66, v66, v12
    v_mul_f32 v67, v67, v12
    v_cvt_pk_bf16_f32 v33, v66, v67
    v_mfma_f32_32x32x16_bf16 v[80:95], a[72:75], a[132:135], v[80:95]
    ds_read_b64_tr_b16 v[24:25], v3 offset:34816
    ds_read_b64_tr_b16 v[26:27], v3 offset:35840
    v_mfma_f32_32x32x16_bf16 v[96:111], a[76:79], a[132:135], v[96:111]
    ds_read_b64_tr_b16 v[28:29], v3 offset:35328
    ds_read_b64_tr_b16 v[30:31], v3 offset:36352
    v_mul_f32 v68, v68, v12
    v_mul_f32 v69, v69, v12
    s_waitcnt vmcnt(11)
    s_barrier
    s_waitcnt lgkmcnt(4)
    v_mfma_f32_32x32x16_bf16 v[112:127], v[16:19], a[216:219], v[112:127]
    ds_read_b64_tr_b16 v[16:17], v3 offset:36864
    ds_read_b64_tr_b16 v[18:19], v3 offset:37888
    v_cvt_pk_bf16_f32 v34, v68, v69
    v_mul_f32 v70, v70, v12
    v_mul_f32 v71, v71, v12
    v_cvt_pk_bf16_f32 v35, v70, v71
    v_mfma_f32_32x32x16_bf16 v[128:143], v[20:23], a[216:219], v[128:143]
    ds_read_b64_tr_b16 v[20:21], v3 offset:37376
    ds_read_b64_tr_b16 v[22:23], v3 offset:38400
    s_add_u32 m0, s27, 16384
    s_add_u32 s29, s25, 256
    buffer_load_dwordx4 v6, s[8:11], s29 offen nt lds
    v_xor_b32 v6, 32, v6
    s_waitcnt lgkmcnt(4)
    v_mfma_f32_32x32x16_bf16 v[112:127], v[24:27], a[220:223], v[112:127]
    ds_read_b64_tr_b16 v[24:25], v3 offset:38912
    ds_read_b64_tr_b16 v[26:27], v3 offset:39936
    v_xor_b32 v0, 64, v9
    ds_write_b128 v0, v[32:35]
    v_mfma_f32_32x32x16_bf16 v[128:143], v[28:31], a[220:223], v[128:143]
    ds_read_b64_tr_b16 v[28:29], v3 offset:39424
    ds_read_b64_tr_b16 v[30:31], v3 offset:40448
    v_mul_f32 v72, v72, v12
    v_mul_f32 v73, v73, v12
    v_cvt_pk_bf16_f32 v36, v72, v73
    s_waitcnt lgkmcnt(5)
    v_mfma_f32_32x32x16_bf16 v[112:127], v[16:19], a[232:235], v[112:127]
    ds_read_b64_tr_b16 v[16:17], v3 offset:40960
    ds_read_b64_tr_b16 v[18:19], v3 offset:41984
    s_add_u32 m0, s27, 20480
    s_add_u32 s29, s25, 4352
    buffer_load_dwordx4 v6, s[8:11], s29 offen nt lds
    v_xor_b32 v6, 32, v6
    v_mfma_f32_32x32x16_bf16 v[128:143], v[20:23], a[232:235], v[128:143]
    ds_read_b64_tr_b16 v[20:21], v3 offset:41472
    ds_read_b64_tr_b16 v[22:23], v3 offset:42496
    ds_read_b128 a[64:67], v7 offset:32768
    v_mul_f32 v74, v74, v12
    v_mul_f32 v75, v75, v12
    s_waitcnt lgkmcnt(5)
    v_mfma_f32_32x32x16_bf16 v[112:127], v[24:27], a[236:239], v[112:127]
    ds_read_b64_tr_b16 v[24:25], v3 offset:43008
    ds_read_b64_tr_b16 v[26:27], v3 offset:44032
    ds_read_b128 a[68:71], v8 offset:32768
    ds_read_b128 a[72:75], v7 offset:33280
    ds_read_b128 a[76:79], v8 offset:33280
    v_cvt_pk_bf16_f32 v37, v74, v75
    v_mul_f32 v76, v76, v12
    v_mfma_f32_32x32x16_bf16 v[128:143], v[28:31], a[236:239], v[128:143]
    ds_read_b64_tr_b16 v[28:29], v3 offset:43520
    ds_read_b64_tr_b16 v[30:31], v3 offset:44544
    s_add_u32 m0, s27, 24576
    s_add_u32 s29, s25, 8448
    buffer_load_dwordx4 v6, s[8:11], s29 offen nt lds
    v_xor_b32 v6, 32, v6
    s_waitcnt lgkmcnt(8)
    v_mfma_f32_32x32x16_bf16 v[112:127], v[16:19], v[232:235], v[112:127]
    ds_read_b64_tr_b16 v[16:17], v3 offset:45056
    ds_read_b64_tr_b16 v[18:19], v3 offset:46080
    v_mul_f32 v77, v77, v12
    v_cvt_pk_bf16_f32 v38, v76, v77
    v_mul_f32 v78, v78, v12
    v_mul_f32 v79, v79, v12
    v_cvt_pk_bf16_f32 v39, v78, v79
    v_mfma_f32_32x32x16_bf16 v[128:143], v[20:23], v[232:235], v[128:143]
    ds_read_b64_tr_b16 v[20:21], v3 offset:45568
    ds_read_b64_tr_b16 v[22:23], v3 offset:46592
    v_xor_b32 v0, 96, v9
    ds_write_b128 v0, v[36:39]
    s_waitcnt lgkmcnt(5)
    v_mfma_f32_32x32x16_bf16 v[112:127], v[24:27], v[236:239], v[112:127]
    ds_read_b64_tr_b16 v[24:25], v3 offset:47104
    ds_read_b64_tr_b16 v[26:27], v3 offset:48128
    s_add_u32 m0, s27, 28672
    s_add_u32 s29, s25, 12544
    buffer_load_dwordx4 v6, s[8:11], s29 offen nt lds
    v_xor_b32 v6, 32, v6
    ds_read_b128 v[32:35], v10 offset:0
    v_mfma_f32_32x32x16_bf16 v[128:143], v[28:31], v[236:239], v[128:143]
    ds_read_b64_tr_b16 v[28:29], v3 offset:47616
    ds_read_b64_tr_b16 v[30:31], v3 offset:48640
    ds_read_b128 v[36:39], v10 offset:1024
    s_waitcnt lgkmcnt(7)
    v_mfma_f32_32x32x16_bf16 v[112:127], v[16:19], v[248:251], v[112:127]
    v_xor_b32 v3, 0xc000, v3
    ds_read_b64_tr_b16 v[16:17], v3 offset:0
    ds_read_b64_tr_b16 v[18:19], v3 offset:1024
    s_waitcnt lgkmcnt(5)
    s_add_u32 s30, s24, 256
    buffer_store_dwordx4 v[32:35], v11, s[20:23], s30 offen sc1
    v_mfma_f32_32x32x16_bf16 v[128:143], v[20:23], v[248:251], v[128:143]
    ds_read_b64_tr_b16 v[20:21], v3 offset:512
    ds_read_b64_tr_b16 v[22:23], v3 offset:1536
    s_add_u32 m0, s27, 131072
    s_add_u32 s29, s25, 33152
    buffer_load_dwordx4 v6, s[8:11], s29 offen nt lds
    v_xor_b32 v6, 32, v6
    s_waitcnt lgkmcnt(5)
    v_mfma_f32_32x32x16_bf16 v[112:127], v[24:27], v[252:255], v[112:127]
    ds_read_b64_tr_b16 v[24:25], v3 offset:2048
    ds_read_b64_tr_b16 v[26:27], v3 offset:3072
    s_waitcnt lgkmcnt(6)
    s_add_u32 s30, s24, 4352
    buffer_store_dwordx4 v[36:39], v11, s[20:23], s30 offen sc1
    v_mfma_f32_32x32x16_bf16 v[128:143], v[28:31], v[252:255], v[128:143]
    ds_read_b64_tr_b16 v[28:29], v3 offset:2560
    ds_read_b64_tr_b16 v[30:31], v3 offset:3584
    ds_read_b128 v[32:35], v10 offset:2048
    ds_read_b128 v[36:39], v10 offset:3072
    s_waitcnt lgkmcnt(6)
    v_mfma_f32_32x32x16_bf16 v[48:63], v[16:19], v[144:147], 0
    ds_read_b64_tr_b16 v[16:17], v3 offset:4096
    ds_read_b64_tr_b16 v[18:19], v3 offset:5120
    s_add_u32 m0, s27, 135168
    s_add_u32 s29, s25, 37248
    buffer_load_dwordx4 v6, s[8:11], s29 offen nt lds
    v_xor_b32 v6, 32, v6
    s_waitcnt lgkmcnt(3)
    s_add_u32 s30, s24, 8448
    buffer_store_dwordx4 v[32:35], v11, s[20:23], s30 offen sc1
    v_mfma_f32_32x32x16_bf16 v[64:79], v[20:23], v[144:147], 0
    ds_read_b64_tr_b16 v[20:21], v3 offset:4608
    ds_read_b64_tr_b16 v[22:23], v3 offset:5632
    s_waitcnt lgkmcnt(4)
    s_add_u32 s30, s24, 12544
    buffer_store_dwordx4 v[36:39], v11, s[20:23], s30 offen sc1
    v_mfma_f32_32x32x16_bf16 v[48:63], v[24:27], v[148:151], v[48:63]
    ds_read_b64_tr_b16 v[24:25], v3 offset:6144
    ds_read_b64_tr_b16 v[26:27], v3 offset:7168
    v_mul_f32 v112, v112, v13
    v_mul_f32 v113, v113, v13
    v_mfma_f32_32x32x16_bf16 v[64:79], v[28:31], v[148:151], v[64:79]
    ds_read_b64_tr_b16 v[28:29], v3 offset:6656
    ds_read_b64_tr_b16 v[30:31], v3 offset:7680
    s_add_u32 m0, s27, 139264
    s_add_u32 s29, s25, 41344
    buffer_load_dwordx4 v6, s[8:11], s29 offen nt lds
    v_xor_b32 v6, 32, v6
    s_waitcnt lgkmcnt(4)
    v_mfma_f32_32x32x16_bf16 v[48:63], v[16:19], v[152:155], v[48:63]
    ds_read_b64_tr_b16 v[16:17], v3 offset:8192
    ds_read_b64_tr_b16 v[18:19], v3 offset:9216
    v_cvt_pk_bf16_f32 v112, v112, v113
    v_accvgpr_write_b32 a112, v112
    v_mfma_f32_32x32x16_bf16 v[64:79], v[20:23], v[152:155], v[64:79]
    ds_read_b64_tr_b16 v[20:21], v3 offset:8704
    ds_read_b64_tr_b16 v[22:23], v3 offset:9728
    v_mul_f32 v114, v114, v13
    s_waitcnt lgkmcnt(4)
    v_mfma_f32_32x32x16_bf16 v[48:63], v[24:27], v[156:159], v[48:63]
    ds_read_b64_tr_b16 v[24:25], v3 offset:10240
    ds_read_b64_tr_b16 v[26:27], v3 offset:11264
    s_add_u32 m0, s27, 143360
    s_add_u32 s29, s25, 45440
    buffer_load_dwordx4 v6, s[8:11], s29 offen nt lds
    v_xor_b32 v6, 32, v6
    v_mfma_f32_32x32x16_bf16 v[64:79], v[28:31], v[156:159], v[64:79]
    ds_read_b64_tr_b16 v[28:29], v3 offset:10752
    ds_read_b64_tr_b16 v[30:31], v3 offset:11776
    v_mul_f32 v115, v115, v13
    v_cvt_pk_bf16_f32 v114, v114, v115
    s_waitcnt lgkmcnt(4)
    v_mfma_f32_32x32x16_bf16 v[48:63], v[16:19], v[160:163], v[48:63]
    ds_read_b64_tr_b16 v[16:17], v3 offset:12288
    ds_read_b64_tr_b16 v[18:19], v3 offset:13312
    v_accvgpr_write_b32 a113, v114
    v_mul_f32 v116, v116, v13
    v_mul_f32 v117, v117, v13
    v_mfma_f32_32x32x16_bf16 v[64:79], v[20:23], v[160:163], v[64:79]
    ds_read_b64_tr_b16 v[20:21], v3 offset:12800
    ds_read_b64_tr_b16 v[22:23], v3 offset:13824
    s_waitcnt lgkmcnt(4)
    v_mfma_f32_32x32x16_bf16 v[48:63], v[24:27], v[164:167], v[48:63]
    ds_read_b64_tr_b16 v[24:25], v3 offset:14336
    ds_read_b64_tr_b16 v[26:27], v3 offset:15360
    v_cvt_pk_bf16_f32 v116, v116, v117
    v_accvgpr_write_b32 a114, v116
    v_mul_f32 v118, v118, v13
    v_mfma_f32_32x32x16_bf16 v[64:79], v[28:31], v[164:167], v[64:79]
    ds_read_b64_tr_b16 v[28:29], v3 offset:14848
    ds_read_b64_tr_b16 v[30:31], v3 offset:15872
    v_mul_f32 v119, v119, v13
    v_cvt_pk_bf16_f32 v118, v118, v119
    s_waitcnt lgkmcnt(4)
    v_mfma_f32_32x32x16_bf16 v[48:63], v[16:19], v[168:171], v[48:63]
    ds_read_b64_tr_b16 v[16:17], v3 offset:16384
    ds_read_b64_tr_b16 v[18:19], v3 offset:17408
    v_mfma_f32_32x32x16_bf16 v[64:79], v[20:23], v[168:171], v[64:79]
    ds_read_b64_tr_b16 v[20:21], v3 offset:16896
    ds_read_b64_tr_b16 v[22:23], v3 offset:17920
    v_accvgpr_write_b32 a115, v118
    v_mul_f32 v120, v120, v13
    s_waitcnt lgkmcnt(4)
    v_mfma_f32_32x32x16_bf16 v[48:63], v[24:27], v[172:175], v[48:63]
    ds_read_b64_tr_b16 v[24:25], v3 offset:18432
    ds_read_b64_tr_b16 v[26:27], v3 offset:19456
    v_mul_f32 v121, v121, v13
    v_cvt_pk_bf16_f32 v120, v120, v121
    v_accvgpr_write_b32 a116, v120
    v_mfma_f32_32x32x16_bf16 v[64:79], v[28:31], v[172:175], v[64:79]
    ds_read_b64_tr_b16 v[28:29], v3 offset:18944
    ds_read_b64_tr_b16 v[30:31], v3 offset:19968
    s_waitcnt lgkmcnt(4)
    v_mfma_f32_32x32x16_bf16 v[80:95], v[16:19], a[144:147], v[80:95]
    ds_read_b64_tr_b16 v[16:17], v3 offset:20480
    ds_read_b64_tr_b16 v[18:19], v3 offset:21504
    v_mul_f32 v122, v122, v13
    v_mul_f32 v123, v123, v13
    v_cvt_pk_bf16_f32 v122, v122, v123
    v_mfma_f32_32x32x16_bf16 v[96:111], v[20:23], a[144:147], v[96:111]
    ds_read_b64_tr_b16 v[20:21], v3 offset:20992
    ds_read_b64_tr_b16 v[22:23], v3 offset:22016
    v_accvgpr_write_b32 a117, v122
    v_mul_f32 v124, v124, v13
    s_waitcnt lgkmcnt(4)
    v_mfma_f32_32x32x16_bf16 v[80:95], v[24:27], a[148:151], v[80:95]
    ds_read_b64_tr_b16 v[24:25], v3 offset:22528
    ds_read_b64_tr_b16 v[26:27], v3 offset:23552
    v_mfma_f32_32x32x16_bf16 v[96:111], v[28:31], a[148:151], v[96:111]
    ds_read_b64_tr_b16 v[28:29], v3 offset:23040
    ds_read_b64_tr_b16 v[30:31], v3 offset:24064
    v_mul_f32 v125, v125, v13
    v_cvt_pk_bf16_f32 v124, v124, v125
    s_waitcnt lgkmcnt(4)
    v_mfma_f32_32x32x16_bf16 v[80:95], v[16:19], a[160:163], v[80:95]
    ds_read_b64_tr_b16 v[16:17], v3 offset:24576
    ds_read_b64_tr_b16 v[18:19], v3 offset:25600
    v_accvgpr_write_b32 a118, v124
    v_mul_f32 v126, v126, v13
    v_mul_f32 v127, v127, v13
    v_mfma_f32_32x32x16_bf16 v[96:111], v[20:23], a[160:163], v[96:111]
    ds_read_b64_tr_b16 v[20:21], v3 offset:25088
    ds_read_b64_tr_b16 v[22:23], v3 offset:26112
    s_waitcnt lgkmcnt(4)
    v_mfma_f32_32x32x16_bf16 v[80:95], v[24:27], a[164:167], v[80:95]
    ds_read_b64_tr_b16 v[24:25], v3 offset:26624
    ds_read_b64_tr_b16 v[26:27], v3 offset:27648
    v_cvt_pk_bf16_f32 v126, v126, v127
    v_accvgpr_write_b32 a119, v126
    v_mul_f32 v128, v128, v13
    v_mfma_f32_32x32x16_bf16 v[96:111], v[28:31], a[164:167], v[96:111]
    ds_read_b64_tr_b16 v[28:29], v3 offset:27136
    ds_read_b64_tr_b16 v[30:31], v3 offset:28160
    v_mul_f32 v129, v129, v13
    v_cvt_pk_bf16_f32 v128, v128, v129
    s_waitcnt lgkmcnt(4)
    v_mfma_f32_32x32x16_bf16 v[80:95], v[16:19], a[176:179], v[80:95]
    ds_read_b64_tr_b16 v[16:17], v3 offset:28672
    ds_read_b64_tr_b16 v[18:19], v3 offset:29696
    v_mfma_f32_32x32x16_bf16 v[96:111], v[20:23], a[176:179], v[96:111]
    ds_read_b64_tr_b16 v[20:21], v3 offset:29184
    ds_read_b64_tr_b16 v[22:23], v3 offset:30208
    v_accvgpr_write_b32 a128, v128
    v_mul_f32 v130, v130, v13
    s_waitcnt lgkmcnt(4)
    v_mfma_f32_32x32x16_bf16 v[80:95], v[24:27], a[180:183], v[80:95]
    ds_read_b64_tr_b16 v[24:25], v3 offset:30720
    ds_read_b64_tr_b16 v[26:27], v3 offset:31744
    v_mul_f32 v131, v131, v13
    v_cvt_pk_bf16_f32 v130, v130, v131
    v_accvgpr_write_b32 a129, v130
    v_mfma_f32_32x32x16_bf16 v[96:111], v[28:31], a[180:183], v[96:111]
    ds_read_b64_tr_b16 v[28:29], v3 offset:31232
    ds_read_b64_tr_b16 v[30:31], v3 offset:32256
    s_waitcnt lgkmcnt(4)
    v_mfma_f32_32x32x16_bf16 v[80:95], v[16:19], a[192:195], v[80:95]
    ds_read_b64_tr_b16 v[16:17], v3 offset:32768
    ds_read_b64_tr_b16 v[18:19], v3 offset:33792
    v_mul_f32 v132, v132, v13
    v_mul_f32 v133, v133, v13
    v_cvt_pk_bf16_f32 v132, v132, v133
    v_mfma_f32_32x32x16_bf16 v[96:111], v[20:23], a[192:195], v[96:111]
    ds_read_b64_tr_b16 v[20:21], v3 offset:33280
    ds_read_b64_tr_b16 v[22:23], v3 offset:34304
    v_accvgpr_write_b32 a130, v132
    v_mul_f32 v134, v134, v13
    s_waitcnt lgkmcnt(4)
    v_mfma_f32_32x32x16_bf16 v[80:95], v[24:27], a[196:199], v[80:95]
    ds_read_b64_tr_b16 v[24:25], v3 offset:34816
    ds_read_b64_tr_b16 v[26:27], v3 offset:35840
    v_mfma_f32_32x32x16_bf16 v[96:111], v[28:31], a[196:199], v[96:111]
    ds_read_b64_tr_b16 v[28:29], v3 offset:35328
    ds_read_b64_tr_b16 v[30:31], v3 offset:36352
    v_mul_f32 v135, v135, v13
    s_barrier
    s_waitcnt lgkmcnt(4)
    v_mfma_f32_32x32x16_bf16 v[80:95], v[16:19], a[208:211], v[80:95]
    ds_read_b64_tr_b16 v[16:17], v3 offset:36864
    ds_read_b64_tr_b16 v[18:19], v3 offset:37888
    v_cvt_pk_bf16_f32 v134, v134, v135
    v_accvgpr_write_b32 a131, v134
    v_mul_f32 v136, v136, v13
    v_mfma_f32_32x32x16_bf16 v[96:111], v[20:23], a[208:211], v[96:111]
    ds_read_b64_tr_b16 v[20:21], v3 offset:37376
    ds_read_b64_tr_b16 v[22:23], v3 offset:38400
    s_add_u32 m0, s27, 32768
    s_add_u32 s29, s25, 384
    buffer_load_dwordx4 v6, s[8:11], s29 offen nt lds
    v_xor_b32 v6, 32, v6
    s_waitcnt lgkmcnt(4)
    v_mfma_f32_32x32x16_bf16 v[80:95], v[24:27], a[212:215], v[80:95]
    ds_read_b64_tr_b16 v[24:25], v3 offset:38912
    ds_read_b64_tr_b16 v[26:27], v3 offset:39936
    v_mul_f32 v137, v137, v13
    v_cvt_pk_bf16_f32 v136, v136, v137
    v_accvgpr_write_b32 a132, v136
    v_mfma_f32_32x32x16_bf16 v[96:111], v[28:31], a[212:215], v[96:111]
    ds_read_b64_tr_b16 v[28:29], v3 offset:39424
    ds_read_b64_tr_b16 v[30:31], v3 offset:40448
    v_mul_f32 v138, v138, v13
    v_mul_f32 v139, v139, v13
    s_waitcnt lgkmcnt(4)
    v_mfma_f32_32x32x16_bf16 v[80:95], v[16:19], a[224:227], v[80:95]
    ds_read_b64_tr_b16 v[16:17], v3 offset:40960
    ds_read_b64_tr_b16 v[18:19], v3 offset:41984
    s_add_u32 m0, s27, 36864
    s_add_u32 s29, s25, 4480
    buffer_load_dwordx4 v6, s[8:11], s29 offen nt lds
    v_xor_b32 v6, 32, v6
    v_mfma_f32_32x32x16_bf16 v[96:111], v[20:23], a[224:227], v[96:111]
    ds_read_b64_tr_b16 v[20:21], v3 offset:41472
    ds_read_b64_tr_b16 v[22:23], v3 offset:42496
    v_cvt_pk_bf16_f32 v138, v138, v139
    v_accvgpr_write_b32 a133, v138
    s_waitcnt lgkmcnt(4)
    v_mfma_f32_32x32x16_bf16 v[80:95], v[24:27], a[228:231], v[80:95]
    ds_read_b64_tr_b16 v[24:25], v3 offset:43008
    ds_read_b64_tr_b16 v[26:27], v3 offset:44032
    v_mul_f32 v140, v140, v13
    v_mul_f32 v141, v141, v13
    v_cvt_pk_bf16_f32 v140, v140, v141
    v_mfma_f32_32x32x16_bf16 v[96:111], v[28:31], a[228:231], v[96:111]
    ds_read_b64_tr_b16 v[28:29], v3 offset:43520
    ds_read_b64_tr_b16 v[30:31], v3 offset:44544
    s_add_u32 m0, s27, 40960
    s_add_u32 s29, s25, 8576
    buffer_load_dwordx4 v6, s[8:11], s29 offen nt lds
    v_xor_b32 v6, 32, v6
    s_waitcnt lgkmcnt(4)
    v_mfma_f32_32x32x16_bf16 v[80:95], v[16:19], a[240:243], v[80:95]
    ds_read_b64_tr_b16 v[16:17], v3 offset:45056
    ds_read_b64_tr_b16 v[18:19], v3 offset:46080
    v_accvgpr_write_b32 a134, v140
    v_mul_f32 v142, v142, v13
    v_mul_f32 v143, v143, v13
    v_mfma_f32_32x32x16_bf16 v[96:111], v[20:23], a[240:243], v[96:111]
    ds_read_b64_tr_b16 v[20:21], v3 offset:45568
    ds_read_b64_tr_b16 v[22:23], v3 offset:46592
    v_cvt_pk_bf16_f32 v142, v142, v143
    v_accvgpr_write_b32 a135, v142
    s_waitcnt lgkmcnt(4)
    v_mfma_f32_32x32x16_bf16 v[80:95], v[24:27], a[244:247], v[80:95]
    ds_read_b64_tr_b16 v[24:25], v3 offset:47104
    ds_read_b64_tr_b16 v[26:27], v3 offset:48128
    s_add_u32 m0, s27, 45056
    s_add_u32 s29, s25, 12672
    buffer_load_dwordx4 v6, s[8:11], s29 offen nt lds
    v_xor_b32 v6, 32, v6
    v_mfma_f32_32x32x16_bf16 v[96:111], v[28:31], a[244:247], v[96:111]
    ds_read_b64_tr_b16 v[28:29], v3 offset:47616
    ds_read_b64_tr_b16 v[30:31], v3 offset:48640
    s_waitcnt lgkmcnt(4)
    v_mfma_f32_32x32x16_bf16 v[80:95], v[16:19], a[248:251], v[80:95]
    ds_read_b64_tr_b16 v[16:17], v3 offset:0
    ds_read_b64_tr_b16 v[18:19], v3 offset:1024
    v_mfma_f32_32x32x16_bf16 v[96:111], v[20:23], a[248:251], v[96:111]
    ds_read_b64_tr_b16 v[20:21], v3 offset:512
    ds_read_b64_tr_b16 v[22:23], v3 offset:1536
    s_waitcnt lgkmcnt(4)
    v_mfma_f32_32x32x16_bf16 v[80:95], v[24:27], a[252:255], v[80:95]
    ds_read_b64_tr_b16 v[24:25], v3 offset:2048
    ds_read_b64_tr_b16 v[26:27], v3 offset:3072
    v_mfma_f32_32x32x16_bf16 v[96:111], v[28:31], a[252:255], v[96:111]
    ds_read_b64_tr_b16 v[28:29], v3 offset:2560
    ds_read_b64_tr_b16 v[30:31], v3 offset:3584
    s_waitcnt lgkmcnt(4)
    v_mfma_f32_32x32x16_bf16 v[112:127], v[16:19], a[88:91], 0
    ds_read_b64_tr_b16 v[16:17], v3 offset:4096
    ds_read_b64_tr_b16 v[18:19], v3 offset:5120
    v_mfma_f32_32x32x16_bf16 v[128:143], v[20:23], a[88:91], 0
    ds_read_b64_tr_b16 v[20:21], v3 offset:4608
    ds_read_b64_tr_b16 v[22:23], v3 offset:5632
    s_waitcnt lgkmcnt(4)
    v_mfma_f32_32x32x16_bf16 v[112:127], v[24:27], a[92:95], v[112:127]
    ds_read_b64_tr_b16 v[24:25], v3 offset:6144
    ds_read_b64_tr_b16 v[26:27], v3 offset:7168
    v_mul_f32 v80, v80, v14
    v_mul_f32 v81, v81, v14
    v_cvt_pk_bf16_f32 v80, v80, v81
    v_accvgpr_write_b32 a176, v80
    v_mfma_f32_32x32x16_bf16 v[128:143], v[28:31], a[92:95], v[128:143]
    ds_read_b64_tr_b16 v[28:29], v3 offset:6656
    ds_read_b64_tr_b16 v[30:31], v3 offset:7680
    s_waitcnt lgkmcnt(4)
    v_mfma_f32_32x32x16_bf16 v[112:127], v[16:19], a[104:107], v[112:127]
    ds_read_b64_tr_b16 v[16:17], v3 offset:8192
    ds_read_b64_tr_b16 v[18:19], v3 offset:9216
    v_mul_f32 v82, v82, v14
    v_mul_f32 v83, v83, v14
    v_cvt_pk_bf16_f32 v82, v82, v83
    v_accvgpr_write_b32 a177, v82
    v_mfma_f32_32x32x16_bf16 v[128:143], v[20:23], a[104:107], v[128:143]
    ds_read_b64_tr_b16 v[20:21], v3 offset:8704
    ds_read_b64_tr_b16 v[22:23], v3 offset:9728
    v_mul_f32 v84, v84, v14
    v_mul_f32 v85, v85, v14
    v_cvt_pk_bf16_f32 v84, v84, v85
    s_waitcnt lgkmcnt(4)
    v_mfma_f32_32x32x16_bf16 v[112:127], v[24:27], a[108:111], v[112:127]
    ds_read_b64_tr_b16 v[24:25], v3 offset:10240
    ds_read_b64_tr_b16 v[26:27], v3 offset:11264
    v_mfma_f32_32x32x16_bf16 v[128:143], v[28:31], a[108:111], v[128:143]
    ds_read_b64_tr_b16 v[28:29], v3 offset:10752
    ds_read_b64_tr_b16 v[30:31], v3 offset:11776
    v_accvgpr_write_b32 a178, v84
    v_mul_f32 v86, v86, v14
    v_mul_f32 v87, v87, v14
    s_waitcnt lgkmcnt(4)
    v_mfma_f32_32x32x16_bf16 v[112:127], v[16:19], a[120:123], v[112:127]
    ds_read_b64_tr_b16 v[16:17], v3 offset:12288
    ds_read_b64_tr_b16 v[18:19], v3 offset:13312
    v_cvt_pk_bf16_f32 v86, v86, v87
    v_accvgpr_write_b32 a179, v86
    v_mul_f32 v88, v88, v14
    v_mul_f32 v89, v89, v14
    v_mfma_f32_32x32x16_bf16 v[128:143], v[20:23], a[120:123], v[128:143]
    ds_read_b64_tr_b16 v[20:21], v3 offset:12800
    ds_read_b64_tr_b16 v[22:23], v3 offset:13824
    s_waitcnt lgkmcnt(4)
    v_mfma_f32_32x32x16_bf16 v[112:127], v[24:27], a[124:127], v[112:127]
    ds_read_b64_tr_b16 v[24:25], v3 offset:14336
    ds_read_b64_tr_b16 v[26:27], v3 offset:15360
    v_cvt_pk_bf16_f32 v88, v88, v89
    v_accvgpr_write_b32 a180, v88
    v_mul_f32 v90, v90, v14
    v_mul_f32 v91, v91, v14
    v_mfma_f32_32x32x16_bf16 v[128:143], v[28:31], a[124:127], v[128:143]
    ds_read_b64_tr_b16 v[28:29], v3 offset:14848
    ds_read_b64_tr_b16 v[30:31], v3 offset:15872
    v_cvt_pk_bf16_f32 v90, v90, v91
    v_accvgpr_write_b32 a181, v90
    v_mul_f32 v92, v92, v14
    s_waitcnt lgkmcnt(4)
    v_mfma_f32_32x32x16_bf16 v[112:127], v[16:19], a[136:139], v[112:127]
    ds_read_b64_tr_b16 v[16:17], v3 offset:16384
    ds_read_b64_tr_b16 v[18:19], v3 offset:17408
    v_mfma_f32_32x32x16_bf16 v[128:143], v[20:23], a[136:139], v[128:143]
    ds_read_b64_tr_b16 v[20:21], v3 offset:16896
    ds_read_b64_tr_b16 v[22:23], v3 offset:17920
    v_mul_f32 v93, v93, v14
    v_cvt_pk_bf16_f32 v92, v92, v93
    v_accvgpr_write_b32 a182, v92
    s_waitcnt lgkmcnt(4)
    v_mfma_f32_32x32x16_bf16 v[112:127], v[24:27], a[140:143], v[112:127]
    ds_read_b64_tr_b16 v[24:25], v3 offset:18432
    ds_read_b64_tr_b16 v[26:27], v3 offset:19456
    v_mul_f32 v94, v94, v14
    v_mul_f32 v95, v95, v14
    v_cvt_pk_bf16_f32 v94, v94, v95
    v_accvgpr_write_b32 a183, v94
    v_mfma_f32_32x32x16_bf16 v[128:143], v[28:31], a[140:143], v[128:143]
    ds_read_b64_tr_b16 v[28:29], v3 offset:18944
    ds_read_b64_tr_b16 v[30:31], v3 offset:19968
    s_waitcnt lgkmcnt(4)
    v_mfma_f32_32x32x16_bf16 v[48:63], v[16:19], v[176:179], v[48:63]
    ds_read_b64_tr_b16 v[16:17], v3 offset:20480
    ds_read_b64_tr_b16 v[18:19], v3 offset:21504
    v_mul_f32 v96, v96, v14
    v_mul_f32 v97, v97, v14
    v_cvt_pk_bf16_f32 v96, v96, v97
    v_accvgpr_write_b32 a192, v96
    v_mfma_f32_32x32x16_bf16 v[64:79], v[20:23], v[176:179], v[64:79]
    ds_read_b64_tr_b16 v[20:21], v3 offset:20992
    ds_read_b64_tr_b16 v[22:23], v3 offset:22016
    v_mul_f32 v98, v98, v14
    v_mul_f32 v99, v99, v14
    v_cvt_pk_bf16_f32 v98, v98, v99
    s_waitcnt lgkmcnt(4)
    v_mfma_f32_32x32x16_bf16 v[48:63], v[24:27], v[180:183], v[48:63]
    ds_read_b64_tr_b16 v[24:25], v3 offset:22528
    ds_read_b64_tr_b16 v[26:27], v3 offset:23552
    v_mfma_f32_32x32x16_bf16 v[64:79], v[28:31], v[180:183], v[64:79]
    ds_read_b64_tr_b16 v[28:29], v3 offset:23040
    ds_read_b64_tr_b16 v[30:31], v3 offset:24064
    v_accvgpr_write_b32 a193, v98
    v_mul_f32 v100, v100, v14
    v_mul_f32 v101, v101, v14
    s_waitcnt lgkmcnt(4)
    v_mfma_f32_32x32x16_bf16 v[48:63], v[16:19], v[184:187], v[48:63]
    ds_read_b64_tr_b16 v[16:17], v3 offset:24576
    ds_read_b64_tr_b16 v[18:19], v3 offset:25600
    v_cvt_pk_bf16_f32 v100, v100, v101
    v_accvgpr_write_b32 a194, v100
    v_mul_f32 v102, v102, v14
    v_mul_f32 v103, v103, v14
    v_mfma_f32_32x32x16_bf16 v[64:79], v[20:23], v[184:187], v[64:79]
    ds_read_b64_tr_b16 v[20:21], v3 offset:25088
    ds_read_b64_tr_b16 v[22:23], v3 offset:26112
    s_waitcnt lgkmcnt(4)
    v_mfma_f32_32x32x16_bf16 v[48:63], v[24:27], v[188:191], v[48:63]
    ds_read_b64_tr_b16 v[24:25], v3 offset:26624
    ds_read_b64_tr_b16 v[26:27], v3 offset:27648
    v_cvt_pk_bf16_f32 v102, v102, v103
    v_accvgpr_write_b32 a195, v102
    v_mul_f32 v104, v104, v14
    v_mul_f32 v105, v105, v14
    v_cvt_pk_bf16_f32 v104, v104, v105
    v_mfma_f32_32x32x16_bf16 v[64:79], v[28:31], v[188:191], v[64:79]
    ds_read_b64_tr_b16 v[28:29], v3 offset:27136
    ds_read_b64_tr_b16 v[30:31], v3 offset:28160
    v_accvgpr_write_b32 a196, v104
    v_mul_f32 v106, v106, v14
    v_mul_f32 v107, v107, v14
    v_cvt_pk_bf16_f32 v106, v106, v107
    s_waitcnt lgkmcnt(4)
    v_mfma_f32_32x32x16_bf16 v[48:63], v[16:19], v[192:195], v[48:63]
    ds_read_b64_tr_b16 v[16:17], v3 offset:28672
    ds_read_b64_tr_b16 v[18:19], v3 offset:29696
    v_mfma_f32_32x32x16_bf16 v[64:79], v[20:23], v[192:195], v[64:79]
    ds_read_b64_tr_b16 v[20:21], v3 offset:29184
    ds_read_b64_tr_b16 v[22:23], v3 offset:30208
    v_accvgpr_write_b32 a197, v106
    v_mul_f32 v108, v108, v14
    v_mul_f32 v109, v109, v14
    v_cvt_pk_bf16_f32 v108, v108, v109
    s_waitcnt lgkmcnt(4)
    v_mfma_f32_32x32x16_bf16 v[48:63], v[24:27], v[196:199], v[48:63]
    ds_read_b64_tr_b16 v[24:25], v3 offset:30720
    ds_read_b64_tr_b16 v[26:27], v3 offset:31744
    v_accvgpr_write_b32 a198, v108
    v_mul_f32 v110, v110, v14
    v_mul_f32 v111, v111, v14
    v_cvt_pk_bf16_f32 v110, v110, v111
    v_accvgpr_write_b32 a199, v110
    v_mfma_f32_32x32x16_bf16 v[64:79], v[28:31], v[196:199], v[64:79]
    ds_read_b64_tr_b16 v[28:29], v3 offset:31232
    ds_read_b64_tr_b16 v[30:31], v3 offset:32256
    s_waitcnt lgkmcnt(4)
    v_mfma_f32_32x32x16_bf16 v[48:63], v[16:19], v[200:203], v[48:63]
    ds_read_b64_tr_b16 v[16:17], v3 offset:32768
    ds_read_b64_tr_b16 v[18:19], v3 offset:33792
    s_waitcnt vmcnt(12)
    v_subrev_u32 v15, 98304, v7
    ds_read_b128 v[80:83], v15 offset:16384
    v_mfma_f32_32x32x16_bf16 v[64:79], v[20:23], v[200:203], v[64:79]
    ds_read_b64_tr_b16 v[20:21], v3 offset:33280
    ds_read_b64_tr_b16 v[22:23], v3 offset:34304
    ds_read_b128 v[88:91], v15 offset:16896
    v_xor_b32 v15, 32, v15
    ds_read_b128 v[84:87], v15 offset:16384
    s_waitcnt lgkmcnt(7)
    v_mfma_f32_32x32x16_bf16 v[48:63], v[24:27], v[204:207], v[48:63]
    ds_read_b64_tr_b16 v[24:25], v3 offset:34816
    ds_read_b64_tr_b16 v[26:27], v3 offset:35840
    v_mfma_f32_32x32x16_bf16 v[64:79], v[28:31], v[204:207], v[64:79]
    ds_read_b64_tr_b16 v[28:29], v3 offset:35328
    ds_read_b64_tr_b16 v[30:31], v3 offset:36352
    ds_read_b128 v[92:95], v15 offset:16896
    s_barrier
    s_waitcnt lgkmcnt(7)
    v_mfma_f32_32x32x16_bf16 v[48:63], v[16:19], v[208:211], v[48:63]
    ds_read_b64_tr_b16 v[16:17], v3 offset:36864
    ds_read_b64_tr_b16 v[18:19], v3 offset:37888
    v_mfma_f32_32x32x16_bf16 v[64:79], v[20:23], v[208:211], v[64:79]
    ds_read_b64_tr_b16 v[20:21], v3 offset:37376
    ds_read_b64_tr_b16 v[22:23], v3 offset:38400
    s_add_u32 m0, s27, 49152
    s_add_u32 s29, s25, 16640
    buffer_load_dwordx4 v6, s[8:11], s29 offen nt lds
    v_xor_b32 v6, 32, v6
    s_waitcnt lgkmcnt(5)
    v_mfma_f32_32x32x16_bf16 v[48:63], v[24:27], v[212:215], v[48:63]
    ds_read_b64_tr_b16 v[24:25], v3 offset:38912
    ds_read_b64_tr_b16 v[26:27], v3 offset:39936
    s_waitcnt lgkmcnt(6)
    s_waitcnt vmcnt(1)
    v_subrev_u32 v15, 98304, v7
    ds_read_b128 v[96:99], v15 offset:32768
    ds_read_b128 v[104:107], v15 offset:33280
    v_mfma_f32_32x32x16_bf16 v[64:79], v[28:31], v[212:215], v[64:79]
    ds_read_b64_tr_b16 v[28:29], v3 offset:39424
    ds_read_b64_tr_b16 v[30:31], v3 offset:40448
    v_xor_b32 v15, 32, v15
    ds_read_b128 v[100:103], v15 offset:32768
    ds_read_b128 v[108:111], v15 offset:33280
    s_waitcnt lgkmcnt(8)
    v_mfma_f32_32x32x16_bf16 v[48:63], v[16:19], v[216:219], v[48:63]
    ds_read_b64_tr_b16 v[16:17], v3 offset:40960
    ds_read_b64_tr_b16 v[18:19], v3 offset:41984
    s_add_u32 m0, s27, 53248
    s_add_u32 s29, s25, 20736
    buffer_load_dwordx4 v6, s[8:11], s29 offen nt lds
    v_xor_b32 v6, 32, v6
    v_mfma_f32_32x32x16_bf16 v[64:79], v[20:23], v[216:219], v[64:79]
    ds_read_b64_tr_b16 v[20:21], v3 offset:41472
    ds_read_b64_tr_b16 v[22:23], v3 offset:42496
    s_waitcnt lgkmcnt(6)
    v_mfma_f32_32x32x16_bf16 v[48:63], v[24:27], v[220:223], v[48:63]
    ds_read_b64_tr_b16 v[24:25], v3 offset:43008
    ds_read_b64_tr_b16 v[26:27], v3 offset:44032
    v_mfma_f32_32x32x16_bf16 v[64:79], v[28:31], v[220:223], v[64:79]
    ds_read_b64_tr_b16 v[28:29], v3 offset:43520
    ds_read_b64_tr_b16 v[30:31], v3 offset:44544
    s_add_u32 m0, s27, 57344
    s_add_u32 s29, s25, 24832
    buffer_load_dwordx4 v6, s[8:11], s29 offen nt lds
    v_xor_b32 v6, 32, v6
    s_waitcnt lgkmcnt(8)
    s_waitcnt lgkmcnt(4)
    v_mfma_f32_32x32x16_bf16 v[48:63], v[16:19], v[224:227], v[48:63]
    ds_read_b64_tr_b16 v[16:17], v3 offset:45056
    ds_read_b64_tr_b16 v[18:19], v3 offset:46080
    v_mfma_f32_32x32x16_bf16 v[64:79], v[20:23], v[224:227], v[64:79]
    ds_read_b64_tr_b16 v[20:21], v3 offset:45568
    ds_read_b64_tr_b16 v[22:23], v3 offset:46592
    s_waitcnt lgkmcnt(4)
    v_mfma_f32_32x32x16_bf16 v[48:63], v[24:27], v[228:231], v[48:63]
    ds_read_b64_tr_b16 v[24:25], v3 offset:47104
    ds_read_b64_tr_b16 v[26:27], v3 offset:48128
    s_add_u32 m0, s27, 61440
    s_add_u32 s29, s25, 28928
    buffer_load_dwordx4 v6, s[8:11], s29 offen nt lds
    v_xor_b32 v6, 32, v6
    v_mfma_f32_32x32x16_bf16 v[64:79], v[28:31], v[228:231], v[64:79]
    ds_read_b64_tr_b16 v[28:29], v3 offset:47616
    ds_read_b64_tr_b16 v[30:31], v3 offset:48640
    s_waitcnt lgkmcnt(4)
    v_mfma_f32_32x32x16_bf16 v[48:63], v[16:19], v[240:243], v[48:63]
    ds_read_b64_tr_b16 v[16:17], v3 offset:16384
    ds_read_b64_tr_b16 v[18:19], v3 offset:17408
    v_mfma_f32_32x32x16_bf16 v[64:79], v[20:23], v[240:243], v[64:79]
    ds_read_b64_tr_b16 v[20:21], v3 offset:16896
    ds_read_b64_tr_b16 v[22:23], v3 offset:17920
    s_waitcnt lgkmcnt(4)
    v_mfma_f32_32x32x16_bf16 v[48:63], v[24:27], v[244:247], v[48:63]
    ds_read_b64_tr_b16 v[24:25], v3 offset:18432
    ds_read_b64_tr_b16 v[26:27], v3 offset:19456
    v_mfma_f32_32x32x16_bf16 v[64:79], v[28:31], v[244:247], v[64:79]
    ds_read_b64_tr_b16 v[28:29], v3 offset:18944
    ds_read_b64_tr_b16 v[30:31], v3 offset:19968
    s_waitcnt lgkmcnt(4)
    v_mfma_f32_32x32x16_bf16 v[112:127], v[16:19], a[152:155], v[112:127]
    ds_read_b64_tr_b16 v[16:17], v3 offset:20480
    ds_read_b64_tr_b16 v[18:19], v3 offset:21504
    v_mfma_f32_32x32x16_bf16 v[128:143], v[20:23], a[152:155], v[128:143]
    ds_read_b64_tr_b16 v[20:21], v3 offset:20992
    ds_read_b64_tr_b16 v[22:23], v3 offset:22016
    s_waitcnt lgkmcnt(4)
    v_mfma_f32_32x32x16_bf16 v[112:127], v[24:27], a[156:159], v[112:127]
    ds_read_b64_tr_b16 v[24:25], v3 offset:22528
    ds_read_b64_tr_b16 v[26:27], v3 offset:23552
    v_mul_f32 v48, v48, v12
    v_mul_f32 v49, v49, v12
    v_cvt_pk_bf16_f32 v48, v48, v49
    v_accvgpr_write_b32 a144, v48
    v_mul_f32 v50, v50, v12
    v_mfma_f32_32x32x16_bf16 v[128:143], v[28:31], a[156:159], v[128:143]
    ds_read_b64_tr_b16 v[28:29], v3 offset:23040
    ds_read_b64_tr_b16 v[30:31], v3 offset:24064
    s_waitcnt lgkmcnt(4)
    v_mfma_f32_32x32x16_bf16 v[112:127], v[16:19], a[168:171], v[112:127]
    ds_read_b64_tr_b16 v[16:17], v3 offset:24576
    ds_read_b64_tr_b16 v[18:19], v3 offset:25600
    v_mul_f32 v51, v51, v12
    v_cvt_pk_bf16_f32 v50, v50, v51
    v_accvgpr_write_b32 a145, v50
    v_mul_f32 v52, v52, v12
    v_mul_f32 v53, v53, v12
    v_mfma_f32_32x32x16_bf16 v[128:143], v[20:23], a[168:171], v[128:143]
    ds_read_b64_tr_b16 v[20:21], v3 offset:25088
    ds_read_b64_tr_b16 v[22:23], v3 offset:26112
    v_cvt_pk_bf16_f32 v52, v52, v53
    v_accvgpr_write_b32 a146, v52
    v_mul_f32 v54, v54, v12
    v_mul_f32 v55, v55, v12
    v_cvt_pk_bf16_f32 v54, v54, v55
    s_waitcnt lgkmcnt(4)
    v_mfma_f32_32x32x16_bf16 v[112:127], v[24:27], a[172:175], v[112:127]
    ds_read_b64_tr_b16 v[24:25], v3 offset:26624
    ds_read_b64_tr_b16 v[26:27], v3 offset:27648
    v_mfma_f32_32x32x16_bf16 v[128:143], v[28:31], a[172:175], v[128:143]
    ds_read_b64_tr_b16 v[28:29], v3 offset:27136
    ds_read_b64_tr_b16 v[30:31], v3 offset:28160
    v_accvgpr_write_b32 a147, v54
    v_mul_f32 v56, v56, v12
    v_mul_f32 v57, v57, v12
    v_cvt_pk_bf16_f32 v56, v56, v57
    v_accvgpr_write_b32 a148, v56
    s_waitcnt lgkmcnt(4)
    v_mfma_f32_32x32x16_bf16 v[112:127], v[16:19], a[184:187], v[112:127]
    ds_read_b64_tr_b16 v[16:17], v3 offset:28672
    ds_read_b64_tr_b16 v[18:19], v3 offset:29696
    v_mul_f32 v58, v58, v12
    v_mul_f32 v59, v59, v12
    v_cvt_pk_bf16_f32 v58, v58, v59
    v_accvgpr_write_b32 a149, v58
    v_mul_f32 v60, v60, v12
    v_mul_f32 v61, v61, v12
    v_mfma_f32_32x32x16_bf16 v[128:143], v[20:23], a[184:187], v[128:143]
    ds_read_b64_tr_b16 v[20:21], v3 offset:29184
    ds_read_b64_tr_b16 v[22:23], v3 offset:30208
    s_waitcnt lgkmcnt(4)
    v_mfma_f32_32x32x16_bf16 v[112:127], v[24:27], a[188:191], v[112:127]
    ds_read_b64_tr_b16 v[24:25], v3 offset:30720
    ds_read_b64_tr_b16 v[26:27], v3 offset:31744
    v_cvt_pk_bf16_f32 v60, v60, v61
    v_accvgpr_write_b32 a150, v60
    v_mul_f32 v62, v62, v12
    v_mul_f32 v63, v63, v12
    v_cvt_pk_bf16_f32 v62, v62, v63
    v_accvgpr_write_b32 a151, v62
    v_mfma_f32_32x32x16_bf16 v[128:143], v[28:31], a[188:191], v[128:143]
    ds_read_b64_tr_b16 v[28:29], v3 offset:31232
    ds_read_b64_tr_b16 v[30:31], v3 offset:32256
    v_mul_f32 v64, v64, v12
    v_mul_f32 v65, v65, v12
    v_cvt_pk_bf16_f32 v64, v64, v65
    v_accvgpr_write_b32 a160, v64
    v_mul_f32 v66, v66, v12
    s_waitcnt lgkmcnt(4)
    v_mfma_f32_32x32x16_bf16 v[112:127], v[16:19], a[200:203], v[112:127]
    ds_read_b64_tr_b16 v[16:17], v3 offset:32768
    ds_read_b64_tr_b16 v[18:19], v3 offset:33792
    v_mfma_f32_32x32x16_bf16 v[128:143], v[20:23], a[200:203], v[128:143]
    ds_read_b64_tr_b16 v[20:21], v3 offset:33280
    ds_read_b64_tr_b16 v[22:23], v3 offset:34304
    v_mul_f32 v67, v67, v12
    v_cvt_pk_bf16_f32 v66, v66, v67
    v_accvgpr_write_b32 a161, v66
    v_mul_f32 v68, v68, v12
    v_mul_f32 v69, v69, v12
    s_waitcnt lgkmcnt(4)
    v_mfma_f32_32x32x16_bf16 v[112:127], v[24:27], a[204:207], v[112:127]
    ds_read_b64_tr_b16 v[24:25], v3 offset:34816
    ds_read_b64_tr_b16 v[26:27], v3 offset:35840
    v_cvt_pk_bf16_f32 v68, v68, v69
    v_accvgpr_write_b32 a162, v68
    v_mul_f32 v70, v70, v12
    v_mul_f32 v71, v71, v12
    v_cvt_pk_bf16_f32 v70, v70, v71
    v_accvgpr_write_b32 a163, v70
    v_mfma_f32_32x32x16_bf16 v[128:143], v[28:31], a[204:207], v[128:143]
    ds_read_b64_tr_b16 v[28:29], v3 offset:35328
    ds_read_b64_tr_b16 v[30:31], v3 offset:36352
    s_barrier
    s_waitcnt lgkmcnt(4)
    v_mfma_f32_32x32x16_bf16 v[112:127], v[16:19], a[216:219], v[112:127]
    ds_read_b64_tr_b16 v[16:17], v3 offset:36864
    ds_read_b64_tr_b16 v[18:19], v3 offset:37888
    v_xor_b32 v1, 0xc000, v1
    v_xor_b32 v2, 0xc000, v2
    ds_read_b128 v[216:219], v1 offset:0
    v_mul_f32 v72, v72, v12
    v_mul_f32 v73, v73, v12
    v_cvt_pk_bf16_f32 v72, v72, v73
    v_mfma_f32_32x32x16_bf16 v[128:143], v[20:23], a[216:219], v[128:143]
    ds_read_b64_tr_b16 v[20:21], v3 offset:37376
    ds_read_b64_tr_b16 v[22:23], v3 offset:38400
    ds_read_b128 v[220:223], v2 offset:0
    v_accvgpr_write_b32 a164, v72
    v_mul_f32 v74, v74, v12
    v_mul_f32 v75, v75, v12
    v_cvt_pk_bf16_f32 v74, v74, v75
    s_waitcnt lgkmcnt(6)
    v_mfma_f32_32x32x16_bf16 v[112:127], v[24:27], a[220:223], v[112:127]
    ds_read_b64_tr_b16 v[24:25], v3 offset:38912
    ds_read_b64_tr_b16 v[26:27], v3 offset:39936
    ds_read_b128 a[240:243], v1 offset:512
    s_add_u32 m0, s27, 65536
    s_add_u32 s29, s25, 16768
    buffer_load_dwordx4 v6, s[8:11], s29 offen nt lds
    v_xor_b32 v6, 32, v6
    v_mfma_f32_32x32x16_bf16 v[128:143], v[28:31], a[220:223], v[128:143]
    ds_read_b64_tr_b16 v[28:29], v3 offset:39424
    ds_read_b64_tr_b16 v[30:31], v3 offset:40448
    ds_read_b128 a[244:247], v2 offset:512
    v_accvgpr_write_b32 a165, v74
    v_mul_f32 v76, v76, v12
    v_mul_f32 v77, v77, v12
    v_cvt_pk_bf16_f32 v76, v76, v77
    s_waitcnt lgkmcnt(7)
    v_mfma_f32_32x32x16_bf16 v[112:127], v[16:19], a[232:235], v[112:127]
    ds_read_b64_tr_b16 v[16:17], v3 offset:40960
    ds_read_b64_tr_b16 v[18:19], v3 offset:41984
    ds_read_b128 v[224:227], v1 offset:4096
    v_accvgpr_write_b32 a166, v76
    v_mul_f32 v78, v78, v12
    v_mul_f32 v79, v79, v12
    v_cvt_pk_bf16_f32 v78, v78, v79
    v_accvgpr_write_b32 a167, v78
    v_mfma_f32_32x32x16_bf16 v[128:143], v[20:23], a[232:235], v[128:143]
    ds_read_b64_tr_b16 v[20:21], v3 offset:41472
    ds_read_b64_tr_b16 v[22:23], v3 offset:42496
    ds_read_b128 v[228:231], v2 offset:4096
    s_add_u32 m0, s27, 69632
    s_add_u32 s29, s25, 20864
    buffer_load_dwordx4 v6, s[8:11], s29 offen nt lds
    v_xor_b32 v6, 32, v6
    s_waitcnt lgkmcnt(7)
    v_mfma_f32_32x32x16_bf16 v[112:127], v[24:27], a[236:239], v[112:127]
    ds_read_b64_tr_b16 v[24:25], v3 offset:43008
    ds_read_b64_tr_b16 v[26:27], v3 offset:44032
    ds_read_b128 a[248:251], v1 offset:4608
    v_mfma_f32_32x32x16_bf16 v[128:143], v[28:31], a[236:239], v[128:143]
    ds_read_b64_tr_b16 v[28:29], v3 offset:43520
    ds_read_b64_tr_b16 v[30:31], v3 offset:44544
    ds_read_b128 a[252:255], v2 offset:4608
    s_waitcnt lgkmcnt(7)
    v_mfma_f32_32x32x16_bf16 v[112:127], v[16:19], v[232:235], v[112:127]
    ds_read_b64_tr_b16 v[16:17], v3 offset:45056
    ds_read_b64_tr_b16 v[18:19], v3 offset:46080
    ds_read_b128 v[240:243], v1 offset:8192
    s_add_u32 m0, s27, 73728
    s_add_u32 s29, s25, 24960
    buffer_load_dwordx4 v6, s[8:11], s29 offen nt lds
    v_xor_b32 v6, 32, v6
    v_mfma_f32_32x32x16_bf16 v[128:143], v[20:23], v[232:235], v[128:143]
    ds_read_b64_tr_b16 v[20:21], v3 offset:45568
    ds_read_b64_tr_b16 v[22:23], v3 offset:46592
    ds_read_b128 v[244:247], v2 offset:8192
    s_waitcnt lgkmcnt(7)
    v_mfma_f32_32x32x16_bf16 v[112:127], v[24:27], v[236:239], v[112:127]
    ds_read_b64_tr_b16 v[24:25], v3 offset:47104
    ds_read_b64_tr_b16 v[26:27], v3 offset:48128
    ds_read_b128 a[232:235], v1 offset:8704
    v_mfma_f32_32x32x16_bf16 v[128:143], v[28:31], v[236:239], v[128:143]
    ds_read_b64_tr_b16 v[28:29], v3 offset:47616
    ds_read_b64_tr_b16 v[30:31], v3 offset:48640
    ds_read_b128 a[236:239], v2 offset:8704
    s_add_u32 m0, s27, 77824
    s_add_u32 s29, s25, 29056
    buffer_load_dwordx4 v6, s[8:11], s29 offen nt lds
    v_xor_b32 v6, 32, v6
    s_waitcnt lgkmcnt(7)
    v_mfma_f32_32x32x16_bf16 v[112:127], v[16:19], v[248:251], v[112:127]
    ds_read_b128 v[232:235], v1 offset:12288
    v_mfma_f32_32x32x16_bf16 v[128:143], v[20:23], v[248:251], v[128:143]
    ds_read_b128 v[236:239], v2 offset:12288
    s_waitcnt lgkmcnt(3)
    v_mfma_f32_32x32x16_bf16 v[112:127], v[24:27], v[252:255], v[112:127]
    ds_read_b128 v[248:251], v1 offset:12800
    v_mfma_f32_32x32x16_bf16 v[128:143], v[28:31], v[252:255], v[128:143]
    ds_read_b128 v[16:19], v7 offset:0
    ds_read_b128 v[252:255], v2 offset:12800
    s_mov_b32 s32, s24
    s_mov_b32 s24, s25
    s_mov_b32 s25, 2130706432
    s_add_u32 s31, s31, 1
    s_cmp_lt_u32 s31, 2
    s_cbranch_scc1 L_head
    s_nop 7
    s_nop 7
    ds_write_b128 v9, a[112:115]
    v_xor_b32 v0, 32, v9
    ds_write_b128 v0, a[116:119]
    v_xor_b32 v0, 64, v9
    ds_write_b128 v0, a[128:131]
    v_xor_b32 v0, 96, v9
    ds_write_b128 v0, a[132:135]
    ds_read_b128 a[112:115], v10 offset:0
    ds_read_b128 a[116:119], v10 offset:1024
    ds_read_b128 a[128:131], v10 offset:2048
    ds_read_b128 a[132:135], v10 offset:3072
    s_waitcnt lgkmcnt(3)
    s_add_u32 s30, s32, 16640
    buffer_store_dwordx4 a[112:115], v11, s[20:23], s30 offen sc1
    s_waitcnt lgkmcnt(2)
    s_add_u32 s30, s32, 20736
    buffer_store_dwordx4 a[116:119], v11, s[20:23], s30 offen sc1
    s_waitcnt lgkmcnt(1)
    s_add_u32 s30, s32, 24832
    buffer_store_dwordx4 a[128:131], v11, s[20:23], s30 offen sc1
    s_waitcnt lgkmcnt(0)
    s_add_u32 s30, s32, 28928
    buffer_store_dwordx4 a[132:135], v11, s[20:23], s30 offen sc1
    ds_write_b128 v9, a[176:179]
    v_xor_b32 v0, 32, v9
    ds_write_b128 v0, a[180:183]
    v_xor_b32 v0, 64, v9
    ds_write_b128 v0, a[192:195]
    v_xor_b32 v0, 96, v9
    ds_write_b128 v0, a[196:199]
    ds_read_b128 a[176:179], v10 offset:0
    ds_read_b128 a[180:183], v10 offset:1024
    ds_read_b128 a[192:195], v10 offset:2048
    ds_read_b128 a[196:199], v10 offset:3072
    s_waitcnt lgkmcnt(3)
    s_add_u32 s30, s32, 33152
    buffer_store_dwordx4 a[176:179], v11, s[20:23], s30 offen sc1
    s_waitcnt lgkmcnt(2)
    s_add_u32 s30, s32, 37248
    buffer_store_dwordx4 a[180:183], v11, s[20:23], s30 offen sc1
    s_waitcnt lgkmcnt(1)
    s_add_u32 s30, s32, 41344
    buffer_store_dwordx4 a[192:195], v11, s[20:23], s30 offen sc1
    s_waitcnt lgkmcnt(0)
    s_add_u32 s30, s32, 45440
    buffer_store_dwordx4 a[196:199], v11, s[20:23], s30 offen sc1
    ds_write_b128 v9, a[144:147]
    v_xor_b32 v0, 32, v9
    ds_write_b128 v0, a[148:151]
    v_xor_b32 v0, 64, v9
    ds_write_b128 v0, a[160:163]
    v_xor_b32 v0, 96, v9
    ds_write_b128 v0, a[164:167]
    ds_read_b128 a[144:147], v10 offset:0
    ds_read_b128 a[148:151], v10 offset:1024
    ds_read_b128 a[160:163], v10 offset:2048
    ds_read_b128 a[164:167], v10 offset:3072
    s_waitcnt lgkmcnt(3)
    s_add_u32 s30, s32, 384
    buffer_store_dwordx4 a[144:147], v11, s[20:23], s30 offen sc1
    s_waitcnt lgkmcnt(2)
    s_add_u32 s30, s32, 4480
    buffer_store_dwordx4 a[148:151], v11, s[20:23], s30 offen sc1
    s_waitcnt lgkmcnt(1)
    s_add_u32 s30, s32, 8576
    buffer_store_dwordx4 a[160:163], v11, s[20:23], s30 offen sc1
    s_waitcnt lgkmcnt(0)
    s_add_u32 s30, s32, 12672
    buffer_store_dwordx4 a[164:167], v11, s[20:23], s30 offen sc1
    v_mul_f32 v112, v112, v13
    v_mul_f32 v113, v113, v13
    v_cvt_pk_bf16_f32 v32, v112, v113
    v_mul_f32 v114, v114, v13
    v_mul_f32 v115, v115, v13
    v_cvt_pk_bf16_f32 v33, v114, v115
    v_mul_f32 v116, v116, v13
    v_mul_f32 v117, v117, v13
    v_cvt_pk_bf16_f32 v34, v116, v117
    v_mul_f32 v118, v118, v13
    v_mul_f32 v119, v119, v13
    v_cvt_pk_bf16_f32 v35, v118, v119
    ds_write_b128 v9, v[32:35]
    v_mul_f32 v120, v120, v13
    v_mul_f32 v121, v121, v13
    v_cvt_pk_bf16_f32 v36, v120, v121
    v_mul_f32 v122, v122, v13
    v_mul_f32 v123, v123, v13
    v_cvt_pk_bf16_f32 v37, v122, v123
    v_mul_f32 v124, v124, v13
    v_mul_f32 v125, v125, v13
    v_cvt_pk_bf16_f32 v38, v124, v125
    v_mul_f32 v126, v126, v13
    v_mul_f32 v127, v127, v13
    v_cvt_pk_bf16_f32 v39, v126, v127
    v_xor_b32 v0, 32, v9
    ds_write_b128 v0, v[36:39]
    v_mul_f32 v128, v128, v13
    v_mul_f32 v129, v129, v13
    v_cvt_pk_bf16_f32 v32, v128, v129
    v_mul_f32 v130, v130, v13
    v_mul_f32 v131, v131, v13
    v_cvt_pk_bf16_f32 v33, v130, v131
    v_mul_f32 v132, v132, v13
    v_mul_f32 v133, v133, v13
    v_cvt_pk_bf16_f32 v34, v132, v133
    v_mul_f32 v134, v134, v13
    v_mul_f32 v135, v135, v13
    v_cvt_pk_bf16_f32 v35, v134, v135
    v_xor_b32 v0, 64, v9
    ds_write_b128 v0, v[32:35]
    v_mul_f32 v136, v136, v13
    v_mul_f32 v137, v137, v13
    v_cvt_pk_bf16_f32 v36, v136, v137
    v_mul_f32 v138, v138, v13
    v_mul_f32 v139, v139, v13
    v_cvt_pk_bf16_f32 v37, v138, v139
    v_mul_f32 v140, v140, v13
    v_mul_f32 v141, v141, v13
    v_cvt_pk_bf16_f32 v38, v140, v141
    v_mul_f32 v142, v142, v13
    v_mul_f32 v143, v143, v13
    v_cvt_pk_bf16_f32 v39, v142, v143
    v_xor_b32 v0, 96, v9
    ds_write_b128 v0, v[36:39]
    ds_read_b128 v[32:35], v10 offset:0
    ds_read_b128 v[36:39], v10 offset:1024
    s_waitcnt lgkmcnt(1)
    s_add_u32 s30, s32, 16768
    buffer_store_dwordx4 v[32:35], v11, s[20:23], s30 offen sc1
    s_waitcnt lgkmcnt(0)
    s_add_u32 s30, s32, 20864
    buffer_store_dwordx4 v[36:39], v11, s[20:23], s30 offen sc1
    ds_read_b128 v[32:35], v10 offset:2048
    ds_read_b128 v[36:39], v10 offset:3072
    s_waitcnt lgkmcnt(1)
    s_add_u32 s30, s32, 24960
    buffer_store_dwordx4 v[32:35], v11, s[20:23], s30 offen sc1
    s_waitcnt lgkmcnt(0)
    s_add_u32 s30, s32, 29056
    buffer_store_dwordx4 v[36:39], v11, s[20:23], s30 offen sc1
L_end:
    s_endpgm
L_rare3:
    s_call_b64 s[34:35], L_redo1
    s_call_b64 s[34:35], L_resc2_0
    v_accvgpr_write_b32 a96, v64
    v_accvgpr_write_b32 a97, v65
    v_accvgpr_write_b32 a98, v66
    v_accvgpr_write_b32 a99, v67
    v_accvgpr_write_b32 a100, v68
    v_accvgpr_write_b32 a101, v69
    v_accvgpr_write_b32 a102, v70
    v_accvgpr_write_b32 a103, v71
    v_add_f32 v14, v14, v0
    v_mul_f32 v42, v42, v46
    s_branch L_back3
L_rare4:
    s_call_b64 s[34:35], L_redo0
    s_call_b64 s[34:35], L_resc0_0
    v_mov_b32 v152, v48
    v_mov_b32 v153, v49
    v_mov_b32 v154, v50
    v_mov_b32 v155, v51
    v_mov_b32 v156, v52
    v_mov_b32 v157, v53
    v_mov_b32 v158, v54
    v_mov_b32 v159, v55
    v_add_f32 v12, v12, v0
    v_mul_f32 v40, v40, v46
    s_branch L_back4
L_rare5:
    s_call_b64 s[34:35], L_redo1
    s_call_b64 s[34:35], L_resc1_0
    v_accvgpr_write_b32 a104, v64
    v_accvgpr_write_b32 a105, v65
    v_accvgpr_write_b32 a106, v66
    v_accvgpr_write_b32 a107, v67
    v_accvgpr_write_b32 a108, v68
    v_accvgpr_write_b32 a109, v69
    v_accvgpr_write_b32 a110, v70
    v_accvgpr_write_b32 a111, v71
    v_add_f32 v13, v13, v0
    v_mul_f32 v41, v41, v46
    s_branch L_back5
L_rare6:
    s_call_b64 s[34:35], L_redo0
    s_call_b64 s[34:35], L_resc2_1
    v_accvgpr_write_b32 a112, v48
    v_accvgpr_write_b32 a113, v49
    v_accvgpr_write_b32 a114, v50
    v_accvgpr_write_b32 a115, v51
    v_accvgpr_write_b32 a116, v52
    v_accvgpr_write_b32 a117, v53
    v_accvgpr_write_b32 a118, v54
    v_accvgpr_write_b32 a119, v55
    v_add_f32 v14, v14, v0
    v_mul_f32 v42, v42, v46
    s_branch L_back6
L_rare7:
    s_call_b64 s[34:35], L_redo1
    s_call_b64 s[34:35], L_resc0_1
    v_mov_b32 v160, v64
    v_mov_b32 v161, v65
    v_mov_b32 v162, v66
    v_mov_b32 v163, v67
    v_mov_b32 v164, v68
    v_mov_b32 v165, v69
    v_mov_b32 v166, v70
    v_mov_b32 v167, v71
    v_add_f32 v12, v12, v0
    v_mul_f32 v40, v40, v46
    s_branch L_back7
L_rare8:
    s_call_b64 s[34:35], L_redo0
    s_call_b64 s[34:35], L_resc1_1
    v_accvgpr_write_b32 a120, v48
    v_accvgpr_write_b32 a121, v49
    v_accvgpr_write_b32 a122, v50
    v_accvgpr_write_b32 a123, v51
    v_accvgpr_write_b32 a124, v52
    v_accvgpr_write_b32 a125, v53
    v_accvgpr_write_b32 a126, v54
    v_accvgpr_write_b32 a127, v55
    v_add_f32 v13, v13, v0
    v_mul_f32 v41, v41, v46
    s_branch L_back8
L_rare9:
    s_call_b64 s[34:35], L_redo1
    s_call_b64 s[34:35], L_resc2_2
    v_accvgpr_write_b32 a128, v64
    v_accvgpr_write_b32 a129, v65
    v_accvgpr_write_b32 a130, v66
    v_accvgpr_write_b32 a131, v67
    v_accvgpr_write_b32 a132, v68
    v_accvgpr_write_b32 a133, v69
    v_accvgpr_write_b32 a134, v70
    v_accvgpr_write_b32 a135, v71
    v_add_f32 v14, v14, v0
    v_mul_f32 v42, v42, v46
    s_branch L_back9
L_rare10:
    s_call_b64 s[34:35], L_redo0
    s_call_b64 s[34:35], L_resc0_2
    v_mov_b32 v168, v48
    v_mov_b32 v169, v49
    v_mov_b32 v170, v50
    v_mov_b32 v171, v51
    v_mov_b32 v172, v52
    v_mov_b32 v173, v53
    v_mov_b32 v174, v54
    v_mov_b32 v175, v55
    v_add_f32 v12, v12, v0
    v_mul_f32 v40, v40, v46
    s_branch L_back10
L_rare11:
    s_call_b64 s[34:35], L_redo1
    s_call_b64 s[34:35], L_resc1_2
    v_accvgpr_write_b32 a136, v64
    v_accvgpr_write_b32 a137, v65
    v_accvgpr_write_b32 a138, v66
    v_accvgpr_write_b32 a139, v67
    v_accvgpr_write_b32 a140, v68
    v_accvgpr_write_b32 a141, v69
    v_accvgpr_write_b32 a142, v70
    v_accvgpr_write_b32 a143, v71
    v_add_f32 v13, v13, v0
    v_mul_f32 v41, v41, v46
    s_branch L_back11
L_rare12:
    s_call_b64 s[34:35], L_redo0
    s_call_b64 s[34:35], L_resc2_3
    v_accvgpr_write_b32 a144, v48
    v_accvgpr_write_b32 a145, v49
    v_accvgpr_write_b32 a146, v50
    v_accvgpr_write_b32 a147, v51
    v_accvgpr_write_b32 a148, v52
    v_accvgpr_write_b32 a149, v53
    v_accvgpr_write_b32 a150, v54
    v_accvgpr_write_b32 a151, v55
    v_add_f32 v14, v14, v0
    v_mul_f32 v42, v42, v46
    s_branch L_back12
L_rare13:
    s_call_b64 s[34:35], L_redo1
    s_call_b64 s[34:35], L_resc0_3
    v_mov_b32 v176, v64
    v_mov_b32 v177, v65
    v_mov_b32 v178, v66
    v_mov_b32 v179, v67
    v_mov_b32 v180, v68
    v_mov_b32 v181, v69
    v_mov_b32 v182, v70
    v_mov_b32 v183, v71
    v_add_f32 v12, v12, v0
    v_mul_f32 v40, v40, v46
    s_branch L_back13
L_rare14:
    s_call_b64 s[34:35], L_redo0
    s_call_b64 s[34:35], L_resc1_3
    v_accvgpr_write_b32 a152, v48
    v_accvgpr_write_b32 a153, v49
    v_accvgpr_write_b32 a154, v50
    v_accvgpr_write_b32 a155, v51
    v_accvgpr_write_b32 a156, v52
    v_accvgpr_write_b32 a157, v53
    v_accvgpr_write_b32 a158, v54
    v_accvgpr_write_b32 a159, v55
    v_add_f32 v13, v13, v0
    v_mul_f32 v41, v41, v46
    s_branch L_back14
L_rare15:
    s_call_b64 s[34:35], L_redo1
    s_call_b64 s[34:35], L_resc2_4
    v_accvgpr_write_b32 a160, v64
    v_accvgpr_write_b32 a161, v65
    v_accvgpr_write_b32 a162, v66
    v_accvgpr_write_b32 a163, v67
    v_accvgpr_write_b32 a164, v68
    v_accvgpr_write_b32 a165, v69
    v_accvgpr_write_b32 a166, v70
    v_accvgpr_write_b32 a167, v71
    v_add_f32 v14, v14, v0
    v_mul_f32 v42, v42, v46
    s_branch L_back15
L_rare16:
    s_call_b64 s[34:35], L_redo0
    s_call_b64 s[34:35], L_resc0_4
    v_mov_b32 v184, v48
    v_mov_b32 v185, v49
    v_mov_b32 v186, v50
    v_mov_b32 v187, v51
    v_mov_b32 v188, v52
    v_mov_b32 v189, v53
    v_mov_b32 v190, v54
    v_mov_b32 v191, v55
    v_add_f32 v12, v12, v0
    v_mul_f32 v40, v40, v46
    s_branch L_back16
L_rare17:
    s_call_b64 s[34:35], L_redo1
    s_call_b64 s[34:35], L_resc1_4
    v_accvgpr_write_b32 a168, v64
    v_accvgpr_write_b32 a169, v65
    v_accvgpr_write_b32 a170, v66
    v_accvgpr_write_b32 a171, v67
    v_accvgpr_write_b32 a172, v68
    v_accvgpr_write_b32 a173, v69
    v_accvgpr_write_b32 a174, v70
    v_accvgpr_write_b32 a175, v71
    v_add_f32 v13, v13, v0
    v_mul_f32 v41, v41, v46
    s_branch L_back17
L_rare18:
    s_call_b64 s[34:35], L_redo0
    s_call_b64 s[34:35], L_resc2_5
    v_accvgpr_write_b32 a176, v48
    v_accvgpr_write_b32 a177, v49
    v_accvgpr_write_b32 a178, v50
    v_accvgpr_write_b32 a179, v51
    v_accvgpr_write_b32 a180, v52
    v_accvgpr_write_b32 a181, v53
    v_accvgpr_write_b32 a182, v54
    v_accvgpr_write_b32 a183, v55
    v_add_f32 v14, v14, v0
    v_mul_f32 v42, v42, v46
    s_branch L_back18
L_rare19:
    s_call_b64 s[34:35], L_redo1
    s_call_b64 s[34:35], L_resc0_5
    v_mov_b32 v192, v64
    v_mov_b32 v193, v65
    v_mov_b32 v194, v66
    v_mov_b32 v195, v67
    v_mov_b32 v196, v68
    v_mov_b32 v197, v69
    v_mov_b32 v198, v70
    v_mov_b32 v199, v71
    v_add_f32 v12, v12, v0
    v_mul_f32 v40, v40, v46
    s_branch L_back19
L_rare20:
    s_call_b64 s[34:35], L_redo0
    s_call_b64 s[34:35], L_resc1_5
    v_accvgpr_write_b32 a184, v48
    v_accvgpr_write_b32 a185, v49
    v_accvgpr_write_b32 a186, v50
    v_accvgpr_write_b32 a187, v51
    v_accvgpr_write_b32 a188, v52
    v_accvgpr_write_b32 a189, v53
    v_accvgpr_write_b32 a190, v54
    v_accvgpr_write_b32 a191, v55
    v_add_f32 v13, v13, v0
    v_mul_f32 v41, v41, v46
    s_branch L_back20
L_rare21:
    s_call_b64 s[34:35], L_redo1
    s_call_b64 s[34:35], L_resc2_6
    v_accvgpr_write_b32 a192, v64
    v_accvgpr_write_b32 a193, v65
    v_accvgpr_write_b32 a194, v66
    v_accvgpr_write_b32 a195, v67
    v_accvgpr_write_b32 a196, v68
    v_accvgpr_write_b32 a197, v69
    v_accvgpr_write_b32 a198, v70
    v_accvgpr_write_b32 a199, v71
    v_add_f32 v14, v14, v0
    v_mul_f32 v42, v42, v46
    s_branch L_back21
L_rare22:
    s_call_b64 s[34:35], L_redo0
    s_call_b64 s[34:35], L_resc0_6
    v_mov_b32 v200, v48
    v_mov_b32 v201, v49
    v_mov_b32 v202, v50
    v_mov_b32 v203, v51
    v_mov_b32 v204, v52
    v_mov_b32 v205, v53
    v_mov_b32 v206, v54
    v_mov_b32 v207, v55
    v_add_f32 v12, v12, v0
    v_mul_f32 v40, v40, v46
    s_branch L_back22
L_rare23:
    s_call_b64 s[34:35], L_redo1
    s_call_b64 s[34:35], L_resc1_6
    v_accvgpr_write_b32 a200, v64
    v_accvgpr_write_b32 a201, v65
    v_accvgpr_write_b32 a202, v66
    v_accvgpr_write_b32 a203, v67
    v_accvgpr_write_b32 a204, v68
    v_accvgpr_write_b32 a205, v69
    v_accvgpr_write_b32 a206, v70
    v_accvgpr_write_b32 a207, v71
    v_add_f32 v13, v13, v0
    v_mul_f32 v41, v41, v46
    s_branch L_back23
L_rare24:
    s_call_b64 s[34:35], L_redo0
    s_call_b64 s[34:35], L_resc2_7
    v_accvgpr_write_b32 a208, v48
    v_accvgpr_write_b32 a209, v49
    v_accvgpr_write_b32 a210, v50
    v_accvgpr_write_b32 a211, v51
    v_accvgpr_write_b32 a212, v52
    v_accvgpr_write_b32 a213, v53
    v_accvgpr_write_b32 a214, v54
    v_accvgpr_write_b32 a215, v55
    v_add_f32 v14, v14, v0
    v_mul_f32 v42, v42, v46
    s_branch L_back24
L_rare25:
    s_call_b64 s[34:35], L_redo1
    s_call_b64 s[34:35], L_resc0_7
    v_mov_b32 v208, v64
    v_mov_b32 v209, v65
    v_mov_b32 v210, v66
    v_mov_b32 v211, v67
    v_mov_b32 v212, v68
    v_mov_b32 v213, v69
    v_mov_b32 v214, v70
    v_mov_b32 v215, v71
    v_add_f32 v12, v12, v0
    v_mul_f32 v40, v40, v46
    s_branch L_back25
L_rare26:
    s_call_b64 s[34:35], L_redo0
    s_call_b64 s[34:35], L_resc1_7
    v_accvgpr_write_b32 a216, v48
    v_accvgpr_write_b32 a217, v49
    v_accvgpr_write_b32 a218, v50
    v_accvgpr_write_b32 a219, v51
    v_accvgpr_write_b32 a220, v52
    v_accvgpr_write_b32 a221, v53
    v_accvgpr_write_b32 a222, v54
    v_accvgpr_write_b32 a223, v55
    v_add_f32 v13, v13, v0
    v_mul_f32 v41, v41, v46
    s_branch L_back26
L_rare27:
    s_call_b64 s[34:35], L_redo1
    s_call_b64 s[34:35], L_resc2_8
    v_accvgpr_write_b32 a224, v64
    v_accvgpr_write_b32 a225, v65
    v_accvgpr_write_b32 a226, v66
    v_accvgpr_write_b32 a227, v67
    v_accvgpr_write_b32 a228, v68
    v_accvgpr_write_b32 a229, v69
    v_accvgpr_write_b32 a230, v70
    v_accvgpr_write_b32 a231, v71
    v_add_f32 v14, v14, v0
    v_mul_f32 v42, v42, v46
    s_branch L_back27
L_rare28:
    s_call_b64 s[34:35], L_redo0
    s_call_b64 s[34:35], L_resc0_8
    v_mov_b32 v216, v48
    v_mov_b32 v217, v49
    v_mov_b32 v218, v50
    v_mov_b32 v219, v51
    v_mov_b32 v220, v52
    v_mov_b32 v221, v53
    v_mov_b32 v222, v54
    v_mov_b32 v223, v55
    v_add_f32 v12, v12, v0
    v_mul_f32 v40, v40, v46
    s_branch L_back28
L_rare29:
    s_call_b64 s[34:35], L_redo1
    s_call_b64 s[34:35], L_resc1_8
    v_accvgpr_write_b32 a232, v64
    v_accvgpr_write_b32 a233, v65
    v_accvgpr_write_b32 a234, v66
    v_accvgpr_write_b32 a235, v67
    v_accvgpr_write_b32 a236, v68
    v_accvgpr_write_b32 a237, v69
    v_accvgpr_write_b32 a238, v70
    v_accvgpr_write_b32 a239, v71
    v_add_f32 v13, v13, v0
    v_mul_f32 v41, v41, v46
    s_branch L_back29
L_rare30:
    s_call_b64 s[34:35], L_redo0
    s_call_b64 s[34:35], L_resc2_9
    v_accvgpr_write_b32 a240, v48
    v_accvgpr_write_b32 a241, v49
    v_accvgpr_write_b32 a242, v50
    v_accvgpr_write_b32 a243, v51
    v_accvgpr_write_b32 a244, v52
    v_accvgpr_write_b32 a245, v53
    v_accvgpr_write_b32 a246, v54
    v_accvgpr_write_b32 a247, v55
    v_add_f32 v14, v14, v0
    v_mul_f32 v42, v42, v46
    s_branch L_back30
L_rare31:
    s_call_b64 s[34:35], L_redo1
    s_call_b64 s[34:35], L_resc0_9
    v_mov_b32 v224, v64
    v_mov_b32 v225, v65
    v_mov_b32 v226, v66
    v_mov_b32 v227, v67
    v_mov_b32 v228, v68
    v_mov_b32 v229, v69
    v_mov_b32 v230, v70
    v_mov_b32 v231, v71
    v_add_f32 v12, v12, v0
    v_mul_f32 v40, v40, v46
    s_branch L_back31
L_rare32:
    s_call_b64 s[34:35], L_redo0
    s_call_b64 s[34:35], L_resc1_9
    v_mov_b32 v232, v48
    v_mov_b32 v233, v49
    v_mov_b32 v234, v50
    v_mov_b32 v235, v51
    v_mov_b32 v236, v52
    v_mov_b32 v237, v53
    v_mov_b32 v238, v54
    v_mov_b32 v239, v55
    v_add_f32 v13, v13, v0
    v_mul_f32 v41, v41, v46
    s_branch L_back32
L_rare33:
    s_call_b64 s[34:35], L_redo1
    s_call_b64 s[34:35], L_resc2_10
    v_accvgpr_write_b32 a248, v64
    v_accvgpr_write_b32 a249, v65
    v_accvgpr_write_b32 a250, v66
    v_accvgpr_write_b32 a251, v67
    v_accvgpr_write_b32 a252, v68
    v_accvgpr_write_b32 a253, v69
    v_accvgpr_write_b32 a254, v70
    v_accvgpr_write_b32 a255, v71
    v_add_f32 v14, v14, v0
    v_mul_f32 v42, v42, v46
    s_branch L_back33
L_rare34:
    s_call_b64 s[34:35], L_redo0
    s_call_b64 s[34:35], L_resc0_10
    v_mov_b32 v240, v48
    v_mov_b32 v241, v49
    v_mov_b32 v242, v50
    v_mov_b32 v243, v51
    v_mov_b32 v244, v52
    v_mov_b32 v245, v53
    v_mov_b32 v246, v54
    v_mov_b32 v247, v55
    v_add_f32 v12, v12, v0
    v_mul_f32 v40, v40, v46
    s_branch L_back34
L_rare35:
    s_call_b64 s[34:35], L_redo1
    s_call_b64 s[34:35], L_resc1_10
    v_mov_b32 v248, v64
    v_mov_b32 v249, v65
    v_mov_b32 v250, v66
    v_mov_b32 v251, v67
    v_mov_b32 v252, v68
    v_mov_b32 v253, v69
    v_mov_b32 v254, v70
    v_mov_b32 v255, v71
    v_add_f32 v13, v13, v0
    v_mul_f32 v41, v41, v46
    s_branch L_back35
L_redo0:
    v_max3_f32 v0, v48, v49, v50
    v_max3_f32 v0, v0, v51, v52
    v_max3_f32 v0, v0, v53, v54
    v_max3_f32 v0, v0, v55, v56
    v_max3_f32 v0, v0, v57, v58
    v_max3_f32 v0, v0, v59, v60
    v_max3_f32 v0, v0, v61, v62
    v_max_f32 v0, v0, v63
    v_mov_b32 v44, v0
    s_nop 1
    v_permlane32_swap_b32 v0, v44
    v_max_f32 v0, v0, v44
    v_add_f32 v0, 0x40e00000, v0
    v_max_f32 v0, 0, v0
    v_exp_f32 v46, -v0
    v_sub_f32 v48, v48, v0
    v_sub_f32 v49, v49, v0
    v_sub_f32 v50, v50, v0
    v_sub_f32 v51, v51, v0
    v_sub_f32 v52, v52, v0
    v_sub_f32 v53, v53, v0
    v_sub_f32 v54, v54, v0
    v_sub_f32 v55, v55, v0
    v_sub_f32 v56, v56, v0
    v_sub_f32 v57, v57, v0
    v_sub_f32 v58, v58, v0
    v_sub_f32 v59, v59, v0
    v_sub_f32 v60, v60, v0
    v_sub_f32 v61, v61, v0
    v_sub_f32 v62, v62, v0
    v_sub_f32 v63, v63, v0
    v_exp_f32 v48, v48
    v_exp_f32 v49, v49
    v_exp_f32 v50, v50
    v_exp_f32 v51, v51
    v_exp_f32 v52, v52
    v_exp_f32 v53, v53
    v_exp_f32 v54, v54
    v_exp_f32 v55, v55
    v_exp_f32 v56, v56
    v_exp_f32 v57, v57
    v_exp_f32 v58, v58
    v_exp_f32 v59, v59
    v_exp_f32 v60, v60
    v_exp_f32 v61, v61
    v_exp_f32 v62, v62
    v_exp_f32 v63, v63
    s_nop 0
    v_add_f32 v43, v48, v49
    v_add_f32 v43, v43, v50
    v_add_f32 v43, v43, v51
    v_add_f32 v43, v43, v52
    v_add_f32 v43, v43, v53
    v_add_f32 v43, v43, v54
    v_add_f32 v43, v43, v55
    v_add_f32 v43, v43, v56
    v_add_f32 v43, v43, v57
    v_add_f32 v43, v43, v58
    v_add_f32 v43, v43, v59
    v_add_f32 v43, v43, v60
    v_add_f32 v43, v43, v61
    v_add_f32 v43, v43, v62
    v_add_f32 v43, v43, v63
    v_cvt_pk_bf16_f32 v48, v48, v49
    v_cvt_pk_bf16_f32 v49, v50, v51
    v_cvt_pk_bf16_f32 v50, v52, v53
    v_cvt_pk_bf16_f32 v51, v54, v55
    v_cvt_pk_bf16_f32 v52, v56, v57
    v_cvt_pk_bf16_f32 v53, v58, v59
    v_cvt_pk_bf16_f32 v54, v60, v61
    v_cvt_pk_bf16_f32 v55, v62, v63
    s_setpc_b64 s[34:35]
L_redo1:
    v_max3_f32 v0, v64, v65, v66
    v_max3_f32 v0, v0, v67, v68
    v_max3_f32 v0, v0, v69, v70
    v_max3_f32 v0, v0, v71, v72
    v_max3_f32 v0, v0, v73, v74
    v_max3_f32 v0, v0, v75, v76
    v_max3_f32 v0, v0, v77, v78
    v_max_f32 v0, v0, v79
    v_mov_b32 v44, v0
    s_nop 1
    v_permlane32_swap_b32 v0, v44
    v_max_f32 v0, v0, v44
    v_add_f32 v0, 0x40e00000, v0
    v_max_f32 v0, 0, v0
    v_exp_f32 v46, -v0
    v_sub_f32 v64, v64, v0
    v_sub_f32 v65, v65, v0
    v_sub_f32 v66, v66, v0
    v_sub_f32 v67, v67, v0
    v_sub_f32 v68, v68, v0
    v_sub_f32 v69, v69, v0
    v_sub_f32 v70, v70, v0
    v_sub_f32 v71, v71, v0
    v_sub_f32 v72, v72, v0
    v_sub_f32 v73, v73, v0
    v_sub_f32 v74, v74, v0
    v_sub_f32 v75, v75, v0
    v_sub_f32 v76, v76, v0
    v_sub_f32 v77, v77, v0
    v_sub_f32 v78, v78, v0
    v_sub_f32 v79, v79, v0
    v_exp_f32 v64, v64
    v_exp_f32 v65, v65
    v_exp_f32 v66, v66
    v_exp_f32 v67, v67
    v_exp_f32 v68, v68
    v_exp_f32 v69, v69
    v_exp_f32 v70, v70
    v_exp_f32 v71, v71
    v_exp_f32 v72, v72
    v_exp_f32 v73, v73
    v_exp_f32 v74, v74
    v_exp_f32 v75, v75
    v_exp_f32 v76, v76
    v_exp_f32 v77, v77
    v_exp_f32 v78, v78
    v_exp_f32 v79, v79
    s_nop 0
    v_add_f32 v43, v64, v65
    v_add_f32 v43, v43, v66
    v_add_f32 v43, v43, v67
    v_add_f32 v43, v43, v68
    v_add_f32 v43, v43, v69
    v_add_f32 v43, v43, v70
    v_add_f32 v43, v43, v71
    v_add_f32 v43, v43, v72
    v_add_f32 v43, v43, v73
    v_add_f32 v43, v43, v74
    v_add_f32 v43, v43, v75
    v_add_f32 v43, v43, v76
    v_add_f32 v43, v43, v77
    v_add_f32 v43, v43, v78
    v_add_f32 v43, v43, v79
    v_cvt_pk_bf16_f32 v64, v64, v65
    v_cvt_pk_bf16_f32 v65, v66, v67
    v_cvt_pk_bf16_f32 v66, v68, v69
    v_cvt_pk_bf16_f32 v67, v70, v71
    v_cvt_pk_bf16_f32 v68, v72, v73
    v_cvt_pk_bf16_f32 v69, v74, v75
    v_cvt_pk_bf16_f32 v70, v76, v77
    v_cvt_pk_bf16_f32 v71, v78, v79
    s_setpc_b64 s[34:35]
L_resc0_10:
    v_and_b32 v45, 0xffff0000, v224
    v_lshlrev_b32 v44, 16, v224
    v_mul_f32 v45, v45, v46
    v_mul_f32 v44, v44, v46
    v_cvt_pk_bf16_f32 v224, v44, v45
    v_and_b32 v45, 0xffff0000, v225
    v_lshlrev_b32 v44, 16, v225
    v_mul_f32 v45, v45, v46
    v_mul_f32 v44, v44, v46
    v_cvt_pk_bf16_f32 v225, v44, v45
    v_and_b32 v45, 0xffff0000, v226
    v_lshlrev_b32 v44, 16, v226
    v_mul_f32 v45, v45, v46
    v_mul_f32 v44, v44, v46
    v_cvt_pk_bf16_f32 v226, v44, v45
    v_and_b32 v45, 0xffff0000, v227
    v_lshlrev_b32 v44, 16, v227
    v_mul_f32 v45, v45, v46
    v_mul_f32 v44, v44, v46
    v_cvt_pk_bf16_f32 v227, v44, v45
    v_and_b32 v45, 0xffff0000, v228
    v_lshlrev_b32 v44, 16, v228
    v_mul_f32 v45, v45, v46
    v_mul_f32 v44, v44, v46
    v_cvt_pk_bf16_f32 v228, v44, v45
    v_and_b32 v45, 0xffff0000, v229
    v_lshlrev_b32 v44, 16, v229
    v_mul_f32 v45, v45, v46
    v_mul_f32 v44, v44, v46
    v_cvt_pk_bf16_f32 v229, v44, v45
    v_and_b32 v45, 0xffff0000, v230
    v_lshlrev_b32 v44, 16, v230
    v_mul_f32 v45, v45, v46
    v_mul_f32 v44, v44, v46
    v_cvt_pk_bf16_f32 v230, v44, v45
    v_and_b32 v45, 0xffff0000, v231
    v_lshlrev_b32 v44, 16, v231
    v_mul_f32 v45, v45, v46
    v_mul_f32 v44, v44, v46
    v_cvt_pk_bf16_f32 v231, v44, v45
L_resc0_9:
    v_and_b32 v45, 0xffff0000, v216
    v_lshlrev_b32 v44, 16, v216
    v_mul_f32 v45, v45, v46
    v_mul_f32 v44, v44, v46
    v_cvt_pk_bf16_f32 v216, v44, v45
    v_and_b32 v45, 0xffff0000, v217
    v_lshlrev_b32 v44, 16, v217
    v_mul_f32 v45, v45, v46
    v_mul_f32 v44, v44, v46
    v_cvt_pk_bf16_f32 v217, v44, v45
    v_and_b32 v45, 0xffff0000, v218
    v_lshlrev_b32 v44, 16, v218
    v_mul_f32 v45, v45, v46
    v_mul_f32 v44, v44, v46
    v_cvt_pk_bf16_f32 v218, v44, v45
    v_and_b32 v45, 0xffff0000, v219
    v_lshlrev_b32 v44, 16, v219
    v_mul_f32 v45, v45, v46
    v_mul_f32 v44, v44, v46
    v_cvt_pk_bf16_f32 v219, v44, v45
    v_and_b32 v45, 0xffff0000, v220
    v_lshlrev_b32 v44, 16, v220
    v_mul_f32 v45, v45, v46
    v_mul_f32 v44, v44, v46
    v_cvt_pk_bf16_f32 v220, v44, v45
    v_and_b32 v45, 0xffff0000, v221
    v_lshlrev_b32 v44, 16, v221
    v_mul_f32 v45, v45, v46
    v_mul_f32 v44, v44, v46
    v_cvt_pk_bf16_f32 v221, v44, v45
    v_and_b32 v45, 0xffff0000, v222
    v_lshlrev_b32 v44, 16, v222
    v_mul_f32 v45, v45, v46
    v_mul_f32 v44, v44, v46
    v_cvt_pk_bf16_f32 v222, v44, v45
    v_and_b32 v45, 0xffff0000, v223
    v_lshlrev_b32 v44, 16, v223
    v_mul_f32 v45, v45, v46
    v_mul_f32 v44, v44, v46
    v_cvt_pk_bf16_f32 v223, v44, v45
L_resc0_8:
    v_and_b32 v45, 0xffff0000, v208
    v_lshlrev_b32 v44, 16, v208
    v_mul_f32 v45, v45, v46
    v_mul_f32 v44, v44, v46
    v_cvt_pk_bf16_f32 v208, v44, v45
    v_and_b32 v45, 0xffff0000, v209
    v_lshlrev_b32 v44, 16, v209
    v_mul_f32 v45, v45, v46
    v_mul_f32 v44, v44, v46
    v_cvt_pk_bf16_f32 v209, v44, v45
    v_and_b32 v45, 0xffff0000, v210
    v_lshlrev_b32 v44, 16, v210
    v_mul_f32 v45, v45, v46
    v_mul_f32 v44, v44, v46
    v_cvt_pk_bf16_f32 v210, v44, v45
    v_and_b32 v45, 0xffff0000, v211
    v_lshlrev_b32 v44, 16, v211
    v_mul_f32 v45, v45, v46
    v_mul_f32 v44, v44, v46
    v_cvt_pk_bf16_f32 v211, v44, v45
    v_and_b32 v45, 0xffff0000, v212
    v_lshlrev_b32 v44, 16, v212
    v_mul_f32 v45, v45, v46
    v_mul_f32 v44, v44, v46
    v_cvt_pk_bf16_f32 v212, v44, v45
    v_and_b32 v45, 0xffff0000, v213
    v_lshlrev_b32 v44, 16, v213
    v_mul_f32 v45, v45, v46
    v_mul_f32 v44, v44, v46
    v_cvt_pk_bf16_f32 v213, v44, v45
    v_and_b32 v45, 0xffff0000, v214
    v_lshlrev_b32 v44, 16, v214
    v_mul_f32 v45, v45, v46
    v_mul_f32 v44, v44, v46
    v_cvt_pk_bf16_f32 v214, v44, v45
    v_and_b32 v45, 0xffff0000, v215
    v_lshlrev_b32 v44, 16, v215
    v_mul_f32 v45, v45, v46
    v_mul_f32 v44, v44, v46
    v_cvt_pk_bf16_f32 v215, v44, v45
L_resc0_7:
    v_and_b32 v45, 0xffff0000, v200
    v_lshlrev_b32 v44, 16, v200
    v_mul_f32 v45, v45, v46
    v_mul_f32 v44, v44, v46
    v_cvt_pk_bf16_f32 v200, v44, v45
    v_and_b32 v45, 0xffff0000, v201
    v_lshlrev_b32 v44, 16, v201
    v_mul_f32 v45, v45, v46
    v_mul_f32 v44, v44, v46
    v_cvt_pk_bf16_f32 v201, v44, v45
    v_and_b32 v45, 0xffff0000, v202
    v_lshlrev_b32 v44, 16, v202
    v_mul_f32 v45, v45, v46
    v_mul_f32 v44, v44, v46
    v_cvt_pk_bf16_f32 v202, v44, v45
    v_and_b32 v45, 0xffff0000, v203
    v_lshlrev_b32 v44, 16, v203
    v_mul_f32 v45, v45, v46
    v_mul_f32 v44, v44, v46
    v_cvt_pk_bf16_f32 v203, v44, v45
    v_and_b32 v45, 0xffff0000, v204
    v_lshlrev_b32 v44, 16, v204
    v_mul_f32 v45, v45, v46
    v_mul_f32 v44, v44, v46
    v_cvt_pk_bf16_f32 v204, v44, v45
    v_and_b32 v45, 0xffff0000, v205
    v_lshlrev_b32 v44, 16, v205
    v_mul_f32 v45, v45, v46
    v_mul_f32 v44, v44, v46
    v_cvt_pk_bf16_f32 v205, v44, v45
    v_and_b32 v45, 0xffff0000, v206
    v_lshlrev_b32 v44, 16, v206
    v_mul_f32 v45, v45, v46
    v_mul_f32 v44, v44, v46
    v_cvt_pk_bf16_f32 v206, v44, v45
    v_and_b32 v45, 0xffff0000, v207
    v_lshlrev_b32 v44, 16, v207
    v_mul_f32 v45, v45, v46
    v_mul_f32 v44, v44, v46
    v_cvt_pk_bf16_f32 v207, v44, v45
L_resc0_6:
    v_and_b32 v45, 0xffff0000, v192
    v_lshlrev_b32 v44, 16, v192
    v_mul_f32 v45, v45, v46
    v_mul_f32 v44, v44, v46
    v_cvt_pk_bf16_f32 v192, v44, v45
    v_and_b32 v45, 0xffff0000, v193
    v_lshlrev_b32 v44, 16, v193
    v_mul_f32 v45, v45, v46
    v_mul_f32 v44, v44, v46
    v_cvt_pk_bf16_f32 v193, v44, v45
    v_and_b32 v45, 0xffff0000, v194
    v_lshlrev_b32 v44, 16, v194
    v_mul_f32 v45, v45, v46
    v_mul_f32 v44, v44, v46
    v_cvt_pk_bf16_f32 v194, v44, v45
    v_and_b32 v45, 0xffff0000, v195
    v_lshlrev_b32 v44, 16, v195
    v_mul_f32 v45, v45, v46
    v_mul_f32 v44, v44, v46
    v_cvt_pk_bf16_f32 v195, v44, v45
    v_and_b32 v45, 0xffff0000, v196
    v_lshlrev_b32 v44, 16, v196
    v_mul_f32 v45, v45, v46
    v_mul_f32 v44, v44, v46
    v_cvt_pk_bf16_f32 v196, v44, v45
    v_and_b32 v45, 0xffff0000, v197
    v_lshlrev_b32 v44, 16, v197
    v_mul_f32 v45, v45, v46
    v_mul_f32 v44, v44, v46
    v_cvt_pk_bf16_f32 v197, v44, v45
    v_and_b32 v45, 0xffff0000, v198
    v_lshlrev_b32 v44, 16, v198
    v_mul_f32 v45, v45, v46
    v_mul_f32 v44, v44, v46
    v_cvt_pk_bf16_f32 v198, v44, v45
    v_and_b32 v45, 0xffff0000, v199
    v_lshlrev_b32 v44, 16, v199
    v_mul_f32 v45, v45, v46
    v_mul_f32 v44, v44, v46
    v_cvt_pk_bf16_f32 v199, v44, v45
L_resc0_5:
    v_and_b32 v45, 0xffff0000, v184
    v_lshlrev_b32 v44, 16, v184
    v_mul_f32 v45, v45, v46
    v_mul_f32 v44, v44, v46
    v_cvt_pk_bf16_f32 v184, v44, v45
    v_and_b32 v45, 0xffff0000, v185
    v_lshlrev_b32 v44, 16, v185
    v_mul_f32 v45, v45, v46
    v_mul_f32 v44, v44, v46
    v_cvt_pk_bf16_f32 v185, v44, v45
    v_and_b32 v45, 0xffff0000, v186
    v_lshlrev_b32 v44, 16, v186
    v_mul_f32 v45, v45, v46
    v_mul_f32 v44, v44, v46
    v_cvt_pk_bf16_f32 v186, v44, v45
    v_and_b32 v45, 0xffff0000, v187
    v_lshlrev_b32 v44, 16, v187
    v_mul_f32 v45, v45, v46
    v_mul_f32 v44, v44, v46
    v_cvt_pk_bf16_f32 v187, v44, v45
    v_and_b32 v45, 0xffff0000, v188
    v_lshlrev_b32 v44, 16, v188
    v_mul_f32 v45, v45, v46
    v_mul_f32 v44, v44, v46
    v_cvt_pk_bf16_f32 v188, v44, v45
    v_and_b32 v45, 0xffff0000, v189
    v_lshlrev_b32 v44, 16, v189
    v_mul_f32 v45, v45, v46
    v_mul_f32 v44, v44, v46
    v_cvt_pk_bf16_f32 v189, v44, v45
    v_and_b32 v45, 0xffff0000, v190
    v_lshlrev_b32 v44, 16, v190
    v_mul_f32 v45, v45, v46
    v_mul_f32 v44, v44, v46
    v_cvt_pk_bf16_f32 v190, v44, v45
    v_and_b32 v45, 0xffff0000, v191
    v_lshlrev_b32 v44, 16, v191
    v_mul_f32 v45, v45, v46
    v_mul_f32 v44, v44, v46
    v_cvt_pk_bf16_f32 v191, v44, v45
L_resc0_4:
    v_and_b32 v45, 0xffff0000, v176
    v_lshlrev_b32 v44, 16, v176
    v_mul_f32 v45, v45, v46
    v_mul_f32 v44, v44, v46
    v_cvt_pk_bf16_f32 v176, v44, v45
    v_and_b32 v45, 0xffff0000, v177
    v_lshlrev_b32 v44, 16, v177
    v_mul_f32 v45, v45, v46
    v_mul_f32 v44, v44, v46
    v_cvt_pk_bf16_f32 v177, v44, v45
    v_and_b32 v45, 0xffff0000, v178
    v_lshlrev_b32 v44, 16, v178
    v_mul_f32 v45, v45, v46
    v_mul_f32 v44, v44, v46
    v_cvt_pk_bf16_f32 v178, v44, v45
    v_and_b32 v45, 0xffff0000, v179
    v_lshlrev_b32 v44, 16, v179
    v_mul_f32 v45, v45, v46
    v_mul_f32 v44, v44, v46
    v_cvt_pk_bf16_f32 v179, v44, v45
    v_and_b32 v45, 0xffff0000, v180
    v_lshlrev_b32 v44, 16, v180
    v_mul_f32 v45, v45, v46
    v_mul_f32 v44, v44, v46
    v_cvt_pk_bf16_f32 v180, v44, v45
    v_and_b32 v45, 0xffff0000, v181
    v_lshlrev_b32 v44, 16, v181
    v_mul_f32 v45, v45, v46
    v_mul_f32 v44, v44, v46
    v_cvt_pk_bf16_f32 v181, v44, v45
    v_and_b32 v45, 0xffff0000, v182
    v_lshlrev_b32 v44, 16, v182
    v_mul_f32 v45, v45, v46
    v_mul_f32 v44, v44, v46
    v_cvt_pk_bf16_f32 v182, v44, v45
    v_and_b32 v45, 0xffff0000, v183
    v_lshlrev_b32 v44, 16, v183
    v_mul_f32 v45, v45, v46
    v_mul_f32 v44, v44, v46
    v_cvt_pk_bf16_f32 v183, v44, v45
L_resc0_3:
    v_and_b32 v45, 0xffff0000, v168
    v_lshlrev_b32 v44, 16, v168
    v_mul_f32 v45, v45, v46
    v_mul_f32 v44, v44, v46
    v_cvt_pk_bf16_f32 v168, v44, v45
    v_and_b32 v45, 0xffff0000, v169
    v_lshlrev_b32 v44, 16, v169
    v_mul_f32 v45, v45, v46
    v_mul_f32 v44, v44, v46
    v_cvt_pk_bf16_f32 v169, v44, v45
    v_and_b32 v45, 0xffff0000, v170
    v_lshlrev_b32 v44, 16, v170
    v_mul_f32 v45, v45, v46
    v_mul_f32 v44, v44, v46
    v_cvt_pk_bf16_f32 v170, v44, v45
    v_and_b32 v45, 0xffff0000, v171
    v_lshlrev_b32 v44, 16, v171
    v_mul_f32 v45, v45, v46
    v_mul_f32 v44, v44, v46
    v_cvt_pk_bf16_f32 v171, v44, v45
    v_and_b32 v45, 0xffff0000, v172
    v_lshlrev_b32 v44, 16, v172
    v_mul_f32 v45, v45, v46
    v_mul_f32 v44, v44, v46
    v_cvt_pk_bf16_f32 v172, v44, v45
    v_and_b32 v45, 0xffff0000, v173
    v_lshlrev_b32 v44, 16, v173
    v_mul_f32 v45, v45, v46
    v_mul_f32 v44, v44, v46
    v_cvt_pk_bf16_f32 v173, v44, v45
    v_and_b32 v45, 0xffff0000, v174
    v_lshlrev_b32 v44, 16, v174
    v_mul_f32 v45, v45, v46
    v_mul_f32 v44, v44, v46
    v_cvt_pk_bf16_f32 v174, v44, v45
    v_and_b32 v45, 0xffff0000, v175
    v_lshlrev_b32 v44, 16, v175
    v_mul_f32 v45, v45, v46
    v_mul_f32 v44, v44, v46
    v_cvt_pk_bf16_f32 v175, v44, v45
L_resc0_2:
    v_and_b32 v45, 0xffff0000, v160
    v_lshlrev_b32 v44, 16, v160
    v_mul_f32 v45, v45, v46
    v_mul_f32 v44, v44, v46
    v_cvt_pk_bf16_f32 v160, v44, v45
    v_and_b32 v45, 0xffff0000, v161
    v_lshlrev_b32 v44, 16, v161
    v_mul_f32 v45, v45, v46
    v_mul_f32 v44, v44, v46
    v_cvt_pk_bf16_f32 v161, v44, v45
    v_and_b32 v45, 0xffff0000, v162
    v_lshlrev_b32 v44, 16, v162
    v_mul_f32 v45, v45, v46
    v_mul_f32 v44, v44, v46
    v_cvt_pk_bf16_f32 v162, v44, v45
    v_and_b32 v45, 0xffff0000, v163
    v_lshlrev_b32 v44, 16, v163
    v_mul_f32 v45, v45, v46
    v_mul_f32 v44, v44, v46
    v_cvt_pk_bf16_f32 v163, v44, v45
    v_and_b32 v45, 0xffff0000, v164
    v_lshlrev_b32 v44, 16, v164
    v_mul_f32 v45, v45, v46
    v_mul_f32 v44, v44, v46
    v_cvt_pk_bf16_f32 v164, v44, v45
    v_and_b32 v45, 0xffff0000, v165
    v_lshlrev_b32 v44, 16, v165
    v_mul_f32 v45, v45, v46
    v_mul_f32 v44, v44, v46
    v_cvt_pk_bf16_f32 v165, v44, v45
    v_and_b32 v45, 0xffff0000, v166
    v_lshlrev_b32 v44, 16, v166
    v_mul_f32 v45, v45, v46
    v_mul_f32 v44, v44, v46
    v_cvt_pk_bf16_f32 v166, v44, v45
    v_and_b32 v45, 0xffff0000, v167
    v_lshlrev_b32 v44, 16, v167
    v_mul_f32 v45, v45, v46
    v_mul_f32 v44, v44, v46
    v_cvt_pk_bf16_f32 v167, v44, v45
L_resc0_1:
    v_and_b32 v45, 0xffff0000, v152
    v_lshlrev_b32 v44, 16, v152
    v_mul_f32 v45, v45, v46
    v_mul_f32 v44, v44, v46
    v_cvt_pk_bf16_f32 v152, v44, v45
    v_and_b32 v45, 0xffff0000, v153
    v_lshlrev_b32 v44, 16, v153
    v_mul_f32 v45, v45, v46
    v_mul_f32 v44, v44, v46
    v_cvt_pk_bf16_f32 v153, v44, v45
    v_and_b32 v45, 0xffff0000, v154
    v_lshlrev_b32 v44, 16, v154
    v_mul_f32 v45, v45, v46
    v_mul_f32 v44, v44, v46
    v_cvt_pk_bf16_f32 v154, v44, v45
    v_and_b32 v45, 0xffff0000, v155
    v_lshlrev_b32 v44, 16, v155
    v_mul_f32 v45, v45, v46
    v_mul_f32 v44, v44, v46
    v_cvt_pk_bf16_f32 v155, v44, v45
    v_and_b32 v45, 0xffff0000, v156
    v_lshlrev_b32 v44, 16, v156
    v_mul_f32 v45, v45, v46
    v_mul_f32 v44, v44, v46
    v_cvt_pk_bf16_f32 v156, v44, v45
    v_and_b32 v45, 0xffff0000, v157
    v_lshlrev_b32 v44, 16, v157
    v_mul_f32 v45, v45, v46
    v_mul_f32 v44, v44, v46
    v_cvt_pk_bf16_f32 v157, v44, v45
    v_and_b32 v45, 0xffff0000, v158
    v_lshlrev_b32 v44, 16, v158
    v_mul_f32 v45, v45, v46
    v_mul_f32 v44, v44, v46
    v_cvt_pk_bf16_f32 v158, v44, v45
    v_and_b32 v45, 0xffff0000, v159
    v_lshlrev_b32 v44, 16, v159
    v_mul_f32 v45, v45, v46
    v_mul_f32 v44, v44, v46
    v_cvt_pk_bf16_f32 v159, v44, v45
L_resc0_0:
    v_and_b32 v45, 0xffff0000, v144
    v_lshlrev_b32 v44, 16, v144
    v_mul_f32 v45, v45, v46
    v_mul_f32 v44, v44, v46
    v_cvt_pk_bf16_f32 v144, v44, v45
    v_and_b32 v45, 0xffff0000, v145
    v_lshlrev_b32 v44, 16, v145
    v_mul_f32 v45, v45, v46
    v_mul_f32 v44, v44, v46
    v_cvt_pk_bf16_f32 v145, v44, v45
    v_and_b32 v45, 0xffff0000, v146
    v_lshlrev_b32 v44, 16, v146
    v_mul_f32 v45, v45, v46
    v_mul_f32 v44, v44, v46
    v_cvt_pk_bf16_f32 v146, v44, v45
    v_and_b32 v45, 0xffff0000, v147
    v_lshlrev_b32 v44, 16, v147
    v_mul_f32 v45, v45, v46
    v_mul_f32 v44, v44, v46
    v_cvt_pk_bf16_f32 v147, v44, v45
    v_and_b32 v45, 0xffff0000, v148
    v_lshlrev_b32 v44, 16, v148
    v_mul_f32 v45, v45, v46
    v_mul_f32 v44, v44, v46
    v_cvt_pk_bf16_f32 v148, v44, v45
    v_and_b32 v45, 0xffff0000, v149
    v_lshlrev_b32 v44, 16, v149
    v_mul_f32 v45, v45, v46
    v_mul_f32 v44, v44, v46
    v_cvt_pk_bf16_f32 v149, v44, v45
    v_and_b32 v45, 0xffff0000, v150
    v_lshlrev_b32 v44, 16, v150
    v_mul_f32 v45, v45, v46
    v_mul_f32 v44, v44, v46
    v_cvt_pk_bf16_f32 v150, v44, v45
    v_and_b32 v45, 0xffff0000, v151
    v_lshlrev_b32 v44, 16, v151
    v_mul_f32 v45, v45, v46
    v_mul_f32 v44, v44, v46
    v_cvt_pk_bf16_f32 v151, v44, v45
    s_setpc_b64 s[34:35]
L_resc1_10:
    v_and_b32 v45, 0xffff0000, v232
    v_lshlrev_b32 v44, 16, v232
    v_mul_f32 v45, v45, v46
    v_mul_f32 v44, v44, v46
    v_cvt_pk_bf16_f32 v232, v44, v45
    v_and_b32 v45, 0xffff0000, v233
    v_lshlrev_b32 v44, 16, v233
    v_mul_f32 v45, v45, v46
    v_mul_f32 v44, v44, v46
    v_cvt_pk_bf16_f32 v233, v44, v45
    v_and_b32 v45, 0xffff0000, v234
    v_lshlrev_b32 v44, 16, v234
    v_mul_f32 v45, v45, v46
    v_mul_f32 v44, v44, v46
    v_cvt_pk_bf16_f32 v234, v44, v45
    v_and_b32 v45, 0xffff0000, v235
    v_lshlrev_b32 v44, 16, v235
    v_mul_f32 v45, v45, v46
    v_mul_f32 v44, v44, v46
    v_cvt_pk_bf16_f32 v235, v44, v45
    v_and_b32 v45, 0xffff0000, v236
    v_lshlrev_b32 v44, 16, v236
    v_mul_f32 v45, v45, v46
    v_mul_f32 v44, v44, v46
    v_cvt_pk_bf16_f32 v236, v44, v45
    v_and_b32 v45, 0xffff0000, v237
    v_lshlrev_b32 v44, 16, v237
    v_mul_f32 v45, v45, v46
    v_mul_f32 v44, v44, v46
    v_cvt_pk_bf16_f32 v237, v44, v45
    v_and_b32 v45, 0xffff0000, v238
    v_lshlrev_b32 v44, 16, v238
    v_mul_f32 v45, v45, v46
    v_mul_f32 v44, v44, v46
    v_cvt_pk_bf16_f32 v238, v44, v45
    v_and_b32 v45, 0xffff0000, v239
    v_lshlrev_b32 v44, 16, v239
    v_mul_f32 v45, v45, v46
    v_mul_f32 v44, v44, v46
    v_cvt_pk_bf16_f32 v239, v44, v45
L_resc1_9:
    v_accvgpr_read_b32 v44, a232
    v_and_b32 v45, 0xffff0000, v44
    v_lshlrev_b32 v44, 16, v44
    v_mul_f32 v45, v45, v46
    v_mul_f32 v44, v44, v46
    v_cvt_pk_bf16_f32 v44, v44, v45
    v_accvgpr_write_b32 a232, v44
    v_accvgpr_read_b32 v44, a233
    v_and_b32 v45, 0xffff0000, v44
    v_lshlrev_b32 v44, 16, v44
    v_mul_f32 v45, v45, v46
    v_mul_f32 v44, v44, v46
    v_cvt_pk_bf16_f32 v44, v44, v45
    v_accvgpr_write_b32 a233, v44
    v_accvgpr_read_b32 v44, a234
    v_and_b32 v45, 0xffff0000, v44
    v_lshlrev_b32 v44, 16, v44
    v_mul_f32 v45, v45, v46
    v_mul_f32 v44, v44, v46
    v_cvt_pk_bf16_f32 v44, v44, v45
    v_accvgpr_write_b32 a234, v44
    v_accvgpr_read_b32 v44, a235
    v_and_b32 v45, 0xffff0000, v44
    v_lshlrev_b32 v44, 16, v44
    v_mul_f32 v45, v45, v46
    v_mul_f32 v44, v44, v46
    v_cvt_pk_bf16_f32 v44, v44, v45
    v_accvgpr_write_b32 a235, v44
    v_accvgpr_read_b32 v44, a236
    v_and_b32 v45, 0xffff0000, v44
    v_lshlrev_b32 v44, 16, v44
    v_mul_f32 v45, v45, v46
    v_mul_f32 v44, v44, v46
    v_cvt_pk_bf16_f32 v44, v44, v45
    v_accvgpr_write_b32 a236, v44
    v_accvgpr_read_b32 v44, a237
    v_and_b32 v45, 0xffff0000, v44
    v_lshlrev_b32 v44, 16, v44
    v_mul_f32 v45, v45, v46
    v_mul_f32 v44, v44, v46
    v_cvt_pk_bf16_f32 v44, v44, v45
    v_accvgpr_write_b32 a237, v44
    v_accvgpr_read_b32 v44, a238
    v_and_b32 v45, 0xffff0000, v44
    v_lshlrev_b32 v44, 16, v44
    v_mul_f32 v45, v45, v46
    v_mul_f32 v44, v44, v46
    v_cvt_pk_bf16_f32 v44, v44, v45
    v_accvgpr_write_b32 a238, v44
    v_accvgpr_read_b32 v44, a239
    v_and_b32 v45, 0xffff0000, v44
    v_lshlrev_b32 v44, 16, v44
    v_mul_f32 v45, v45, v46
    v_mul_f32 v44, v44, v46
    v_cvt_pk_bf16_f32 v44, v44, v45
    v_accvgpr_write_b32 a239, v44
L_resc1_8:
    v_accvgpr_read_b32 v44, a216
    v_and_b32 v45, 0xffff0000, v44
    v_lshlrev_b32 v44, 16, v44
    v_mul_f32 v45, v45, v46
    v_mul_f32 v44, v44, v46
    v_cvt_pk_bf16_f32 v44, v44, v45
    v_accvgpr_write_b32 a216, v44
    v_accvgpr_read_b32 v44, a217
    v_and_b32 v45, 0xffff0000, v44
    v_lshlrev_b32 v44, 16, v44
    v_mul_f32 v45, v45, v46
    v_mul_f32 v44, v44, v46
    v_cvt_pk_bf16_f32 v44, v44, v45
    v_accvgpr_write_b32 a217, v44
    v_accvgpr_read_b32 v44, a218
    v_and_b32 v45, 0xffff0000, v44
    v_lshlrev_b32 v44, 16, v44
    v_mul_f32 v45, v45, v46
    v_mul_f32 v44, v44, v46
    v_cvt_pk_bf16_f32 v44, v44, v45
    v_accvgpr_write_b32 a218, v44
    v_accvgpr_read_b32 v44, a219
    v_and_b32 v45, 0xffff0000, v44
    v_lshlrev_b32 v44, 16, v44
    v_mul_f32 v45, v45, v46
    v_mul_f32 v44, v44, v46
    v_cvt_pk_bf16_f32 v44, v44, v45
    v_accvgpr_write_b32 a219, v44
    v_accvgpr_read_b32 v44, a220
    v_and_b32 v45, 0xffff0000, v44
    v_lshlrev_b32 v44, 16, v44
    v_mul_f32 v45, v45, v46
    v_mul_f32 v44, v44, v46
    v_cvt_pk_bf16_f32 v44, v44, v45
    v_accvgpr_write_b32 a220, v44
    v_accvgpr_read_b32 v44, a221
    v_and_b32 v45, 0xffff0000, v44
    v_lshlrev_b32 v44, 16, v44
    v_mul_f32 v45, v45, v46
    v_mul_f32 v44, v44, v46
    v_cvt_pk_bf16_f32 v44, v44, v45
    v_accvgpr_write_b32 a221, v44
    v_accvgpr_read_b32 v44, a222
    v_and_b32 v45, 0xffff0000, v44
    v_lshlrev_b32 v44, 16, v44
    v_mul_f32 v45, v45, v46
    v_mul_f32 v44, v44, v46
    v_cvt_pk_bf16_f32 v44, v44, v45
    v_accvgpr_write_b32 a222, v44
    v_accvgpr_read_b32 v44, a223
    v_and_b32 v45, 0xffff0000, v44
    v_lshlrev_b32 v44, 16, v44
    v_mul_f32 v45, v45, v46
    v_mul_f32 v44, v44, v46
    v_cvt_pk_bf16_f32 v44, v44, v45
    v_accvgpr_write_b32 a223, v44
L_resc1_7:
    v_accvgpr_read_b32 v44, a200
    v_and_b32 v45, 0xffff0000, v44
    v_lshlrev_b32 v44, 16, v44
    v_mul_f32 v45, v45, v46
    v_mul_f32 v44, v44, v46
    v_cvt_pk_bf16_f32 v44, v44, v45
    v_accvgpr_write_b32 a200, v44
    v_accvgpr_read_b32 v44, a201
    v_and_b32 v45, 0xffff0000, v44
    v_lshlrev_b32 v44, 16, v44
    v_mul_f32 v45, v45, v46
    v_mul_f32 v44, v44, v46
    v_cvt_pk_bf16_f32 v44, v44, v45
    v_accvgpr_write_b32 a201, v44
    v_accvgpr_read_b32 v44, a202
    v_and_b32 v45, 0xffff0000, v44
    v_lshlrev_b32 v44, 16, v44
    v_mul_f32 v45, v45, v46
    v_mul_f32 v44, v44, v46
    v_cvt_pk_bf16_f32 v44, v44, v45
    v_accvgpr_write_b32 a202, v44
    v_accvgpr_read_b32 v44, a203
    v_and_b32 v45, 0xffff0000, v44
    v_lshlrev_b32 v44, 16, v44
    v_mul_f32 v45, v45, v46
    v_mul_f32 v44, v44, v46
    v_cvt_pk_bf16_f32 v44, v44, v45
    v_accvgpr_write_b32 a203, v44
    v_accvgpr_read_b32 v44, a204
    v_and_b32 v45, 0xffff0000, v44
    v_lshlrev_b32 v44, 16, v44
    v_mul_f32 v45, v45, v46
    v_mul_f32 v44, v44, v46
    v_cvt_pk_bf16_f32 v44, v44, v45
    v_accvgpr_write_b32 a204, v44
    v_accvgpr_read_b32 v44, a205
    v_and_b32 v45, 0xffff0000, v44
    v_lshlrev_b32 v44, 16, v44
    v_mul_f32 v45, v45, v46
    v_mul_f32 v44, v44, v46
    v_cvt_pk_bf16_f32 v44, v44, v45
    v_accvgpr_write_b32 a205, v44
    v_accvgpr_read_b32 v44, a206
    v_and_b32 v45, 0xffff0000, v44
    v_lshlrev_b32 v44, 16, v44
    v_mul_f32 v45, v45, v46
    v_mul_f32 v44, v44, v46
    v_cvt_pk_bf16_f32 v44, v44, v45
    v_accvgpr_write_b32 a206, v44
    v_accvgpr_read_b32 v44, a207
    v_and_b32 v45, 0xffff0000, v44
    v_lshlrev_b32 v44, 16, v44
    v_mul_f32 v45, v45, v46
    v_mul_f32 v44, v44, v46
    v_cvt_pk_bf16_f32 v44, v44, v45
    v_accvgpr_write_b32 a207, v44
L_resc1_6:
    v_accvgpr_read_b32 v44, a184
    v_and_b32 v45, 0xffff0000, v44
    v_lshlrev_b32 v44, 16, v44
    v_mul_f32 v45, v45, v46
    v_mul_f32 v44, v44, v46
    v_cvt_pk_bf16_f32 v44, v44, v45
    v_accvgpr_write_b32 a184, v44
    v_accvgpr_read_b32 v44, a185
    v_and_b32 v45, 0xffff0000, v44
    v_lshlrev_b32 v44, 16, v44
    v_mul_f32 v45, v45, v46
    v_mul_f32 v44, v44, v46
    v_cvt_pk_bf16_f32 v44, v44, v45
    v_accvgpr_write_b32 a185, v44
    v_accvgpr_read_b32 v44, a186
    v_and_b32 v45, 0xffff0000, v44
    v_lshlrev_b32 v44, 16, v44
    v_mul_f32 v45, v45, v46
    v_mul_f32 v44, v44, v46
    v_cvt_pk_bf16_f32 v44, v44, v45
    v_accvgpr_write_b32 a186, v44
    v_accvgpr_read_b32 v44, a187
    v_and_b32 v45, 0xffff0000, v44
    v_lshlrev_b32 v44, 16, v44
    v_mul_f32 v45, v45, v46
    v_mul_f32 v44, v44, v46
    v_cvt_pk_bf16_f32 v44, v44, v45
    v_accvgpr_write_b32 a187, v44
    v_accvgpr_read_b32 v44, a188
    v_and_b32 v45, 0xffff0000, v44
    v_lshlrev_b32 v44, 16, v44
    v_mul_f32 v45, v45, v46
    v_mul_f32 v44, v44, v46
    v_cvt_pk_bf16_f32 v44, v44, v45
    v_accvgpr_write_b32 a188, v44
    v_accvgpr_read_b32 v44, a189
    v_and_b32 v45, 0xffff0000, v44
    v_lshlrev_b32 v44, 16, v44
    v_mul_f32 v45, v45, v46
    v_mul_f32 v44, v44, v46
    v_cvt_pk_bf16_f32 v44, v44, v45
    v_accvgpr_write_b32 a189, v44
    v_accvgpr_read_b32 v44, a190
    v_and_b32 v45, 0xffff0000, v44
    v_lshlrev_b32 v44, 16, v44
    v_mul_f32 v45, v45, v46
    v_mul_f32 v44, v44, v46
    v_cvt_pk_bf16_f32 v44, v44, v45
    v_accvgpr_write_b32 a190, v44
    v_accvgpr_read_b32 v44, a191
    v_and_b32 v45, 0xffff0000, v44
    v_lshlrev_b32 v44, 16, v44
    v_mul_f32 v45, v45, v46
    v_mul_f32 v44, v44, v46
    v_cvt_pk_bf16_f32 v44, v44, v45
    v_accvgpr_write_b32 a191, v44
L_resc1_5:
    v_accvgpr_read_b32 v44, a168
    v_and_b32 v45, 0xffff0000, v44
    v_lshlrev_b32 v44, 16, v44
    v_mul_f32 v45, v45, v46
    v_mul_f32 v44, v44, v46
    v_cvt_pk_bf16_f32 v44, v44, v45
    v_accvgpr_write_b32 a168, v44
    v_accvgpr_read_b32 v44, a169
    v_and_b32 v45, 0xffff0000, v44
    v_lshlrev_b32 v44, 16, v44
    v_mul_f32 v45, v45, v46
    v_mul_f32 v44, v44, v46
    v_cvt_pk_bf16_f32 v44, v44, v45
    v_accvgpr_write_b32 a169, v44
    v_accvgpr_read_b32 v44, a170
    v_and_b32 v45, 0xffff0000, v44
    v_lshlrev_b32 v44, 16, v44
    v_mul_f32 v45, v45, v46
    v_mul_f32 v44, v44, v46
    v_cvt_pk_bf16_f32 v44, v44, v45
    v_accvgpr_write_b32 a170, v44
    v_accvgpr_read_b32 v44, a171
    v_and_b32 v45, 0xffff0000, v44
    v_lshlrev_b32 v44, 16, v44
    v_mul_f32 v45, v45, v46
    v_mul_f32 v44, v44, v46
    v_cvt_pk_bf16_f32 v44, v44, v45
    v_accvgpr_write_b32 a171, v44
    v_accvgpr_read_b32 v44, a172
    v_and_b32 v45, 0xffff0000, v44
    v_lshlrev_b32 v44, 16, v44
    v_mul_f32 v45, v45, v46
    v_mul_f32 v44, v44, v46
    v_cvt_pk_bf16_f32 v44, v44, v45
    v_accvgpr_write_b32 a172, v44
    v_accvgpr_read_b32 v44, a173
    v_and_b32 v45, 0xffff0000, v44
    v_lshlrev_b32 v44, 16, v44
    v_mul_f32 v45, v45, v46
    v_mul_f32 v44, v44, v46
    v_cvt_pk_bf16_f32 v44, v44, v45
    v_accvgpr_write_b32 a173, v44
    v_accvgpr_read_b32 v44, a174
    v_and_b32 v45, 0xffff0000, v44
    v_lshlrev_b32 v44, 16, v44
    v_mul_f32 v45, v45, v46
    v_mul_f32 v44, v44, v46
    v_cvt_pk_bf16_f32 v44, v44, v45
    v_accvgpr_write_b32 a174, v44
    v_accvgpr_read_b32 v44, a175
    v_and_b32 v45, 0xffff0000, v44
    v_lshlrev_b32 v44, 16, v44
    v_mul_f32 v45, v45, v46
    v_mul_f32 v44, v44, v46
    v_cvt_pk_bf16_f32 v44, v44, v45
    v_accvgpr_write_b32 a175, v44
L_resc1_4:
    v_accvgpr_read_b32 v44, a152
    v_and_b32 v45, 0xffff0000, v44
    v_lshlrev_b32 v44, 16, v44
    v_mul_f32 v45, v45, v46
    v_mul_f32 v44, v44, v46
    v_cvt_pk_bf16_f32 v44, v44, v45
    v_accvgpr_write_b32 a152, v44
    v_accvgpr_read_b32 v44, a153
    v_and_b32 v45, 0xffff0000, v44
    v_lshlrev_b32 v44, 16, v44
    v_mul_f32 v45, v45, v46
    v_mul_f32 v44, v44, v46
    v_cvt_pk_bf16_f32 v44, v44, v45
    v_accvgpr_write_b32 a153, v44
    v_accvgpr_read_b32 v44, a154
    v_and_b32 v45, 0xffff0000, v44
    v_lshlrev_b32 v44, 16, v44
    v_mul_f32 v45, v45, v46
    v_mul_f32 v44, v44, v46
    v_cvt_pk_bf16_f32 v44, v44, v45
    v_accvgpr_write_b32 a154, v44
    v_accvgpr_read_b32 v44, a155
    v_and_b32 v45, 0xffff0000, v44
    v_lshlrev_b32 v44, 16, v44
    v_mul_f32 v45, v45, v46
    v_mul_f32 v44, v44, v46
    v_cvt_pk_bf16_f32 v44, v44, v45
    v_accvgpr_write_b32 a155, v44
    v_accvgpr_read_b32 v44, a156
    v_and_b32 v45, 0xffff0000, v44
    v_lshlrev_b32 v44, 16, v44
    v_mul_f32 v45, v45, v46
    v_mul_f32 v44, v44, v46
    v_cvt_pk_bf16_f32 v44, v44, v45
    v_accvgpr_write_b32 a156, v44
    v_accvgpr_read_b32 v44, a157
    v_and_b32 v45, 0xffff0000, v44
    v_lshlrev_b32 v44, 16, v44
    v_mul_f32 v45, v45, v46
    v_mul_f32 v44, v44, v46
    v_cvt_pk_bf16_f32 v44, v44, v45
    v_accvgpr_write_b32 a157, v44
    v_accvgpr_read_b32 v44, a158
    v_and_b32 v45, 0xffff0000, v44
    v_lshlrev_b32 v44, 16, v44
    v_mul_f32 v45, v45, v46
    v_mul_f32 v44, v44, v46
    v_cvt_pk_bf16_f32 v44, v44, v45
    v_accvgpr_write_b32 a158, v44
    v_accvgpr_read_b32 v44, a159
    v_and_b32 v45, 0xffff0000, v44
    v_lshlrev_b32 v44, 16, v44
    v_mul_f32 v45, v45, v46
    v_mul_f32 v44, v44, v46
    v_cvt_pk_bf16_f32 v44, v44, v45
    v_accvgpr_write_b32 a159, v44
L_resc1_3:
    v_accvgpr_read_b32 v44, a136
    v_and_b32 v45, 0xffff0000, v44
    v_lshlrev_b32 v44, 16, v44
    v_mul_f32 v45, v45, v46
    v_mul_f32 v44, v44, v46
    v_cvt_pk_bf16_f32 v44, v44, v45
    v_accvgpr_write_b32 a136, v44
    v_accvgpr_read_b32 v44, a137
    v_and_b32 v45, 0xffff0000, v44
    v_lshlrev_b32 v44, 16, v44
    v_mul_f32 v45, v45, v46
    v_mul_f32 v44, v44, v46
    v_cvt_pk_bf16_f32 v44, v44, v45
    v_accvgpr_write_b32 a137, v44
    v_accvgpr_read_b32 v44, a138
    v_and_b32 v45, 0xffff0000, v44
    v_lshlrev_b32 v44, 16, v44
    v_mul_f32 v45, v45, v46
    v_mul_f32 v44, v44, v46
    v_cvt_pk_bf16_f32 v44, v44, v45
    v_accvgpr_write_b32 a138, v44
    v_accvgpr_read_b32 v44, a139
    v_and_b32 v45, 0xffff0000, v44
    v_lshlrev_b32 v44, 16, v44
    v_mul_f32 v45, v45, v46
    v_mul_f32 v44, v44, v46
    v_cvt_pk_bf16_f32 v44, v44, v45
    v_accvgpr_write_b32 a139, v44
    v_accvgpr_read_b32 v44, a140
    v_and_b32 v45, 0xffff0000, v44
    v_lshlrev_b32 v44, 16, v44
    v_mul_f32 v45, v45, v46
    v_mul_f32 v44, v44, v46
    v_cvt_pk_bf16_f32 v44, v44, v45
    v_accvgpr_write_b32 a140, v44
    v_accvgpr_read_b32 v44, a141
    v_and_b32 v45, 0xffff0000, v44
    v_lshlrev_b32 v44, 16, v44
    v_mul_f32 v45, v45, v46
    v_mul_f32 v44, v44, v46
    v_cvt_pk_bf16_f32 v44, v44, v45
    v_accvgpr_write_b32 a141, v44
    v_accvgpr_read_b32 v44, a142
    v_and_b32 v45, 0xffff0000, v44
    v_lshlrev_b32 v44, 16, v44
    v_mul_f32 v45, v45, v46
    v_mul_f32 v44, v44, v46
    v_cvt_pk_bf16_f32 v44, v44, v45
    v_accvgpr_write_b32 a142, v44
    v_accvgpr_read_b32 v44, a143
    v_and_b32 v45, 0xffff0000, v44
    v_lshlrev_b32 v44, 16, v44
    v_mul_f32 v45, v45, v46
    v_mul_f32 v44, v44, v46
    v_cvt_pk_bf16_f32 v44, v44, v45
    v_accvgpr_write_b32 a143, v44
L_resc1_2:
    v_accvgpr_read_b32 v44, a120
    v_and_b32 v45, 0xffff0000, v44
    v_lshlrev_b32 v44, 16, v44
    v_mul_f32 v45, v45, v46
    v_mul_f32 v44, v44, v46
    v_cvt_pk_bf16_f32 v44, v44, v45
    v_accvgpr_write_b32 a120, v44
    v_accvgpr_read_b32 v44, a121
    v_and_b32 v45, 0xffff0000, v44
    v_lshlrev_b32 v44, 16, v44
    v_mul_f32 v45, v45, v46
    v_mul_f32 v44, v44, v46
    v_cvt_pk_bf16_f32 v44, v44, v45
    v_accvgpr_write_b32 a121, v44
    v_accvgpr_read_b32 v44, a122
    v_and_b32 v45, 0xffff0000, v44
    v_lshlrev_b32 v44, 16, v44
    v_mul_f32 v45, v45, v46
    v_mul_f32 v44, v44, v46
    v_cvt_pk_bf16_f32 v44, v44, v45
    v_accvgpr_write_b32 a122, v44
    v_accvgpr_read_b32 v44, a123
    v_and_b32 v45, 0xffff0000, v44
    v_lshlrev_b32 v44, 16, v44
    v_mul_f32 v45, v45, v46
    v_mul_f32 v44, v44, v46
    v_cvt_pk_bf16_f32 v44, v44, v45
    v_accvgpr_write_b32 a123, v44
    v_accvgpr_read_b32 v44, a124
    v_and_b32 v45, 0xffff0000, v44
    v_lshlrev_b32 v44, 16, v44
    v_mul_f32 v45, v45, v46
    v_mul_f32 v44, v44, v46
    v_cvt_pk_bf16_f32 v44, v44, v45
    v_accvgpr_write_b32 a124, v44
    v_accvgpr_read_b32 v44, a125
    v_and_b32 v45, 0xffff0000, v44
    v_lshlrev_b32 v44, 16, v44
    v_mul_f32 v45, v45, v46
    v_mul_f32 v44, v44, v46
    v_cvt_pk_bf16_f32 v44, v44, v45
    v_accvgpr_write_b32 a125, v44
    v_accvgpr_read_b32 v44, a126
    v_and_b32 v45, 0xffff0000, v44
    v_lshlrev_b32 v44, 16, v44
    v_mul_f32 v45, v45, v46
    v_mul_f32 v44, v44, v46
    v_cvt_pk_bf16_f32 v44, v44, v45
    v_accvgpr_write_b32 a126, v44
    v_accvgpr_read_b32 v44, a127
    v_and_b32 v45, 0xffff0000, v44
    v_lshlrev_b32 v44, 16, v44
    v_mul_f32 v45, v45, v46
    v_mul_f32 v44, v44, v46
    v_cvt_pk_bf16_f32 v44, v44, v45
    v_accvgpr_write_b32 a127, v44
L_resc1_1:
    v_accvgpr_read_b32 v44, a104
    v_and_b32 v45, 0xffff0000, v44
    v_lshlrev_b32 v44, 16, v44
    v_mul_f32 v45, v45, v46
    v_mul_f32 v44, v44, v46
    v_cvt_pk_bf16_f32 v44, v44, v45
    v_accvgpr_write_b32 a104, v44
    v_accvgpr_read_b32 v44, a105
    v_and_b32 v45, 0xffff0000, v44
    v_lshlrev_b32 v44, 16, v44
    v_mul_f32 v45, v45, v46
    v_mul_f32 v44, v44, v46
    v_cvt_pk_bf16_f32 v44, v44, v45
    v_accvgpr_write_b32 a105, v44
    v_accvgpr_read_b32 v44, a106
    v_and_b32 v45, 0xffff0000, v44
    v_lshlrev_b32 v44, 16, v44
    v_mul_f32 v45, v45, v46
    v_mul_f32 v44, v44, v46
    v_cvt_pk_bf16_f32 v44, v44, v45
    v_accvgpr_write_b32 a106, v44
    v_accvgpr_read_b32 v44, a107
    v_and_b32 v45, 0xffff0000, v44
    v_lshlrev_b32 v44, 16, v44
    v_mul_f32 v45, v45, v46
    v_mul_f32 v44, v44, v46
    v_cvt_pk_bf16_f32 v44, v44, v45
    v_accvgpr_write_b32 a107, v44
    v_accvgpr_read_b32 v44, a108
    v_and_b32 v45, 0xffff0000, v44
    v_lshlrev_b32 v44, 16, v44
    v_mul_f32 v45, v45, v46
    v_mul_f32 v44, v44, v46
    v_cvt_pk_bf16_f32 v44, v44, v45
    v_accvgpr_write_b32 a108, v44
    v_accvgpr_read_b32 v44, a109
    v_and_b32 v45, 0xffff0000, v44
    v_lshlrev_b32 v44, 16, v44
    v_mul_f32 v45, v45, v46
    v_mul_f32 v44, v44, v46
    v_cvt_pk_bf16_f32 v44, v44, v45
    v_accvgpr_write_b32 a109, v44
    v_accvgpr_read_b32 v44, a110
    v_and_b32 v45, 0xffff0000, v44
    v_lshlrev_b32 v44, 16, v44
    v_mul_f32 v45, v45, v46
    v_mul_f32 v44, v44, v46
    v_cvt_pk_bf16_f32 v44, v44, v45
    v_accvgpr_write_b32 a110, v44
    v_accvgpr_read_b32 v44, a111
    v_and_b32 v45, 0xffff0000, v44
    v_lshlrev_b32 v44, 16, v44
    v_mul_f32 v45, v45, v46
    v_mul_f32 v44, v44, v46
    v_cvt_pk_bf16_f32 v44, v44, v45
    v_accvgpr_write_b32 a111, v44
L_resc1_0:
    v_accvgpr_read_b32 v44, a88
    v_and_b32 v45, 0xffff0000, v44
    v_lshlrev_b32 v44, 16, v44
    v_mul_f32 v45, v45, v46
    v_mul_f32 v44, v44, v46
    v_cvt_pk_bf16_f32 v44, v44, v45
    v_accvgpr_write_b32 a88, v44
    v_accvgpr_read_b32 v44, a89
    v_and_b32 v45, 0xffff0000, v44
    v_lshlrev_b32 v44, 16, v44
    v_mul_f32 v45, v45, v46
    v_mul_f32 v44, v44, v46
    v_cvt_pk_bf16_f32 v44, v44, v45
    v_accvgpr_write_b32 a89, v44
    v_accvgpr_read_b32 v44, a90
    v_and_b32 v45, 0xffff0000, v44
    v_lshlrev_b32 v44, 16, v44
    v_mul_f32 v45, v45, v46
    v_mul_f32 v44, v44, v46
    v_cvt_pk_bf16_f32 v44, v44, v45
    v_accvgpr_write_b32 a90, v44
    v_accvgpr_read_b32 v44, a91
    v_and_b32 v45, 0xffff0000, v44
    v_lshlrev_b32 v44, 16, v44
    v_mul_f32 v45, v45, v46
    v_mul_f32 v44, v44, v46
    v_cvt_pk_bf16_f32 v44, v44, v45
    v_accvgpr_write_b32 a91, v44
    v_accvgpr_read_b32 v44, a92
    v_and_b32 v45, 0xffff0000, v44
    v_lshlrev_b32 v44, 16, v44
    v_mul_f32 v45, v45, v46
    v_mul_f32 v44, v44, v46
    v_cvt_pk_bf16_f32 v44, v44, v45
    v_accvgpr_write_b32 a92, v44
    v_accvgpr_read_b32 v44, a93
    v_and_b32 v45, 0xffff0000, v44
    v_lshlrev_b32 v44, 16, v44
    v_mul_f32 v45, v45, v46
    v_mul_f32 v44, v44, v46
    v_cvt_pk_bf16_f32 v44, v44, v45
    v_accvgpr_write_b32 a93, v44
    v_accvgpr_read_b32 v44, a94
    v_and_b32 v45, 0xffff0000, v44
    v_lshlrev_b32 v44, 16, v44
    v_mul_f32 v45, v45, v46
    v_mul_f32 v44, v44, v46
    v_cvt_pk_bf16_f32 v44, v44, v45
    v_accvgpr_write_b32 a94, v44
    v_accvgpr_read_b32 v44, a95
    v_and_b32 v45, 0xffff0000, v44
    v_lshlrev_b32 v44, 16, v44
    v_mul_f32 v45, v45, v46
    v_mul_f32 v44, v44, v46
    v_cvt_pk_bf16_f32 v44, v44, v45
    v_accvgpr_write_b32 a95, v44
    s_setpc_b64 s[34:35]
L_resc2_10:
    v_accvgpr_read_b32 v44, a240
    v_and_b32 v45, 0xffff0000, v44
    v_lshlrev_b32 v44, 16, v44
    v_mul_f32 v45, v45, v46
    v_mul_f32 v44, v44, v46
    v_cvt_pk_bf16_f32 v44, v44, v45
    v_accvgpr_write_b32 a240, v44
    v_accvgpr_read_b32 v44, a241
    v_and_b32 v45, 0xffff0000, v44
    v_lshlrev_b32 v44, 16, v44
    v_mul_f32 v45, v45, v46
    v_mul_f32 v44, v44, v46
    v_cvt_pk_bf16_f32 v44, v44, v45
    v_accvgpr_write_b32 a241, v44
    v_accvgpr_read_b32 v44, a242
    v_and_b32 v45, 0xffff0000, v44
    v_lshlrev_b32 v44, 16, v44
    v_mul_f32 v45, v45, v46
    v_mul_f32 v44, v44, v46
    v_cvt_pk_bf16_f32 v44, v44, v45
    v_accvgpr_write_b32 a242, v44
    v_accvgpr_read_b32 v44, a243
    v_and_b32 v45, 0xffff0000, v44
    v_lshlrev_b32 v44, 16, v44
    v_mul_f32 v45, v45, v46
    v_mul_f32 v44, v44, v46
    v_cvt_pk_bf16_f32 v44, v44, v45
    v_accvgpr_write_b32 a243, v44
    v_accvgpr_read_b32 v44, a244
    v_and_b32 v45, 0xffff0000, v44
    v_lshlrev_b32 v44, 16, v44
    v_mul_f32 v45, v45, v46
    v_mul_f32 v44, v44, v46
    v_cvt_pk_bf16_f32 v44, v44, v45
    v_accvgpr_write_b32 a244, v44
    v_accvgpr_read_b32 v44, a245
    v_and_b32 v45, 0xffff0000, v44
    v_lshlrev_b32 v44, 16, v44
    v_mul_f32 v45, v45, v46
    v_mul_f32 v44, v44, v46
    v_cvt_pk_bf16_f32 v44, v44, v45
    v_accvgpr_write_b32 a245, v44
    v_accvgpr_read_b32 v44, a246
    v_and_b32 v45, 0xffff0000, v44
    v_lshlrev_b32 v44, 16, v44
    v_mul_f32 v45, v45, v46
    v_mul_f32 v44, v44, v46
    v_cvt_pk_bf16_f32 v44, v44, v45
    v_accvgpr_write_b32 a246, v44
    v_accvgpr_read_b32 v44, a247
    v_and_b32 v45, 0xffff0000, v44
    v_lshlrev_b32 v44, 16, v44
    v_mul_f32 v45, v45, v46
    v_mul_f32 v44, v44, v46
    v_cvt_pk_bf16_f32 v44, v44, v45
    v_accvgpr_write_b32 a247, v44
L_resc2_9:
    v_accvgpr_read_b32 v44, a224
    v_and_b32 v45, 0xffff0000, v44
    v_lshlrev_b32 v44, 16, v44
    v_mul_f32 v45, v45, v46
    v_mul_f32 v44, v44, v46
    v_cvt_pk_bf16_f32 v44, v44, v45
    v_accvgpr_write_b32 a224, v44
    v_accvgpr_read_b32 v44, a225
    v_and_b32 v45, 0xffff0000, v44
    v_lshlrev_b32 v44, 16, v44
    v_mul_f32 v45, v45, v46
    v_mul_f32 v44, v44, v46
    v_cvt_pk_bf16_f32 v44, v44, v45
    v_accvgpr_write_b32 a225, v44
    v_accvgpr_read_b32 v44, a226
    v_and_b32 v45, 0xffff0000, v44
    v_lshlrev_b32 v44, 16, v44
    v_mul_f32 v45, v45, v46
    v_mul_f32 v44, v44, v46
    v_cvt_pk_bf16_f32 v44, v44, v45
    v_accvgpr_write_b32 a226, v44
    v_accvgpr_read_b32 v44, a227
    v_and_b32 v45, 0xffff0000, v44
    v_lshlrev_b32 v44, 16, v44
    v_mul_f32 v45, v45, v46
    v_mul_f32 v44, v44, v46
    v_cvt_pk_bf16_f32 v44, v44, v45
    v_accvgpr_write_b32 a227, v44
    v_accvgpr_read_b32 v44, a228
    v_and_b32 v45, 0xffff0000, v44
    v_lshlrev_b32 v44, 16, v44
    v_mul_f32 v45, v45, v46
    v_mul_f32 v44, v44, v46
    v_cvt_pk_bf16_f32 v44, v44, v45
    v_accvgpr_write_b32 a228, v44
    v_accvgpr_read_b32 v44, a229
    v_and_b32 v45, 0xffff0000, v44
    v_lshlrev_b32 v44, 16, v44
    v_mul_f32 v45, v45, v46
    v_mul_f32 v44, v44, v46
    v_cvt_pk_bf16_f32 v44, v44, v45
    v_accvgpr_write_b32 a229, v44
    v_accvgpr_read_b32 v44, a230
    v_and_b32 v45, 0xffff0000, v44
    v_lshlrev_b32 v44, 16, v44
    v_mul_f32 v45, v45, v46
    v_mul_f32 v44, v44, v46
    v_cvt_pk_bf16_f32 v44, v44, v45
    v_accvgpr_write_b32 a230, v44
    v_accvgpr_read_b32 v44, a231
    v_and_b32 v45, 0xffff0000, v44
    v_lshlrev_b32 v44, 16, v44
    v_mul_f32 v45, v45, v46
    v_mul_f32 v44, v44, v46
    v_cvt_pk_bf16_f32 v44, v44, v45
    v_accvgpr_write_b32 a231, v44
L_resc2_8:
    v_accvgpr_read_b32 v44, a208
    v_and_b32 v45, 0xffff0000, v44
    v_lshlrev_b32 v44, 16, v44
    v_mul_f32 v45, v45, v46
    v_mul_f32 v44, v44, v46
    v_cvt_pk_bf16_f32 v44, v44, v45
    v_accvgpr_write_b32 a208, v44
    v_accvgpr_read_b32 v44, a209
    v_and_b32 v45, 0xffff0000, v44
    v_lshlrev_b32 v44, 16, v44
    v_mul_f32 v45, v45, v46
    v_mul_f32 v44, v44, v46
    v_cvt_pk_bf16_f32 v44, v44, v45
    v_accvgpr_write_b32 a209, v44
    v_accvgpr_read_b32 v44, a210
    v_and_b32 v45, 0xffff0000, v44
    v_lshlrev_b32 v44, 16, v44
    v_mul_f32 v45, v45, v46
    v_mul_f32 v44, v44, v46
    v_cvt_pk_bf16_f32 v44, v44, v45
    v_accvgpr_write_b32 a210, v44
    v_accvgpr_read_b32 v44, a211
    v_and_b32 v45, 0xffff0000, v44
    v_lshlrev_b32 v44, 16, v44
    v_mul_f32 v45, v45, v46
    v_mul_f32 v44, v44, v46
    v_cvt_pk_bf16_f32 v44, v44, v45
    v_accvgpr_write_b32 a211, v44
    v_accvgpr_read_b32 v44, a212
    v_and_b32 v45, 0xffff0000, v44
    v_lshlrev_b32 v44, 16, v44
    v_mul_f32 v45, v45, v46
    v_mul_f32 v44, v44, v46
    v_cvt_pk_bf16_f32 v44, v44, v45
    v_accvgpr_write_b32 a212, v44
    v_accvgpr_read_b32 v44, a213
    v_and_b32 v45, 0xffff0000, v44
    v_lshlrev_b32 v44, 16, v44
    v_mul_f32 v45, v45, v46
    v_mul_f32 v44, v44, v46
    v_cvt_pk_bf16_f32 v44, v44, v45
    v_accvgpr_write_b32 a213, v44
    v_accvgpr_read_b32 v44, a214
    v_and_b32 v45, 0xffff0000, v44
    v_lshlrev_b32 v44, 16, v44
    v_mul_f32 v45, v45, v46
    v_mul_f32 v44, v44, v46
    v_cvt_pk_bf16_f32 v44, v44, v45
    v_accvgpr_write_b32 a214, v44
    v_accvgpr_read_b32 v44, a215
    v_and_b32 v45, 0xffff0000, v44
    v_lshlrev_b32 v44, 16, v44
    v_mul_f32 v45, v45, v46
    v_mul_f32 v44, v44, v46
    v_cvt_pk_bf16_f32 v44, v44, v45
    v_accvgpr_write_b32 a215, v44
L_resc2_7:
    v_accvgpr_read_b32 v44, a192
    v_and_b32 v45, 0xffff0000, v44
    v_lshlrev_b32 v44, 16, v44
    v_mul_f32 v45, v45, v46
    v_mul_f32 v44, v44, v46
    v_cvt_pk_bf16_f32 v44, v44, v45
    v_accvgpr_write_b32 a192, v44
    v_accvgpr_read_b32 v44, a193
    v_and_b32 v45, 0xffff0000, v44
    v_lshlrev_b32 v44, 16, v44
    v_mul_f32 v45, v45, v46
    v_mul_f32 v44, v44, v46
    v_cvt_pk_bf16_f32 v44, v44, v45
    v_accvgpr_write_b32 a193, v44
    v_accvgpr_read_b32 v44, a194
    v_and_b32 v45, 0xffff0000, v44
    v_lshlrev_b32 v44, 16, v44
    v_mul_f32 v45, v45, v46
    v_mul_f32 v44, v44, v46
    v_cvt_pk_bf16_f32 v44, v44, v45
    v_accvgpr_write_b32 a194, v44
    v_accvgpr_read_b32 v44, a195
    v_and_b32 v45, 0xffff0000, v44
    v_lshlrev_b32 v44, 16, v44
    v_mul_f32 v45, v45, v46
    v_mul_f32 v44, v44, v46
    v_cvt_pk_bf16_f32 v44, v44, v45
    v_accvgpr_write_b32 a195, v44
    v_accvgpr_read_b32 v44, a196
    v_and_b32 v45, 0xffff0000, v44
    v_lshlrev_b32 v44, 16, v44
    v_mul_f32 v45, v45, v46
    v_mul_f32 v44, v44, v46
    v_cvt_pk_bf16_f32 v44, v44, v45
    v_accvgpr_write_b32 a196, v44
    v_accvgpr_read_b32 v44, a197
    v_and_b32 v45, 0xffff0000, v44
    v_lshlrev_b32 v44, 16, v44
    v_mul_f32 v45, v45, v46
    v_mul_f32 v44, v44, v46
    v_cvt_pk_bf16_f32 v44, v44, v45
    v_accvgpr_write_b32 a197, v44
    v_accvgpr_read_b32 v44, a198
    v_and_b32 v45, 0xffff0000, v44
    v_lshlrev_b32 v44, 16, v44
    v_mul_f32 v45, v45, v46
    v_mul_f32 v44, v44, v46
    v_cvt_pk_bf16_f32 v44, v44, v45
    v_accvgpr_write_b32 a198, v44
    v_accvgpr_read_b32 v44, a199
    v_and_b32 v45, 0xffff0000, v44
    v_lshlrev_b32 v44, 16, v44
    v_mul_f32 v45, v45, v46
    v_mul_f32 v44, v44, v46
    v_cvt_pk_bf16_f32 v44, v44, v45
    v_accvgpr_write_b32 a199, v44
L_resc2_6:
    v_accvgpr_read_b32 v44, a176
    v_and_b32 v45, 0xffff0000, v44
    v_lshlrev_b32 v44, 16, v44
    v_mul_f32 v45, v45, v46
    v_mul_f32 v44, v44, v46
    v_cvt_pk_bf16_f32 v44, v44, v45
    v_accvgpr_write_b32 a176, v44
    v_accvgpr_read_b32 v44, a177
    v_and_b32 v45, 0xffff0000, v44
    v_lshlrev_b32 v44, 16, v44
    v_mul_f32 v45, v45, v46
    v_mul_f32 v44, v44, v46
    v_cvt_pk_bf16_f32 v44, v44, v45
    v_accvgpr_write_b32 a177, v44
    v_accvgpr_read_b32 v44, a178
    v_and_b32 v45, 0xffff0000, v44
    v_lshlrev_b32 v44, 16, v44
    v_mul_f32 v45, v45, v46
    v_mul_f32 v44, v44, v46
    v_cvt_pk_bf16_f32 v44, v44, v45
    v_accvgpr_write_b32 a178, v44
    v_accvgpr_read_b32 v44, a179
    v_and_b32 v45, 0xffff0000, v44
    v_lshlrev_b32 v44, 16, v44
    v_mul_f32 v45, v45, v46
    v_mul_f32 v44, v44, v46
    v_cvt_pk_bf16_f32 v44, v44, v45
    v_accvgpr_write_b32 a179, v44
    v_accvgpr_read_b32 v44, a180
    v_and_b32 v45, 0xffff0000, v44
    v_lshlrev_b32 v44, 16, v44
    v_mul_f32 v45, v45, v46
    v_mul_f32 v44, v44, v46
    v_cvt_pk_bf16_f32 v44, v44, v45
    v_accvgpr_write_b32 a180, v44
    v_accvgpr_read_b32 v44, a181
    v_and_b32 v45, 0xffff0000, v44
    v_lshlrev_b32 v44, 16, v44
    v_mul_f32 v45, v45, v46
    v_mul_f32 v44, v44, v46
    v_cvt_pk_bf16_f32 v44, v44, v45
    v_accvgpr_write_b32 a181, v44
    v_accvgpr_read_b32 v44, a182
    v_and_b32 v45, 0xffff0000, v44
    v_lshlrev_b32 v44, 16, v44
    v_mul_f32 v45, v45, v46
    v_mul_f32 v44, v44, v46
    v_cvt_pk_bf16_f32 v44, v44, v45
    v_accvgpr_write_b32 a182, v44
    v_accvgpr_read_b32 v44, a183
    v_and_b32 v45, 0xffff0000, v44
    v_lshlrev_b32 v44, 16, v44
    v_mul_f32 v45, v45, v46
    v_mul_f32 v44, v44, v46
    v_cvt_pk_bf16_f32 v44, v44, v45
    v_accvgpr_write_b32 a183, v44
L_resc2_5:
    v_accvgpr_read_b32 v44, a160
    v_and_b32 v45, 0xffff0000, v44
    v_lshlrev_b32 v44, 16, v44
    v_mul_f32 v45, v45, v46
    v_mul_f32 v44, v44, v46
    v_cvt_pk_bf16_f32 v44, v44, v45
    v_accvgpr_write_b32 a160, v44
    v_accvgpr_read_b32 v44, a161
    v_and_b32 v45, 0xffff0000, v44
    v_lshlrev_b32 v44, 16, v44
    v_mul_f32 v45, v45, v46
    v_mul_f32 v44, v44, v46
    v_cvt_pk_bf16_f32 v44, v44, v45
    v_accvgpr_write_b32 a161, v44
    v_accvgpr_read_b32 v44, a162
    v_and_b32 v45, 0xffff0000, v44
    v_lshlrev_b32 v44, 16, v44
    v_mul_f32 v45, v45, v46
    v_mul_f32 v44, v44, v46
    v_cvt_pk_bf16_f32 v44, v44, v45
    v_accvgpr_write_b32 a162, v44
    v_accvgpr_read_b32 v44, a163
    v_and_b32 v45, 0xffff0000, v44
    v_lshlrev_b32 v44, 16, v44
    v_mul_f32 v45, v45, v46
    v_mul_f32 v44, v44, v46
    v_cvt_pk_bf16_f32 v44, v44, v45
    v_accvgpr_write_b32 a163, v44
    v_accvgpr_read_b32 v44, a164
    v_and_b32 v45, 0xffff0000, v44
    v_lshlrev_b32 v44, 16, v44
    v_mul_f32 v45, v45, v46
    v_mul_f32 v44, v44, v46
    v_cvt_pk_bf16_f32 v44, v44, v45
    v_accvgpr_write_b32 a164, v44
    v_accvgpr_read_b32 v44, a165
    v_and_b32 v45, 0xffff0000, v44
    v_lshlrev_b32 v44, 16, v44
    v_mul_f32 v45, v45, v46
    v_mul_f32 v44, v44, v46
    v_cvt_pk_bf16_f32 v44, v44, v45
    v_accvgpr_write_b32 a165, v44
    v_accvgpr_read_b32 v44, a166
    v_and_b32 v45, 0xffff0000, v44
    v_lshlrev_b32 v44, 16, v44
    v_mul_f32 v45, v45, v46
    v_mul_f32 v44, v44, v46
    v_cvt_pk_bf16_f32 v44, v44, v45
    v_accvgpr_write_b32 a166, v44
    v_accvgpr_read_b32 v44, a167
    v_and_b32 v45, 0xffff0000, v44
    v_lshlrev_b32 v44, 16, v44
    v_mul_f32 v45, v45, v46
    v_mul_f32 v44, v44, v46
    v_cvt_pk_bf16_f32 v44, v44, v45
    v_accvgpr_write_b32 a167, v44
L_resc2_4:
    v_accvgpr_read_b32 v44, a144
    v_and_b32 v45, 0xffff0000, v44
    v_lshlrev_b32 v44, 16, v44
    v_mul_f32 v45, v45, v46
    v_mul_f32 v44, v44, v46
    v_cvt_pk_bf16_f32 v44, v44, v45
    v_accvgpr_write_b32 a144, v44
    v_accvgpr_read_b32 v44, a145
    v_and_b32 v45, 0xffff0000, v44
    v_lshlrev_b32 v44, 16, v44
    v_mul_f32 v45, v45, v46
    v_mul_f32 v44, v44, v46
    v_cvt_pk_bf16_f32 v44, v44, v45
    v_accvgpr_write_b32 a145, v44
    v_accvgpr_read_b32 v44, a146
    v_and_b32 v45, 0xffff0000, v44
    v_lshlrev_b32 v44, 16, v44
    v_mul_f32 v45, v45, v46
    v_mul_f32 v44, v44, v46
    v_cvt_pk_bf16_f32 v44, v44, v45
    v_accvgpr_write_b32 a146, v44
    v_accvgpr_read_b32 v44, a147
    v_and_b32 v45, 0xffff0000, v44
    v_lshlrev_b32 v44, 16, v44
    v_mul_f32 v45, v45, v46
    v_mul_f32 v44, v44, v46
    v_cvt_pk_bf16_f32 v44, v44, v45
    v_accvgpr_write_b32 a147, v44
    v_accvgpr_read_b32 v44, a148
    v_and_b32 v45, 0xffff0000, v44
    v_lshlrev_b32 v44, 16, v44
    v_mul_f32 v45, v45, v46
    v_mul_f32 v44, v44, v46
    v_cvt_pk_bf16_f32 v44, v44, v45
    v_accvgpr_write_b32 a148, v44
    v_accvgpr_read_b32 v44, a149
    v_and_b32 v45, 0xffff0000, v44
    v_lshlrev_b32 v44, 16, v44
    v_mul_f32 v45, v45, v46
    v_mul_f32 v44, v44, v46
    v_cvt_pk_bf16_f32 v44, v44, v45
    v_accvgpr_write_b32 a149, v44
    v_accvgpr_read_b32 v44, a150
    v_and_b32 v45, 0xffff0000, v44
    v_lshlrev_b32 v44, 16, v44
    v_mul_f32 v45, v45, v46
    v_mul_f32 v44, v44, v46
    v_cvt_pk_bf16_f32 v44, v44, v45
    v_accvgpr_write_b32 a150, v44
    v_accvgpr_read_b32 v44, a151
    v_and_b32 v45, 0xffff0000, v44
    v_lshlrev_b32 v44, 16, v44
    v_mul_f32 v45, v45, v46
    v_mul_f32 v44, v44, v46
    v_cvt_pk_bf16_f32 v44, v44, v45
    v_accvgpr_write_b32 a151, v44
L_resc2_3:
    v_accvgpr_read_b32 v44, a128
    v_and_b32 v45, 0xffff0000, v44
    v_lshlrev_b32 v44, 16, v44
    v_mul_f32 v45, v45, v46
    v_mul_f32 v44, v44, v46
    v_cvt_pk_bf16_f32 v44, v44, v45
    v_accvgpr_write_b32 a128, v44
    v_accvgpr_read_b32 v44, a129
    v_and_b32 v45, 0xffff0000, v44
    v_lshlrev_b32 v44, 16, v44
    v_mul_f32 v45, v45, v46
    v_mul_f32 v44, v44, v46
    v_cvt_pk_bf16_f32 v44, v44, v45
    v_accvgpr_write_b32 a129, v44
    v_accvgpr_read_b32 v44, a130
    v_and_b32 v45, 0xffff0000, v44
    v_lshlrev_b32 v44, 16, v44
    v_mul_f32 v45, v45, v46
    v_mul_f32 v44, v44, v46
    v_cvt_pk_bf16_f32 v44, v44, v45
    v_accvgpr_write_b32 a130, v44
    v_accvgpr_read_b32 v44, a131
    v_and_b32 v45, 0xffff0000, v44
    v_lshlrev_b32 v44, 16, v44
    v_mul_f32 v45, v45, v46
    v_mul_f32 v44, v44, v46
    v_cvt_pk_bf16_f32 v44, v44, v45
    v_accvgpr_write_b32 a131, v44
    v_accvgpr_read_b32 v44, a132
    v_and_b32 v45, 0xffff0000, v44
    v_lshlrev_b32 v44, 16, v44
    v_mul_f32 v45, v45, v46
    v_mul_f32 v44, v44, v46
    v_cvt_pk_bf16_f32 v44, v44, v45
    v_accvgpr_write_b32 a132, v44
    v_accvgpr_read_b32 v44, a133
    v_and_b32 v45, 0xffff0000, v44
    v_lshlrev_b32 v44, 16, v44
    v_mul_f32 v45, v45, v46
    v_mul_f32 v44, v44, v46
    v_cvt_pk_bf16_f32 v44, v44, v45
    v_accvgpr_write_b32 a133, v44
    v_accvgpr_read_b32 v44, a134
    v_and_b32 v45, 0xffff0000, v44
    v_lshlrev_b32 v44, 16, v44
    v_mul_f32 v45, v45, v46
    v_mul_f32 v44, v44, v46
    v_cvt_pk_bf16_f32 v44, v44, v45
    v_accvgpr_write_b32 a134, v44
    v_accvgpr_read_b32 v44, a135
    v_and_b32 v45, 0xffff0000, v44
    v_lshlrev_b32 v44, 16, v44
    v_mul_f32 v45, v45, v46
    v_mul_f32 v44, v44, v46
    v_cvt_pk_bf16_f32 v44, v44, v45
    v_accvgpr_write_b32 a135, v44
L_resc2_2:
    v_accvgpr_read_b32 v44, a112
    v_and_b32 v45, 0xffff0000, v44
    v_lshlrev_b32 v44, 16, v44
    v_mul_f32 v45, v45, v46
    v_mul_f32 v44, v44, v46
    v_cvt_pk_bf16_f32 v44, v44, v45
    v_accvgpr_write_b32 a112, v44
    v_accvgpr_read_b32 v44, a113
    v_and_b32 v45, 0xffff0000, v44
    v_lshlrev_b32 v44, 16, v44
    v_mul_f32 v45, v45, v46
    v_mul_f32 v44, v44, v46
    v_cvt_pk_bf16_f32 v44, v44, v45
    v_accvgpr_write_b32 a113, v44
    v_accvgpr_read_b32 v44, a114
    v_and_b32 v45, 0xffff0000, v44
    v_lshlrev_b32 v44, 16, v44
    v_mul_f32 v45, v45, v46
    v_mul_f32 v44, v44, v46
    v_cvt_pk_bf16_f32 v44, v44, v45
    v_accvgpr_write_b32 a114, v44
    v_accvgpr_read_b32 v44, a115
    v_and_b32 v45, 0xffff0000, v44
    v_lshlrev_b32 v44, 16, v44
    v_mul_f32 v45, v45, v46
    v_mul_f32 v44, v44, v46
    v_cvt_pk_bf16_f32 v44, v44, v45
    v_accvgpr_write_b32 a115, v44
    v_accvgpr_read_b32 v44, a116
    v_and_b32 v45, 0xffff0000, v44
    v_lshlrev_b32 v44, 16, v44
    v_mul_f32 v45, v45, v46
    v_mul_f32 v44, v44, v46
    v_cvt_pk_bf16_f32 v44, v44, v45
    v_accvgpr_write_b32 a116, v44
    v_accvgpr_read_b32 v44, a117
    v_and_b32 v45, 0xffff0000, v44
    v_lshlrev_b32 v44, 16, v44
    v_mul_f32 v45, v45, v46
    v_mul_f32 v44, v44, v46
    v_cvt_pk_bf16_f32 v44, v44, v45
    v_accvgpr_write_b32 a117, v44
    v_accvgpr_read_b32 v44, a118
    v_and_b32 v45, 0xffff0000, v44
    v_lshlrev_b32 v44, 16, v44
    v_mul_f32 v45, v45, v46
    v_mul_f32 v44, v44, v46
    v_cvt_pk_bf16_f32 v44, v44, v45
    v_accvgpr_write_b32 a118, v44
    v_accvgpr_read_b32 v44, a119
    v_and_b32 v45, 0xffff0000, v44
    v_lshlrev_b32 v44, 16, v44
    v_mul_f32 v45, v45, v46
    v_mul_f32 v44, v44, v46
    v_cvt_pk_bf16_f32 v44, v44, v45
    v_accvgpr_write_b32 a119, v44
L_resc2_1:
    v_accvgpr_read_b32 v44, a96
    v_and_b32 v45, 0xffff0000, v44
    v_lshlrev_b32 v44, 16, v44
    v_mul_f32 v45, v45, v46
    v_mul_f32 v44, v44, v46
    v_cvt_pk_bf16_f32 v44, v44, v45
    v_accvgpr_write_b32 a96, v44
    v_accvgpr_read_b32 v44, a97
    v_and_b32 v45, 0xffff0000, v44
    v_lshlrev_b32 v44, 16, v44
    v_mul_f32 v45, v45, v46
    v_mul_f32 v44, v44, v46
    v_cvt_pk_bf16_f32 v44, v44, v45
    v_accvgpr_write_b32 a97, v44
    v_accvgpr_read_b32 v44, a98
    v_and_b32 v45, 0xffff0000, v44
    v_lshlrev_b32 v44, 16, v44
    v_mul_f32 v45, v45, v46
    v_mul_f32 v44, v44, v46
    v_cvt_pk_bf16_f32 v44, v44, v45
    v_accvgpr_write_b32 a98, v44
    v_accvgpr_read_b32 v44, a99
    v_and_b32 v45, 0xffff0000, v44
    v_lshlrev_b32 v44, 16, v44
    v_mul_f32 v45, v45, v46
    v_mul_f32 v44, v44, v46
    v_cvt_pk_bf16_f32 v44, v44, v45
    v_accvgpr_write_b32 a99, v44
    v_accvgpr_read_b32 v44, a100
    v_and_b32 v45, 0xffff0000, v44
    v_lshlrev_b32 v44, 16, v44
    v_mul_f32 v45, v45, v46
    v_mul_f32 v44, v44, v46
    v_cvt_pk_bf16_f32 v44, v44, v45
    v_accvgpr_write_b32 a100, v44
    v_accvgpr_read_b32 v44, a101
    v_and_b32 v45, 0xffff0000, v44
    v_lshlrev_b32 v44, 16, v44
    v_mul_f32 v45, v45, v46
    v_mul_f32 v44, v44, v46
    v_cvt_pk_bf16_f32 v44, v44, v45
    v_accvgpr_write_b32 a101, v44
    v_accvgpr_read_b32 v44, a102
    v_and_b32 v45, 0xffff0000, v44
    v_lshlrev_b32 v44, 16, v44
    v_mul_f32 v45, v45, v46
    v_mul_f32 v44, v44, v46
    v_cvt_pk_bf16_f32 v44, v44, v45
    v_accvgpr_write_b32 a102, v44
    v_accvgpr_read_b32 v44, a103
    v_and_b32 v45, 0xffff0000, v44
    v_lshlrev_b32 v44, 16, v44
    v_mul_f32 v45, v45, v46
    v_mul_f32 v44, v44, v46
    v_cvt_pk_bf16_f32 v44, v44, v45
    v_accvgpr_write_b32 a103, v44
L_resc2_0:
    v_accvgpr_read_b32 v44, a80
    v_and_b32 v45, 0xffff0000, v44
    v_lshlrev_b32 v44, 16, v44
    v_mul_f32 v45, v45, v46
    v_mul_f32 v44, v44, v46
    v_cvt_pk_bf16_f32 v44, v44, v45
    v_accvgpr_write_b32 a80, v44
    v_accvgpr_read_b32 v44, a81
    v_and_b32 v45, 0xffff0000, v44
    v_lshlrev_b32 v44, 16, v44
    v_mul_f32 v45, v45, v46
    v_mul_f32 v44, v44, v46
    v_cvt_pk_bf16_f32 v44, v44, v45
    v_accvgpr_write_b32 a81, v44
    v_accvgpr_read_b32 v44, a82
    v_and_b32 v45, 0xffff0000, v44
    v_lshlrev_b32 v44, 16, v44
    v_mul_f32 v45, v45, v46
    v_mul_f32 v44, v44, v46
    v_cvt_pk_bf16_f32 v44, v44, v45
    v_accvgpr_write_b32 a82, v44
    v_accvgpr_read_b32 v44, a83
    v_and_b32 v45, 0xffff0000, v44
    v_lshlrev_b32 v44, 16, v44
    v_mul_f32 v45, v45, v46
    v_mul_f32 v44, v44, v46
    v_cvt_pk_bf16_f32 v44, v44, v45
    v_accvgpr_write_b32 a83, v44
    v_accvgpr_read_b32 v44, a84
    v_and_b32 v45, 0xffff0000, v44
    v_lshlrev_b32 v44, 16, v44
    v_mul_f32 v45, v45, v46
    v_mul_f32 v44, v44, v46
    v_cvt_pk_bf16_f32 v44, v44, v45
    v_accvgpr_write_b32 a84, v44
    v_accvgpr_read_b32 v44, a85
    v_and_b32 v45, 0xffff0000, v44
    v_lshlrev_b32 v44, 16, v44
    v_mul_f32 v45, v45, v46
    v_mul_f32 v44, v44, v46
    v_cvt_pk_bf16_f32 v44, v44, v45
    v_accvgpr_write_b32 a85, v44
    v_accvgpr_read_b32 v44, a86
    v_and_b32 v45, 0xffff0000, v44
    v_lshlrev_b32 v44, 16, v44
    v_mul_f32 v45, v45, v46
    v_mul_f32 v44, v44, v46
    v_cvt_pk_bf16_f32 v44, v44, v45
    v_accvgpr_write_b32 a86, v44
    v_accvgpr_read_b32 v44, a87
    v_and_b32 v45, 0xffff0000, v44
    v_lshlrev_b32 v44, 16, v44
    v_mul_f32 v45, v45, v46
    v_mul_f32 v44, v44, v46
    v_cvt_pk_bf16_f32 v44, v44, v45
    v_accvgpr_write_b32 a87, v44
    s_setpc_b64 s[34:35]
.section .rodata,"a"
.p2align 6
.amdhsa_kernel standalone__mha_softmax__near_ridge_kernel
  .amdhsa_next_free_vgpr 512
  .amdhsa_next_free_sgpr 80
  .amdhsa_accum_offset 256
  .amdhsa_group_segment_fixed_size 0
  .amdhsa_kernarg_size 48
  .amdhsa_user_sgpr_count 2
  .amdhsa_user_sgpr_kernarg_segment_ptr 1
  .amdhsa_system_sgpr_workgroup_id_x 1
.end_amdhsa_kernel
```
